```python
import torch

def _softmax(x, axis=-1):
    return torch.softmax(x, dim=axis)
def _gelu(x):
    return torch.nn.functional.gelu(x, approximate="tanh")
def _silu(x):
    return torch.nn.functional.silu(x)
def _sigmoid(x):
    return torch.sigmoid(x)
def _layernorm(x, axis=-1, eps=1e-5):
    m = x.mean(dim=axis, keepdim=True)
    v = x.var(dim=axis, keepdim=True, unbiased=False)
    return (x - m) / torch.sqrt(v + eps)
def _scatter_add(tgt, idx, src, axis=0):
    return tgt.clone().index_add_(axis, idx, src)
def _segment_sum(src, seg, n):
    out = torch.zeros((n,) + src.shape[1:], dtype=src.dtype)
    return out.index_add_(0, seg, src)
def _pad(x, pw):
    flat = tuple(v for pair in reversed(pw) for v in pair)
    return torch.nn.functional.pad(x, flat)

kernel_name = 'parallel_sum__linear_attn_block__geglu_ffn__prompt'

def setup_inputs():

    _w = (lambda a: (lambda t: t.to(torch.bfloat16) if t.is_floating_point() else t)(torch.as_tensor(a)))
    def _A_setup():
        B, S, D = 1, 2048, 448
        return {
            "x": _w((lambda *s: torch.randn(*s, dtype=torch.bfloat16) * 0.05)(B, S, D)),
            "wqkv": _w((lambda *s: torch.randn(*s, dtype=torch.bfloat16) * 0.4)(D, 3 * D)),
            "wo": _w((lambda *s: torch.randn(*s, dtype=torch.bfloat16) * 0.2)(D, D)),
        }
    _A_in = _A_setup()

    def _B_setup():
        B, S, D, F = 1, 2048, 448, 1792
        return {
            "x": _w((lambda *s: torch.randn(*s, dtype=torch.bfloat16) * 0.05)(B, S, D)),
            "w_gate": _w((lambda *s: torch.randn(*s, dtype=torch.bfloat16) * 0.05)(D, F)),
            "w_up": _w((lambda *s: torch.randn(*s, dtype=torch.bfloat16) * 0.05)(D, F)),
            "w_down": _w((lambda *s: torch.randn(*s, dtype=torch.bfloat16) * 0.05)(F, D)),
        }
    _B_in = _B_setup()

    return {
        "A_x": _A_in["x"],
        "A_wqkv": _A_in["wqkv"],
        "A_wo": _A_in["wo"],
        "B_x": _B_in["x"],
        "B_w_gate": _B_in["w_gate"],
        "B_w_up": _B_in["w_up"],
        "B_w_down": _B_in["w_down"],
    }

def reference(A_x, A_wqkv, A_wo, B_x, B_w_gate, B_w_up, B_w_down):
    def _A_ref(x, wqkv, wo):
        B, S, D = x.shape
        H = 16; Dh = D // H
        qkv = (lambda x, *d: x.permute(*d))((x @ wqkv).reshape(B, S, 3, H, Dh), 2, 0, 3, 1, 4)
        q, k, v = qkv[0], qkv[1], qkv[2]
        phi = lambda t: torch.where(t > 0, t + 1, torch.exp(t)) + 1e-6
        pq, pk = phi(q), phi(k)
        kv = torch.einsum("bhsd,bhse->bhde", pk, v)
        z = torch.einsum("bhsd->bhd", pk)
        num = torch.einsum("bhqd,bhde->bhqe", pq, kv)
        den = torch.einsum("bhqd,bhd->bhq", pq, z)[..., None] + 1e-6
        o = num / den
        return (lambda x, *d: x.permute(*d))(o, 0, 2, 1, 3).reshape(B, S, D) @ wo

    def _B_ref(x, w_gate, w_up, w_down):
        return (_gelu(x @ w_gate) * (x @ w_up)) @ w_down

    x = A_x
    xn = _layernorm(x, axis=-1)
    return x + _A_ref(xn, A_wqkv, A_wo) + _B_ref(xn, B_w_gate, B_w_up, B_w_down)
```

```asm
; @launch grid=(256,1,1) block=(256,1,1) lds=163840
.amdgcn_target "amdgcn-amd-amdhsa--gfx950"
.text
.globl parallel_sum__linear_attn_block__geglu_ffn__prompt_kernel
.p2align 8
.type parallel_sum__linear_attn_block__geglu_ffn__prompt_kernel,@function
parallel_sum__linear_attn_block__geglu_ffn__prompt_kernel:
s_cmp_ge_u32 s2, 256
s_cbranch_scc1 L_end
s_load_dwordx4 s[4:7], s[0:1], 0
s_load_dwordx4 s[20:23], s[0:1], 64
s_load_dwordx2 s[8:9], s[0:1], 16
s_load_dwordx4 s[12:15], s[0:1], 32
s_load_dwordx4 s[16:19], s[0:1], 48
s_getpc_b64 s[44:45]
L_pc:
v_lshrrev_b32 v192, 6, v0
v_and_b32 v193, 63, v0
v_readfirstlane_b32 s10, v192
v_lshlrev_b32 v1, 4, v193
s_and_b32 s11, s2, 7
s_lshr_b32 s92, s2, 3
s_and_b32 s45, s45, 0xffff
s_mov_b32 s46, L_codeend-L_pc
s_mov_b32 s47, 0x20000
s_lshl_b32 s3, s92, 11
v_cmp_gt_u32 vcc, 8, v193
v_lshlrev_b32 v194, 6, v193
v_lshl_add_u32 v194, v192, 9, v194
v_bfrev_b32 v224, 2
v_cndmask_b32 v194, v224, v194, vcc
v_cmp_gt_u32 vcc, 4, v193
s_mov_b32 s79, s2
buffer_load_dword a255, v194, s[44:47], s3 offen
v_cndmask_b32 v238, v224, v1, vcc
s_and_b32 s80, s11, 1
s_lshl_b32 s80, s80, 3
s_and_b32 s3, s92, 7
s_add_u32 s80, s80, s3
s_lshr_b32 s81, s11, 1
s_lshl_b32 s81, s81, 2
s_lshr_b32 s3, s92, 3
s_add_u32 s81, s81, s3
s_mov_b32 s99, s80
s_and_b32 s99, s99, 3
s_mul_i32 s85, s99, 7
s_lshr_b32 s85, s85, 2
v_lshrrev_b32 v222, 3, v193
v_mul_u32_u24 v222, 896, v222
v_lshrrev_b32 v196, 4, v193
v_and_b32 v197, 7, v193
v_xor_b32 v196, v196, v197
v_lshl_add_u32 v222, v196, 4, v222
v_xor_b32 v223, 64, v222
s_lshl_b32 s74, s80, 2
s_add_u32 s74, s74, s10
s_mul_i32 s86, s74, 28672
s_add_u32 s84, s10, 1
s_mul_i32 s84, s84, 28672
s_mov_b32 s26, 1835008
s_mov_b32 s27, 0x20000
s_waitcnt lgkmcnt(0)
s_mov_b32 s24, s4
s_and_b32 s25, s5, 0xffff
s_or_b32 s3, s2, s10
s_cbranch_scc0 L_spin900
L_ok900:
s_lshl_b32 s3, s80, 4
s_add_u32 s3, s3, s81
s_lshl_b32 s3, s3, 2
s_add_u32 s3, s3, s10
s_mul_i32 s3, s3, 1792
v_lshlrev_b32 v221, 7, v193
s_mov_b64 exec, 0x3fff
buffer_load_dword a255, v221, s[24:27], s3 offen
s_mov_b64 exec, -1
s_add_u32 m0, s84, 0
s_lshl_b32 s87, s85, 7
s_add_u32 s87, s87, s86
buffer_load_dwordx4 v222, s[24:27], s87 offen offset:0 lds
v_lshrrev_b32 v197, 5, v193
v_and_b32 v198, 31, v193
v_bfe_u32 v199, v193, 1, 3
v_xor_b32 v199, v199, v197
v_lshlrev_b32 v199, 4, v199
v_lshl_add_u32 v199, v198, 7, v199
v_add_u32 v199, s84, v199
s_mul_i32 s100, s99, 7
s_and_b32 s100, s100, 3
s_add_u32 s3, s100, 0
s_and_b32 s101, s3, 3
s_lshl_b32 s101, s101, 5
v_xor_b32 v204, s101, v199
s_lshr_b32 s3, s3, 2
s_lshl_b32 s101, s3, 12
v_add_u32 v204, s101, v204
s_add_u32 s87, s87, 6144
buffer_load_dwordx4 v223, s[24:27], s87 offen offset:1024 lds
s_mul_i32 s101, s3, 28672
v_subrev_u32 v212, s101, v204
s_add_u32 s3, s100, 1
s_and_b32 s101, s3, 3
s_lshl_b32 s101, s101, 5
v_xor_b32 v205, s101, v199
s_lshr_b32 s3, s3, 2
s_lshl_b32 s101, s3, 12
v_add_u32 v205, s101, v205
s_mul_i32 s101, s3, 28672
v_subrev_u32 v213, s101, v205
s_add_u32 s3, s100, 2
s_and_b32 s101, s3, 3
s_lshl_b32 s101, s101, 5
v_xor_b32 v206, s101, v199
s_lshr_b32 s3, s3, 2
s_add_u32 s87, s87, 6144
buffer_load_dwordx4 v222, s[24:27], s87 offen offset:2048 lds
s_lshl_b32 s101, s3, 12
v_add_u32 v206, s101, v206
s_mul_i32 s101, s3, 28672
v_subrev_u32 v214, s101, v206
s_add_u32 s3, s100, 3
s_and_b32 s101, s3, 3
s_lshl_b32 s101, s101, 5
v_xor_b32 v207, s101, v199
s_lshr_b32 s3, s3, 2
s_lshl_b32 s101, s3, 12
v_add_u32 v207, s101, v207
s_mul_i32 s101, s3, 28672
v_subrev_u32 v215, s101, v207
s_mul_i32 s83, s92, 37
s_lshr_b32 s83, s83, 8
s_mul_i32 s3, s83, 7
s_add_u32 s87, s87, 6144
buffer_load_dwordx4 v223, s[24:27], s87 offen offset:3072 lds
s_add_u32 s85, s85, 1
s_cmp_eq_u32 s85, 7
s_cselect_b32 s85, 0, s85
s_sub_u32 s78, s92, s3
s_cmp_lt_u32 s92, 28
s_cselect_b32 s77, 1, 0
s_and_b32 s3, s11, 1
s_lshl_b32 s3, s3, 4
s_add_u32 s83, s83, s3
s_lshr_b32 s11, s11, 1
s_lshl_b32 s11, s11, 2
s_add_u32 s83, s83, s11
s_mul_i32 s72, s10, 7168
s_lshl_b32 s73, s10, 11
s_and_b32 s82, s81, 1
s_lshr_b32 s100, s81, 1
s_sub_u32 s28, s6, 3072
s_subb_u32 s29, s7, 0
s_and_b32 s29, s29, 0xffff
s_add_u32 m0, s84, 4096
s_lshl_b32 s87, s85, 7
s_add_u32 s87, s87, s86
buffer_load_dwordx4 v222, s[24:27], s87 offen offset:0 lds
s_mov_b32 s30, 1207296
s_mov_b32 s31, 0x20000
s_and_b32 s5, s10, 1
s_lshr_b32 s4, s10, 1
s_cmp_eq_u32 s5, 0
s_cselect_b32 s32, s12, s14
s_cselect_b32 s33, s13, s15
s_sub_u32 s32, s32, 3072
s_subb_u32 s33, s33, 0
s_and_b32 s33, s33, 0xffff
s_mov_b32 s34, 1608704
s_mov_b32 s35, 0x20000
s_mov_b32 s40, s22
s_and_b32 s41, s23, 0xffff
s_mov_b32 s42, 12582912
s_mov_b32 s43, 0x20000
s_add_u32 s87, s87, 6144
buffer_load_dwordx4 v223, s[24:27], s87 offen offset:1024 lds
s_mov_b32 s44, s20
s_and_b32 s45, s21, 0xffff
s_mov_b32 s46, 256
s_mov_b32 s47, 0x20000
s_mov_b32 s48, 3072
s_mov_b32 s55, 3072
s_mov_b32 s49, 45056
s_mov_b32 s56, 59392
s_mov_b32 s50, 87040
s_mov_b32 s57, 115712
s_mov_b32 s51, 129024
s_mov_b32 s58, 172032
s_mov_b32 s52, 175104
s_mov_b32 s59, 232448
s_mov_b32 s53, 217088
s_mov_b32 s60, 288768
s_add_u32 s87, s87, 6144
buffer_load_dwordx4 v222, s[24:27], s87 offen offset:2048 lds
s_mov_b32 s54, 259072
s_mov_b32 s61, 345088
s_add_u32 s3, s99, 0
s_and_b32 s3, s3, 3
s_mul_i32 s62, s3, 401408
s_add_u32 s3, s99, 1
s_and_b32 s3, s3, 3
s_mul_i32 s63, s3, 401408
s_add_u32 s3, s99, 2
s_and_b32 s3, s3, 3
s_mul_i32 s64, s3, 401408
s_add_u32 s3, s99, 3
s_and_b32 s3, s3, 3
s_mul_i32 s65, s3, 401408
s_add_u32 s3, s99, s4
s_add_u32 s3, s3, 0
s_add_u32 s87, s87, 6144
buffer_load_dwordx4 v223, s[24:27], s87 offen offset:3072 lds
s_add_u32 s85, s85, 1
s_cmp_eq_u32 s85, 7
s_cselect_b32 s85, 0, s85
s_and_b32 s3, s3, 3
s_mul_i32 s66, s3, 301056
s_mul_i32 s68, s3, 401408
s_add_u32 s3, s99, s4
s_add_u32 s3, s3, 2
s_and_b32 s3, s3, 3
s_mul_i32 s67, s3, 301056
s_mul_i32 s69, s3, 401408
s_and_b32 s14, s100, 1
s_mul_i32 s15, s100, 448
s_mul_i32 s6, s14, 192
s_sub_u32 s13, 256, s6
s_lshl_b32 s7, s6, 1
s_sub_u32 s7, 384, s7
s_mul_i32 s21, s100, 112
s_cmp_eq_u32 s82, 0
s_cselect_b32 s6, s6, s13
s_cselect_b32 s36, s32, s28
s_cselect_b32 s37, s33, s29
s_cselect_b32 s38, s34, s30
s_cselect_b64 s[68:69], s[62:63], s[68:69]
s_cselect_b64 s[70:71], s[64:65], s[66:67]
s_cselect_b64 vcc, -1, 0
s_add_u32 m0, s84, 8192
s_lshl_b32 s87, s85, 7
s_add_u32 s87, s87, s86
buffer_load_dwordx4 v222, s[24:27], s87 offen offset:0 lds
s_mov_b32 s39, 0x20000
s_add_u32 s6, s6, s15
s_add_u32 s7, s7, s15
s_lshr_b32 s3, s81, 3
s_and_b32 s3, s3, 1
s_xor_b32 s98, s81, s3
s_mul_i32 s13, s5, 896
s_mul_i32 s3, s98, 56
s_add_u32 s13, s13, s3
s_add_u32 s87, s87, 6144
buffer_load_dwordx4 v223, s[24:27], s87 offen offset:1024 lds
s_add_u32 s13, s13, 896
v_lshrrev_b32 v197, 2, v193
v_and_b32 v198, 48, v1
v_mul_u32_u24 v6, 2688, v197
v_add3_u32 v6, v6, v198, s13
v_mul_u32_u24 v4, 3584, v197
v_add3_u32 v4, v4, v198, s7
v_lshrrev_b32 v197, 3, v193
v_bfe_u32 v198, v193, 4, 1
v_lshlrev_b32 v198, 6, v198
v_and_b32 v199, 0x70, v1
v_xor_b32 v198, v198, v199
v_mul_u32_u24 v199, 896, v197
v_add_u32 v7, v199, v198
s_lshl_b32 s5, s5, 3
v_add_u32 v199, s5, v197
s_add_u32 s87, s87, 6144
buffer_load_dwordx4 v222, s[24:27], s87 offen offset:2048 lds
v_mul_u32_u24 v199, 2688, v199
v_add3_u32 v5, v199, v198, s21
s_lshl_b32 s4, s4, 3
v_add_u32 v197, s4, v197
v_mul_u32_u24 v197, 3584, v197
v_add3_u32 v3, v197, v198, s6
v_add_u32 v197, 128, v3
v_cndmask_b32 v4, v4, v197, vcc
v_cndmask_b32 v5, v5, v197, vcc
s_lshl_b32 s3, s74, 3
s_add_u32 s3, s3, s100
s_mul_i32 s74, s3, 18432
s_lshl_b32 s3, s82, 13
s_add_u32 s74, s74, s3
s_add_u32 s75, s74, 4096
s_add_u32 s76, s74, 8192
s_add_u32 s87, s87, 6144
buffer_load_dwordx4 v223, s[24:27], s87 offen offset:3072 lds
s_add_u32 s85, s85, 1
s_cmp_eq_u32 s85, 7
s_cselect_b32 s85, 0, s85
s_lshl_b32 s1, s100, 12
s_add_u32 s1, s1, 10485760
s_cmp_eq_u32 s82, 0
s_cselect_b32 s0, 0x40000000, s76
s_cselect_b32 s1, 0x40000000, s1
s_lshl_b32 s3, s98, 16
s_add_u32 s3, s3, 9437184
s_lshl_b32 s4, s80, 12
s_add_u32 s2, s3, s4
s_lshl_b32 s4, s10, 14
s_add_u32 s6, s3, s4
s_lshl_b32 s4, s80, 8
s_add_u32 s6, s6, s4
s_lshl_b32 s7, s98, 11
s_add_u32 s7, s7, 10485760
s_lshr_b32 s3, s80, 3
s_add_u32 m0, s84, 12288
s_lshl_b32 s87, s85, 7
s_add_u32 s87, s87, s86
buffer_load_dwordx4 v222, s[24:27], s87 offen offset:0 lds
s_lshl_b32 s3, s3, 10
s_add_u32 s7, s7, s3
s_bfe_u32 s3, s80, 0x10002
s_lshl_b32 s3, s3, 3
s_add_u32 s7, s7, s3
s_and_b32 s3, s80, 3
s_lshl_b32 s3, s3, 2
s_add_u32 s3, s3, s10
s_lshl_b32 s3, s3, 6
s_add_u32 s7, s7, s3
s_mov_b32 s93, 0x3f80
s_mov_b32 s94, 0x3f800000
s_mov_b32 s95, 0x3f803f80
s_mul_i32 s3, s83, 57344
s_lshl_b32 s92, s78, 7
s_add_u32 s3, s3, s92
s_add_u32 s87, s87, 6144
buffer_load_dwordx4 v223, s[24:27], s87 offen offset:1024 lds
v_add_u32 v7, s92, v7
v_lshrrev_b32 v197, 5, v193
v_bfe_u32 v198, v193, 2, 2
v_bfe_u32 v199, v193, 4, 1
v_and_b32 v200, 3, v193
v_lshlrev_b32 v200, 3, v200
s_nop 0
v_lshl_add_u32 v200, v199, 5, v200
v_lshl_add_u32 v201, v197, 3, v198
v_lshl_add_u32 v8, v201, 6, v200
v_add_u32 v9, 57344, v8
v_add_u32 v10, 114688, v8
v_bfe_u32 v199, v193, 3, 1
v_lshl_add_u32 v200, v199, 6, v200
v_lshl_add_u32 v200, v198, 7, v200
v_mul_u32_u24 v201, 14336, v197
v_add_u32 v201, v200, v201
s_add_u32 s87, s87, 6144
buffer_load_dwordx4 v222, s[24:27], s87 offen offset:2048 lds
v_add_u32 v232, 57344, v201
v_add_u32 v233, 114688, v201
v_xor_b32 v234, 64, v232
v_xor_b32 v235, 64, v233
v_lshl_add_u32 v200, v197, 9, v200
v_add_u32 v236, s73, v200
v_xor_b32 v237, 64, v236
v_add_u32 v226, 0x20000, v236
v_add_u32 v228, 0x20000, v237
v_and_b32 v198, 31, v193
s_lshl_b32 s92, s10, 7
s_add_u32 s92, s92, 159744
v_lshl_add_u32 v240, v197, 4, s92
v_lshl_add_u32 v230, v198, 2, s92
s_lshl_b32 s92, s10, 12
s_add_u32 s92, s92, 143360
s_add_u32 s87, s87, 6144
buffer_load_dwordx4 v223, s[24:27], s87 offen offset:3072 lds
s_add_u32 s85, s85, 1
s_cmp_eq_u32 s85, 7
s_cselect_b32 s85, 0, s85
v_add_u32 v241, s92, v1
s_lshl_b32 s92, s10, 10
s_add_u32 s92, s92, 143360
v_add_u32 v242, s92, v1
v_lshrrev_b32 v200, 4, v193
v_and_b32 v201, 0xf0, v1
v_lshl_add_u32 v243, v200, 12, v201
v_lshrrev_b32 v200, 2, v193
v_and_b32 v201, 48, v1
v_lshl_add_u32 v200, v200, 8, v201
s_lshl_b32 s92, s10, 6
v_add_u32 v239, s92, v200
v_cmp_eq_u32 vcc, 0, v193
v_mov_b32 v225, 1
s_nop 0
v_cndmask_b32 v224, v224, 0, vcc
v_lshlrev_b32 v229, 2, v198
s_waitcnt vmcnt(8)
ds_read_b128 v[16:19], v204 offset:0
ds_read_b128 v[20:23], v205 offset:0
ds_read_b128 v[24:27], v206 offset:0
ds_read_b128 v[28:31], v207 offset:0
s_add_u32 m0, s84, 16384
s_lshl_b32 s87, s85, 7
s_add_u32 s87, s87, s86
buffer_load_dwordx4 v222, s[24:27], s87 offen offset:0 lds
s_add_u32 s87, s87, 6144
buffer_load_dwordx4 v223, s[24:27], s87 offen offset:1024 lds
s_add_u32 s87, s87, 6144
buffer_load_dwordx4 v222, s[24:27], s87 offen offset:2048 lds
s_add_u32 s87, s87, 6144
buffer_load_dwordx4 v223, s[24:27], s87 offen offset:3072 lds
s_add_u32 s85, s85, 1
s_cmp_eq_u32 s85, 7
s_cselect_b32 s85, 0, s85
s_waitcnt vmcnt(8)
s_or_b32 s101, s79, s10
s_cbranch_scc0 L_spin901
L_ok901:
ds_read_b128 v[32:35], v204 offset:4096
ds_read_b128 v[36:39], v205 offset:4096
ds_read_b128 v[40:43], v206 offset:4096
ds_read_b128 v[44:47], v207 offset:4096
s_waitcnt lgkmcnt(4)
s_nop 0
v_dot2_f32_bf16 v208, v16, s95, 0
v_dot2_f32_bf16 v210, v16, v16, 0
v_dot2_f32_bf16 v209, v17, s95, 0
v_dot2_f32_bf16 v211, v17, v17, 0
v_dot2_f32_bf16 v208, v18, s95, v208
v_dot2_f32_bf16 v210, v18, v18, v210
v_dot2_f32_bf16 v209, v19, s95, v209
v_dot2_f32_bf16 v211, v19, v19, v211
v_dot2_f32_bf16 v208, v20, s95, v208
v_dot2_f32_bf16 v210, v20, v20, v210
v_dot2_f32_bf16 v209, v21, s95, v209
v_dot2_f32_bf16 v211, v21, v21, v211
v_dot2_f32_bf16 v208, v22, s95, v208
v_dot2_f32_bf16 v210, v22, v22, v210
v_dot2_f32_bf16 v209, v23, s95, v209
v_dot2_f32_bf16 v211, v23, v23, v211
v_dot2_f32_bf16 v208, v24, s95, v208
v_dot2_f32_bf16 v210, v24, v24, v210
v_dot2_f32_bf16 v209, v25, s95, v209
v_dot2_f32_bf16 v211, v25, v25, v211
v_dot2_f32_bf16 v208, v26, s95, v208
v_dot2_f32_bf16 v210, v26, v26, v210
v_dot2_f32_bf16 v209, v27, s95, v209
v_dot2_f32_bf16 v211, v27, v27, v211
v_dot2_f32_bf16 v208, v28, s95, v208
v_dot2_f32_bf16 v210, v28, v28, v210
v_dot2_f32_bf16 v209, v29, s95, v209
v_dot2_f32_bf16 v211, v29, v29, v211
v_dot2_f32_bf16 v208, v30, s95, v208
v_dot2_f32_bf16 v210, v30, v30, v210
v_dot2_f32_bf16 v209, v31, s95, v209
v_dot2_f32_bf16 v211, v31, v31, v211
s_add_u32 m0, s84, 20480
s_lshl_b32 s87, s85, 7
s_add_u32 s87, s87, s86
buffer_load_dwordx4 v222, s[24:27], s87 offen offset:0 lds
s_add_u32 s87, s87, 6144
buffer_load_dwordx4 v223, s[24:27], s87 offen offset:1024 lds
s_add_u32 s87, s87, 6144
buffer_load_dwordx4 v222, s[24:27], s87 offen offset:2048 lds
s_add_u32 s87, s87, 6144
buffer_load_dwordx4 v223, s[24:27], s87 offen offset:3072 lds
s_add_u32 s85, s85, 1
s_cmp_eq_u32 s85, 7
s_cselect_b32 s85, 0, s85
s_waitcnt vmcnt(8)
ds_read_b128 v[48:51], v204 offset:8192
ds_read_b128 v[52:55], v205 offset:8192
ds_read_b128 v[56:59], v206 offset:8192
ds_read_b128 v[60:63], v207 offset:8192
s_waitcnt lgkmcnt(4)
s_nop 0
v_dot2_f32_bf16 v208, v32, s95, v208
v_dot2_f32_bf16 v210, v32, v32, v210
v_dot2_f32_bf16 v209, v33, s95, v209
v_dot2_f32_bf16 v211, v33, v33, v211
v_dot2_f32_bf16 v208, v34, s95, v208
v_dot2_f32_bf16 v210, v34, v34, v210
v_dot2_f32_bf16 v209, v35, s95, v209
v_dot2_f32_bf16 v211, v35, v35, v211
v_dot2_f32_bf16 v208, v36, s95, v208
v_dot2_f32_bf16 v210, v36, v36, v210
v_dot2_f32_bf16 v209, v37, s95, v209
v_dot2_f32_bf16 v211, v37, v37, v211
v_dot2_f32_bf16 v208, v38, s95, v208
v_dot2_f32_bf16 v210, v38, v38, v210
v_dot2_f32_bf16 v209, v39, s95, v209
v_dot2_f32_bf16 v211, v39, v39, v211
v_dot2_f32_bf16 v208, v40, s95, v208
v_dot2_f32_bf16 v210, v40, v40, v210
v_dot2_f32_bf16 v209, v41, s95, v209
v_dot2_f32_bf16 v211, v41, v41, v211
v_dot2_f32_bf16 v208, v42, s95, v208
v_dot2_f32_bf16 v210, v42, v42, v210
v_dot2_f32_bf16 v209, v43, s95, v209
v_dot2_f32_bf16 v211, v43, v43, v211
v_dot2_f32_bf16 v208, v44, s95, v208
v_dot2_f32_bf16 v210, v44, v44, v210
v_dot2_f32_bf16 v209, v45, s95, v209
v_dot2_f32_bf16 v211, v45, v45, v211
v_dot2_f32_bf16 v208, v46, s95, v208
v_dot2_f32_bf16 v210, v46, v46, v210
v_dot2_f32_bf16 v209, v47, s95, v209
v_dot2_f32_bf16 v211, v47, v47, v211
s_add_u32 m0, s84, 24576
s_lshl_b32 s87, s85, 7
s_add_u32 s87, s87, s86
buffer_load_dwordx4 v222, s[24:27], s87 offen offset:0 lds
s_add_u32 s87, s87, 6144
buffer_load_dwordx4 v223, s[24:27], s87 offen offset:1024 lds
s_add_u32 s87, s87, 6144
buffer_load_dwordx4 v222, s[24:27], s87 offen offset:2048 lds
s_add_u32 s87, s87, 6144
buffer_load_dwordx4 v223, s[24:27], s87 offen offset:3072 lds
s_lshr_b32 s101, s79, 7
s_lshl_b32 s101, s101, 3
s_bfe_u32 s87, s79, 0x30003
s_add_u32 s101, s101, s87
s_and_b32 s87, s79, 7
s_lshl_b32 s87, s87, 4
s_add_u32 s87, s87, s101
s_lshl_b32 s87, s87, 2
s_add_u32 s98, s87, s10
s_lshl_b32 s101, s101, 1
s_lshr_b32 s87, s10, 1
s_add_u32 s101, s101, s87
s_and_b32 s87, s79, 1
s_lshl_b32 s87, s87, 5
s_add_u32 s101, s101, s87
s_mul_i32 s101, s101, 25088
s_lshr_b32 s87, s81, 2
s_mul_i32 s87, s87, 896
s_add_u32 s101, s101, s87
s_add_u32 s101, s101, 3072
s_cmp_eq_u32 s82, 0
s_cselect_b32 s98, 0x80000, s98
s_cselect_b32 s101, 0x40000000, s101
s_mul_i32 s87, s98, 2352
s_add_u32 s87, s87, 3072
v_mul_u32_u24 v231, 37, v193
v_lshrrev_b32 v231, 8, v231
v_mul_u32_u24 v231, 2688, v231
v_lshl_add_u32 v231, v193, 7, v231
v_lshlrev_b32 v221, 7, v193
s_mov_b64 exec, 0x7ffff
buffer_load_dword a255, v221, s[28:31], s87 offen
s_mov_b32 exec_lo, -1
s_mov_b32 exec_hi, 0x1ffff
buffer_load_dword a255, v231, s[32:35], s101 offen
s_mov_b64 exec, -1
s_waitcnt vmcnt(10)
ds_read_b128 v[64:67], v204 offset:12288
ds_read_b128 v[68:71], v205 offset:12288
ds_read_b128 v[72:75], v206 offset:12288
ds_read_b128 v[76:79], v207 offset:12288
s_waitcnt lgkmcnt(4)
s_nop 0
v_dot2_f32_bf16 v208, v48, s95, v208
v_dot2_f32_bf16 v210, v48, v48, v210
v_dot2_f32_bf16 v209, v49, s95, v209
v_dot2_f32_bf16 v211, v49, v49, v211
v_dot2_f32_bf16 v208, v50, s95, v208
v_dot2_f32_bf16 v210, v50, v50, v210
v_dot2_f32_bf16 v209, v51, s95, v209
v_dot2_f32_bf16 v211, v51, v51, v211
v_dot2_f32_bf16 v208, v52, s95, v208
v_dot2_f32_bf16 v210, v52, v52, v210
v_dot2_f32_bf16 v209, v53, s95, v209
v_dot2_f32_bf16 v211, v53, v53, v211
v_dot2_f32_bf16 v208, v54, s95, v208
v_dot2_f32_bf16 v210, v54, v54, v210
v_dot2_f32_bf16 v209, v55, s95, v209
v_dot2_f32_bf16 v211, v55, v55, v211
v_dot2_f32_bf16 v208, v56, s95, v208
v_dot2_f32_bf16 v210, v56, v56, v210
v_dot2_f32_bf16 v209, v57, s95, v209
v_dot2_f32_bf16 v211, v57, v57, v211
v_dot2_f32_bf16 v208, v58, s95, v208
v_dot2_f32_bf16 v210, v58, v58, v210
v_dot2_f32_bf16 v209, v59, s95, v209
v_dot2_f32_bf16 v211, v59, v59, v211
v_dot2_f32_bf16 v208, v60, s95, v208
v_dot2_f32_bf16 v210, v60, v60, v210
v_dot2_f32_bf16 v209, v61, s95, v209
v_dot2_f32_bf16 v211, v61, v61, v211
v_dot2_f32_bf16 v208, v62, s95, v208
v_dot2_f32_bf16 v210, v62, v62, v210
v_dot2_f32_bf16 v209, v63, s95, v209
v_dot2_f32_bf16 v211, v63, v63, v211
s_waitcnt vmcnt(6)
ds_read_b128 v[80:83], v204 offset:16384
ds_read_b128 v[84:87], v205 offset:16384
ds_read_b128 v[88:91], v206 offset:16384
ds_read_b128 v[92:95], v207 offset:16384
s_waitcnt lgkmcnt(4)
v_dot2_f32_bf16 v208, v64, s95, v208
v_dot2_f32_bf16 v210, v64, v64, v210
v_dot2_f32_bf16 v209, v65, s95, v209
v_dot2_f32_bf16 v211, v65, v65, v211
v_dot2_f32_bf16 v208, v66, s95, v208
v_dot2_f32_bf16 v210, v66, v66, v210
v_dot2_f32_bf16 v209, v67, s95, v209
v_dot2_f32_bf16 v211, v67, v67, v211
v_dot2_f32_bf16 v208, v68, s95, v208
v_dot2_f32_bf16 v210, v68, v68, v210
v_dot2_f32_bf16 v209, v69, s95, v209
v_dot2_f32_bf16 v211, v69, v69, v211
v_dot2_f32_bf16 v208, v70, s95, v208
v_dot2_f32_bf16 v210, v70, v70, v210
v_dot2_f32_bf16 v209, v71, s95, v209
v_dot2_f32_bf16 v211, v71, v71, v211
v_dot2_f32_bf16 v208, v72, s95, v208
v_dot2_f32_bf16 v210, v72, v72, v210
v_dot2_f32_bf16 v209, v73, s95, v209
v_dot2_f32_bf16 v211, v73, v73, v211
v_dot2_f32_bf16 v208, v74, s95, v208
v_dot2_f32_bf16 v210, v74, v74, v210
v_dot2_f32_bf16 v209, v75, s95, v209
v_dot2_f32_bf16 v211, v75, v75, v211
v_dot2_f32_bf16 v208, v76, s95, v208
v_dot2_f32_bf16 v210, v76, v76, v210
v_dot2_f32_bf16 v209, v77, s95, v209
v_dot2_f32_bf16 v211, v77, v77, v211
v_dot2_f32_bf16 v208, v78, s95, v208
v_dot2_f32_bf16 v210, v78, v78, v210
v_dot2_f32_bf16 v209, v79, s95, v209
v_dot2_f32_bf16 v211, v79, v79, v211
s_waitcnt vmcnt(2)
ds_read_b128 v[96:99], v204 offset:20480
ds_read_b128 v[100:103], v205 offset:20480
ds_read_b128 v[104:107], v206 offset:20480
ds_read_b128 v[108:111], v207 offset:20480
s_waitcnt lgkmcnt(4)
v_dot2_f32_bf16 v208, v80, s95, v208
v_dot2_f32_bf16 v210, v80, v80, v210
v_dot2_f32_bf16 v209, v81, s95, v209
v_dot2_f32_bf16 v211, v81, v81, v211
v_dot2_f32_bf16 v208, v82, s95, v208
v_dot2_f32_bf16 v210, v82, v82, v210
v_dot2_f32_bf16 v209, v83, s95, v209
v_dot2_f32_bf16 v211, v83, v83, v211
v_dot2_f32_bf16 v208, v84, s95, v208
v_dot2_f32_bf16 v210, v84, v84, v210
v_dot2_f32_bf16 v209, v85, s95, v209
v_dot2_f32_bf16 v211, v85, v85, v211
v_dot2_f32_bf16 v208, v86, s95, v208
v_dot2_f32_bf16 v210, v86, v86, v210
v_dot2_f32_bf16 v209, v87, s95, v209
v_dot2_f32_bf16 v211, v87, v87, v211
v_dot2_f32_bf16 v208, v88, s95, v208
v_dot2_f32_bf16 v210, v88, v88, v210
v_dot2_f32_bf16 v209, v89, s95, v209
v_dot2_f32_bf16 v211, v89, v89, v211
v_dot2_f32_bf16 v208, v90, s95, v208
v_dot2_f32_bf16 v210, v90, v90, v210
v_dot2_f32_bf16 v209, v91, s95, v209
v_dot2_f32_bf16 v211, v91, v91, v211
v_dot2_f32_bf16 v208, v92, s95, v208
v_dot2_f32_bf16 v210, v92, v92, v210
v_dot2_f32_bf16 v209, v93, s95, v209
v_dot2_f32_bf16 v211, v93, v93, v211
v_dot2_f32_bf16 v208, v94, s95, v208
v_dot2_f32_bf16 v210, v94, v94, v210
v_dot2_f32_bf16 v209, v95, s95, v209
v_dot2_f32_bf16 v211, v95, v95, v211
ds_read_b128 v[112:115], v212 offset:24576
ds_read_b128 v[116:119], v213 offset:24576
ds_read_b128 v[120:123], v214 offset:24576
ds_read_b128 v[124:127], v215 offset:24576
s_waitcnt lgkmcnt(4)
s_nop 0
v_dot2_f32_bf16 v208, v96, s95, v208
v_dot2_f32_bf16 v210, v96, v96, v210
v_dot2_f32_bf16 v209, v97, s95, v209
v_dot2_f32_bf16 v211, v97, v97, v211
v_dot2_f32_bf16 v208, v98, s95, v208
v_dot2_f32_bf16 v210, v98, v98, v210
v_dot2_f32_bf16 v209, v99, s95, v209
v_dot2_f32_bf16 v211, v99, v99, v211
v_dot2_f32_bf16 v208, v100, s95, v208
v_dot2_f32_bf16 v210, v100, v100, v210
v_dot2_f32_bf16 v209, v101, s95, v209
v_dot2_f32_bf16 v211, v101, v101, v211
v_dot2_f32_bf16 v208, v102, s95, v208
v_dot2_f32_bf16 v210, v102, v102, v210
v_dot2_f32_bf16 v209, v103, s95, v209
v_dot2_f32_bf16 v211, v103, v103, v211
v_dot2_f32_bf16 v208, v104, s95, v208
v_dot2_f32_bf16 v210, v104, v104, v210
v_dot2_f32_bf16 v209, v105, s95, v209
v_dot2_f32_bf16 v211, v105, v105, v211
v_dot2_f32_bf16 v208, v106, s95, v208
v_dot2_f32_bf16 v210, v106, v106, v210
v_dot2_f32_bf16 v209, v107, s95, v209
v_dot2_f32_bf16 v211, v107, v107, v211
v_dot2_f32_bf16 v208, v108, s95, v208
v_dot2_f32_bf16 v210, v108, v108, v210
v_dot2_f32_bf16 v209, v109, s95, v209
v_dot2_f32_bf16 v211, v109, v109, v211
v_dot2_f32_bf16 v208, v110, s95, v208
v_dot2_f32_bf16 v210, v110, v110, v210
v_dot2_f32_bf16 v209, v111, s95, v209
v_dot2_f32_bf16 v211, v111, v111, v211
s_waitcnt lgkmcnt(0)
s_barrier
v_dot2_f32_bf16 v208, v112, s95, v208
v_dot2_f32_bf16 v210, v112, v112, v210
v_dot2_f32_bf16 v209, v113, s95, v209
v_dot2_f32_bf16 v211, v113, v113, v211
v_dot2_f32_bf16 v208, v114, s95, v208
v_dot2_f32_bf16 v210, v114, v114, v210
v_dot2_f32_bf16 v209, v115, s95, v209
v_dot2_f32_bf16 v211, v115, v115, v211
v_add_u32 v2, s66, v6
s_add_u32 m0, s72, 0
s_nop 0
buffer_load_dwordx4 v2, s[28:31], s48 offen offset:0 lds
s_nop 0
v_dot2_f32_bf16 v208, v116, s95, v208
v_dot2_f32_bf16 v210, v116, v116, v210
v_dot2_f32_bf16 v209, v117, s95, v209
v_dot2_f32_bf16 v211, v117, v117, v211
v_dot2_f32_bf16 v208, v118, s95, v208
v_dot2_f32_bf16 v210, v118, v118, v210
v_dot2_f32_bf16 v209, v119, s95, v209
v_dot2_f32_bf16 v211, v119, v119, v211
s_add_u32 m0, s72, 0
s_nop 0
buffer_load_dwordx4 v2, s[28:31], s49 offen offset:1024 lds
v_dot2_f32_bf16 v208, v120, s95, v208
v_dot2_f32_bf16 v210, v120, v120, v210
v_dot2_f32_bf16 v209, v121, s95, v209
v_dot2_f32_bf16 v211, v121, v121, v211
v_dot2_f32_bf16 v208, v122, s95, v208
v_dot2_f32_bf16 v210, v122, v122, v210
v_dot2_f32_bf16 v209, v123, s95, v209
v_dot2_f32_bf16 v211, v123, v123, v211
v_dot2_f32_bf16 v208, v124, s95, v208
v_dot2_f32_bf16 v210, v124, v124, v210
v_dot2_f32_bf16 v209, v125, s95, v209
v_dot2_f32_bf16 v211, v125, v125, v211
v_dot2_f32_bf16 v208, v126, s95, v208
v_dot2_f32_bf16 v210, v126, v126, v210
v_dot2_f32_bf16 v209, v127, s95, v209
v_dot2_f32_bf16 v211, v127, v127, v211
s_nop 1
v_add_f32 v208, v208, v209
v_add_f32 v210, v210, v211
v_mov_b32 v209, v208
v_mov_b32 v211, v210
s_nop 0
v_permlane32_swap_b32 v208, v209
v_permlane32_swap_b32 v210, v211
v_add_f32 v208, v208, v209
v_add_f32 v210, v210, v211
v_mul_f32 v208, 0x3b124925, v208
v_mul_f32 v210, 0x3b124925, v210
v_fma_f32 v210, -v208, v208, v210
v_max_f32 v210, 0, v210
v_add_f32 v13, 0x3727c5ac, v210
v_rsq_f32 v14, v13
s_nop 0
v_mul_f32 v11, 0xc0135761, v14
v_mul_f32 v15, 0x3fb8aa3b, v14
v_mul_f32 v209, v14, v14
v_mul_f32 v209, v209, v14
v_mul_f32 v12, 0xbdd2d3e8, v209
ds_write_b32 v230, v15
v_dot2_f32_bf16 v212, v16, s93, v208 neg_lo:[0,0,1]
v_dot2_f32_bf16 v213, v16, s94, v208 neg_lo:[0,0,1]
v_dot2_f32_bf16 v214, v17, s93, v208 neg_lo:[0,0,1]
v_dot2_f32_bf16 v215, v17, s94, v208 neg_lo:[0,0,1]
v_mov_b32 v200, -1
v_mov_b32 v201, -1
v_mov_b32 v202, -1
v_mov_b32 v203, -1
buffer_store_dwordx4 v[200:203], v243, s[40:43], s6 offen sc1
s_nop 0
v_dot2_f32_bf16 v216, v18, s93, v208 neg_lo:[0,0,1]
v_dot2_f32_bf16 v217, v18, s94, v208 neg_lo:[0,0,1]
v_dot2_f32_bf16 v218, v19, s93, v208 neg_lo:[0,0,1]
v_dot2_f32_bf16 v219, v19, s94, v208 neg_lo:[0,0,1]
v_cvt_pk_bf16_f32 v16, v212, v213
v_cvt_pk_bf16_f32 v17, v214, v215
v_dot2_f32_bf16 v212, v20, s93, v208 neg_lo:[0,0,1]
v_dot2_f32_bf16 v213, v20, s94, v208 neg_lo:[0,0,1]
v_dot2_f32_bf16 v214, v21, s93, v208 neg_lo:[0,0,1]
v_dot2_f32_bf16 v215, v21, s94, v208 neg_lo:[0,0,1]
v_cvt_pk_bf16_f32 v18, v216, v217
v_cvt_pk_bf16_f32 v19, v218, v219
v_dot2_f32_bf16 v216, v22, s93, v208 neg_lo:[0,0,1]
v_dot2_f32_bf16 v217, v22, s94, v208 neg_lo:[0,0,1]
v_dot2_f32_bf16 v218, v23, s93, v208 neg_lo:[0,0,1]
v_dot2_f32_bf16 v219, v23, s94, v208 neg_lo:[0,0,1]
v_cvt_pk_bf16_f32 v20, v212, v213
v_cvt_pk_bf16_f32 v21, v214, v215
v_dot2_f32_bf16 v212, v24, s93, v208 neg_lo:[0,0,1]
v_dot2_f32_bf16 v213, v24, s94, v208 neg_lo:[0,0,1]
v_dot2_f32_bf16 v214, v25, s93, v208 neg_lo:[0,0,1]
v_dot2_f32_bf16 v215, v25, s94, v208 neg_lo:[0,0,1]
v_cvt_pk_bf16_f32 v22, v216, v217
v_cvt_pk_bf16_f32 v23, v218, v219
buffer_store_dwordx2 v[200:201], v238, s[40:43], s7 offen sc1
v_dot2_f32_bf16 v216, v26, s93, v208 neg_lo:[0,0,1]
v_dot2_f32_bf16 v217, v26, s94, v208 neg_lo:[0,0,1]
v_dot2_f32_bf16 v218, v27, s93, v208 neg_lo:[0,0,1]
v_dot2_f32_bf16 v219, v27, s94, v208 neg_lo:[0,0,1]
v_cvt_pk_bf16_f32 v24, v212, v213
v_cvt_pk_bf16_f32 v25, v214, v215
v_dot2_f32_bf16 v212, v28, s93, v208 neg_lo:[0,0,1]
v_dot2_f32_bf16 v213, v28, s94, v208 neg_lo:[0,0,1]
v_dot2_f32_bf16 v214, v29, s93, v208 neg_lo:[0,0,1]
v_dot2_f32_bf16 v215, v29, s94, v208 neg_lo:[0,0,1]
v_cvt_pk_bf16_f32 v26, v216, v217
v_cvt_pk_bf16_f32 v27, v218, v219
v_dot2_f32_bf16 v216, v30, s93, v208 neg_lo:[0,0,1]
v_dot2_f32_bf16 v217, v30, s94, v208 neg_lo:[0,0,1]
v_dot2_f32_bf16 v218, v31, s93, v208 neg_lo:[0,0,1]
v_dot2_f32_bf16 v219, v31, s94, v208 neg_lo:[0,0,1]
v_cvt_pk_bf16_f32 v28, v212, v213
v_cvt_pk_bf16_f32 v29, v214, v215
v_dot2_f32_bf16 v212, v32, s93, v208 neg_lo:[0,0,1]
v_dot2_f32_bf16 v213, v32, s94, v208 neg_lo:[0,0,1]
v_dot2_f32_bf16 v214, v33, s93, v208 neg_lo:[0,0,1]
v_dot2_f32_bf16 v215, v33, s94, v208 neg_lo:[0,0,1]
v_cvt_pk_bf16_f32 v30, v216, v217
v_cvt_pk_bf16_f32 v31, v218, v219
v_dot2_f32_bf16 v216, v34, s93, v208 neg_lo:[0,0,1]
v_dot2_f32_bf16 v217, v34, s94, v208 neg_lo:[0,0,1]
v_dot2_f32_bf16 v218, v35, s93, v208 neg_lo:[0,0,1]
v_dot2_f32_bf16 v219, v35, s94, v208 neg_lo:[0,0,1]
v_cvt_pk_bf16_f32 v32, v212, v213
v_cvt_pk_bf16_f32 v33, v214, v215
s_add_u32 m0, s72, 0
s_nop 0
buffer_load_dwordx4 v2, s[28:31], s50 offen offset:2048 lds
v_dot2_f32_bf16 v212, v36, s93, v208 neg_lo:[0,0,1]
v_dot2_f32_bf16 v213, v36, s94, v208 neg_lo:[0,0,1]
v_dot2_f32_bf16 v214, v37, s93, v208 neg_lo:[0,0,1]
v_dot2_f32_bf16 v215, v37, s94, v208 neg_lo:[0,0,1]
v_cvt_pk_bf16_f32 v34, v216, v217
v_cvt_pk_bf16_f32 v35, v218, v219
v_dot2_f32_bf16 v216, v38, s93, v208 neg_lo:[0,0,1]
v_dot2_f32_bf16 v217, v38, s94, v208 neg_lo:[0,0,1]
v_dot2_f32_bf16 v218, v39, s93, v208 neg_lo:[0,0,1]
v_dot2_f32_bf16 v219, v39, s94, v208 neg_lo:[0,0,1]
v_cvt_pk_bf16_f32 v36, v212, v213
v_cvt_pk_bf16_f32 v37, v214, v215
v_dot2_f32_bf16 v212, v40, s93, v208 neg_lo:[0,0,1]
v_dot2_f32_bf16 v213, v40, s94, v208 neg_lo:[0,0,1]
v_dot2_f32_bf16 v214, v41, s93, v208 neg_lo:[0,0,1]
v_dot2_f32_bf16 v215, v41, s94, v208 neg_lo:[0,0,1]
v_cvt_pk_bf16_f32 v38, v216, v217
v_cvt_pk_bf16_f32 v39, v218, v219
v_dot2_f32_bf16 v216, v42, s93, v208 neg_lo:[0,0,1]
v_dot2_f32_bf16 v217, v42, s94, v208 neg_lo:[0,0,1]
v_dot2_f32_bf16 v218, v43, s93, v208 neg_lo:[0,0,1]
v_dot2_f32_bf16 v219, v43, s94, v208 neg_lo:[0,0,1]
v_cvt_pk_bf16_f32 v40, v212, v213
v_cvt_pk_bf16_f32 v41, v214, v215
v_dot2_f32_bf16 v212, v44, s93, v208 neg_lo:[0,0,1]
v_dot2_f32_bf16 v213, v44, s94, v208 neg_lo:[0,0,1]
v_dot2_f32_bf16 v214, v45, s93, v208 neg_lo:[0,0,1]
v_dot2_f32_bf16 v215, v45, s94, v208 neg_lo:[0,0,1]
v_cvt_pk_bf16_f32 v42, v216, v217
v_cvt_pk_bf16_f32 v43, v218, v219
s_add_u32 m0, s72, 0
s_nop 0
buffer_load_dwordx4 v2, s[28:31], s51 offen offset:3072 lds
v_dot2_f32_bf16 v216, v46, s93, v208 neg_lo:[0,0,1]
v_dot2_f32_bf16 v217, v46, s94, v208 neg_lo:[0,0,1]
v_dot2_f32_bf16 v218, v47, s93, v208 neg_lo:[0,0,1]
v_dot2_f32_bf16 v219, v47, s94, v208 neg_lo:[0,0,1]
v_cvt_pk_bf16_f32 v44, v212, v213
v_cvt_pk_bf16_f32 v45, v214, v215
v_dot2_f32_bf16 v212, v48, s93, v208 neg_lo:[0,0,1]
v_dot2_f32_bf16 v213, v48, s94, v208 neg_lo:[0,0,1]
v_dot2_f32_bf16 v214, v49, s93, v208 neg_lo:[0,0,1]
v_dot2_f32_bf16 v215, v49, s94, v208 neg_lo:[0,0,1]
v_cvt_pk_bf16_f32 v46, v216, v217
v_cvt_pk_bf16_f32 v47, v218, v219
v_dot2_f32_bf16 v216, v50, s93, v208 neg_lo:[0,0,1]
v_dot2_f32_bf16 v217, v50, s94, v208 neg_lo:[0,0,1]
v_dot2_f32_bf16 v218, v51, s93, v208 neg_lo:[0,0,1]
v_dot2_f32_bf16 v219, v51, s94, v208 neg_lo:[0,0,1]
v_cvt_pk_bf16_f32 v48, v212, v213
v_cvt_pk_bf16_f32 v49, v214, v215
v_dot2_f32_bf16 v212, v52, s93, v208 neg_lo:[0,0,1]
v_dot2_f32_bf16 v213, v52, s94, v208 neg_lo:[0,0,1]
v_dot2_f32_bf16 v214, v53, s93, v208 neg_lo:[0,0,1]
v_dot2_f32_bf16 v215, v53, s94, v208 neg_lo:[0,0,1]
v_cvt_pk_bf16_f32 v50, v216, v217
v_cvt_pk_bf16_f32 v51, v218, v219
v_dot2_f32_bf16 v216, v54, s93, v208 neg_lo:[0,0,1]
v_dot2_f32_bf16 v217, v54, s94, v208 neg_lo:[0,0,1]
v_dot2_f32_bf16 v218, v55, s93, v208 neg_lo:[0,0,1]
v_dot2_f32_bf16 v219, v55, s94, v208 neg_lo:[0,0,1]
v_cvt_pk_bf16_f32 v52, v212, v213
v_cvt_pk_bf16_f32 v53, v214, v215
s_add_u32 m0, s72, 4096
s_nop 0
buffer_load_dwordx4 v2, s[28:31], s52 offen offset:0 lds
s_nop 0
v_dot2_f32_bf16 v212, v56, s93, v208 neg_lo:[0,0,1]
v_dot2_f32_bf16 v213, v56, s94, v208 neg_lo:[0,0,1]
v_dot2_f32_bf16 v214, v57, s93, v208 neg_lo:[0,0,1]
v_dot2_f32_bf16 v215, v57, s94, v208 neg_lo:[0,0,1]
v_cvt_pk_bf16_f32 v54, v216, v217
v_cvt_pk_bf16_f32 v55, v218, v219
v_dot2_f32_bf16 v216, v58, s93, v208 neg_lo:[0,0,1]
v_dot2_f32_bf16 v217, v58, s94, v208 neg_lo:[0,0,1]
v_dot2_f32_bf16 v218, v59, s93, v208 neg_lo:[0,0,1]
v_dot2_f32_bf16 v219, v59, s94, v208 neg_lo:[0,0,1]
v_cvt_pk_bf16_f32 v56, v212, v213
v_cvt_pk_bf16_f32 v57, v214, v215
v_dot2_f32_bf16 v212, v60, s93, v208 neg_lo:[0,0,1]
v_dot2_f32_bf16 v213, v60, s94, v208 neg_lo:[0,0,1]
v_dot2_f32_bf16 v214, v61, s93, v208 neg_lo:[0,0,1]
v_dot2_f32_bf16 v215, v61, s94, v208 neg_lo:[0,0,1]
v_cvt_pk_bf16_f32 v58, v216, v217
v_cvt_pk_bf16_f32 v59, v218, v219
v_dot2_f32_bf16 v216, v62, s93, v208 neg_lo:[0,0,1]
v_dot2_f32_bf16 v217, v62, s94, v208 neg_lo:[0,0,1]
v_dot2_f32_bf16 v218, v63, s93, v208 neg_lo:[0,0,1]
v_dot2_f32_bf16 v219, v63, s94, v208 neg_lo:[0,0,1]
v_cvt_pk_bf16_f32 v60, v212, v213
v_cvt_pk_bf16_f32 v61, v214, v215
s_add_u32 m0, s72, 4096
s_nop 0
buffer_load_dwordx4 v2, s[28:31], s53 offen offset:1024 lds
s_nop 0
v_dot2_f32_bf16 v212, v64, s93, v208 neg_lo:[0,0,1]
v_dot2_f32_bf16 v213, v64, s94, v208 neg_lo:[0,0,1]
v_dot2_f32_bf16 v214, v65, s93, v208 neg_lo:[0,0,1]
v_dot2_f32_bf16 v215, v65, s94, v208 neg_lo:[0,0,1]
v_cvt_pk_bf16_f32 v62, v216, v217
v_cvt_pk_bf16_f32 v63, v218, v219
v_dot2_f32_bf16 v216, v66, s93, v208 neg_lo:[0,0,1]
v_dot2_f32_bf16 v217, v66, s94, v208 neg_lo:[0,0,1]
v_dot2_f32_bf16 v218, v67, s93, v208 neg_lo:[0,0,1]
v_dot2_f32_bf16 v219, v67, s94, v208 neg_lo:[0,0,1]
v_cvt_pk_bf16_f32 v64, v212, v213
v_cvt_pk_bf16_f32 v65, v214, v215
v_dot2_f32_bf16 v212, v68, s93, v208 neg_lo:[0,0,1]
v_dot2_f32_bf16 v213, v68, s94, v208 neg_lo:[0,0,1]
v_dot2_f32_bf16 v214, v69, s93, v208 neg_lo:[0,0,1]
v_dot2_f32_bf16 v215, v69, s94, v208 neg_lo:[0,0,1]
v_cvt_pk_bf16_f32 v66, v216, v217
v_cvt_pk_bf16_f32 v67, v218, v219
v_dot2_f32_bf16 v216, v70, s93, v208 neg_lo:[0,0,1]
v_dot2_f32_bf16 v217, v70, s94, v208 neg_lo:[0,0,1]
v_dot2_f32_bf16 v218, v71, s93, v208 neg_lo:[0,0,1]
v_dot2_f32_bf16 v219, v71, s94, v208 neg_lo:[0,0,1]
v_cvt_pk_bf16_f32 v68, v212, v213
v_cvt_pk_bf16_f32 v69, v214, v215
v_dot2_f32_bf16 v212, v72, s93, v208 neg_lo:[0,0,1]
v_dot2_f32_bf16 v213, v72, s94, v208 neg_lo:[0,0,1]
v_dot2_f32_bf16 v214, v73, s93, v208 neg_lo:[0,0,1]
v_dot2_f32_bf16 v215, v73, s94, v208 neg_lo:[0,0,1]
v_cvt_pk_bf16_f32 v70, v216, v217
v_cvt_pk_bf16_f32 v71, v218, v219
s_add_u32 m0, s72, 4096
s_nop 0
buffer_load_dwordx4 v2, s[28:31], s54 offen offset:2048 lds
s_nop 0
v_dot2_f32_bf16 v216, v74, s93, v208 neg_lo:[0,0,1]
v_dot2_f32_bf16 v217, v74, s94, v208 neg_lo:[0,0,1]
v_dot2_f32_bf16 v218, v75, s93, v208 neg_lo:[0,0,1]
v_dot2_f32_bf16 v219, v75, s94, v208 neg_lo:[0,0,1]
v_cvt_pk_bf16_f32 v72, v212, v213
v_cvt_pk_bf16_f32 v73, v214, v215
v_dot2_f32_bf16 v212, v76, s93, v208 neg_lo:[0,0,1]
v_dot2_f32_bf16 v213, v76, s94, v208 neg_lo:[0,0,1]
v_dot2_f32_bf16 v214, v77, s93, v208 neg_lo:[0,0,1]
v_dot2_f32_bf16 v215, v77, s94, v208 neg_lo:[0,0,1]
v_cvt_pk_bf16_f32 v74, v216, v217
v_cvt_pk_bf16_f32 v75, v218, v219
v_dot2_f32_bf16 v216, v78, s93, v208 neg_lo:[0,0,1]
v_dot2_f32_bf16 v217, v78, s94, v208 neg_lo:[0,0,1]
v_dot2_f32_bf16 v218, v79, s93, v208 neg_lo:[0,0,1]
v_dot2_f32_bf16 v219, v79, s94, v208 neg_lo:[0,0,1]
v_cvt_pk_bf16_f32 v76, v212, v213
v_cvt_pk_bf16_f32 v77, v214, v215
v_dot2_f32_bf16 v212, v80, s93, v208 neg_lo:[0,0,1]
v_dot2_f32_bf16 v213, v80, s94, v208 neg_lo:[0,0,1]
v_dot2_f32_bf16 v214, v81, s93, v208 neg_lo:[0,0,1]
v_dot2_f32_bf16 v215, v81, s94, v208 neg_lo:[0,0,1]
v_cvt_pk_bf16_f32 v78, v216, v217
v_cvt_pk_bf16_f32 v79, v218, v219
v_dot2_f32_bf16 v216, v82, s93, v208 neg_lo:[0,0,1]
v_dot2_f32_bf16 v217, v82, s94, v208 neg_lo:[0,0,1]
v_dot2_f32_bf16 v218, v83, s93, v208 neg_lo:[0,0,1]
v_dot2_f32_bf16 v219, v83, s94, v208 neg_lo:[0,0,1]
v_cvt_pk_bf16_f32 v80, v212, v213
v_cvt_pk_bf16_f32 v81, v214, v215
v_add_u32 v2, s67, v6
s_add_u32 m0, s72, 28672
s_nop 0
buffer_load_dwordx4 v2, s[28:31], s48 offen offset:0 lds
v_dot2_f32_bf16 v212, v84, s93, v208 neg_lo:[0,0,1]
v_dot2_f32_bf16 v213, v84, s94, v208 neg_lo:[0,0,1]
v_dot2_f32_bf16 v214, v85, s93, v208 neg_lo:[0,0,1]
v_dot2_f32_bf16 v215, v85, s94, v208 neg_lo:[0,0,1]
v_cvt_pk_bf16_f32 v82, v216, v217
v_cvt_pk_bf16_f32 v83, v218, v219
v_dot2_f32_bf16 v216, v86, s93, v208 neg_lo:[0,0,1]
v_dot2_f32_bf16 v217, v86, s94, v208 neg_lo:[0,0,1]
v_dot2_f32_bf16 v218, v87, s93, v208 neg_lo:[0,0,1]
v_dot2_f32_bf16 v219, v87, s94, v208 neg_lo:[0,0,1]
v_cvt_pk_bf16_f32 v84, v212, v213
v_cvt_pk_bf16_f32 v85, v214, v215
v_dot2_f32_bf16 v212, v88, s93, v208 neg_lo:[0,0,1]
v_dot2_f32_bf16 v213, v88, s94, v208 neg_lo:[0,0,1]
v_dot2_f32_bf16 v214, v89, s93, v208 neg_lo:[0,0,1]
v_dot2_f32_bf16 v215, v89, s94, v208 neg_lo:[0,0,1]
v_cvt_pk_bf16_f32 v86, v216, v217
v_cvt_pk_bf16_f32 v87, v218, v219
v_dot2_f32_bf16 v216, v90, s93, v208 neg_lo:[0,0,1]
v_dot2_f32_bf16 v217, v90, s94, v208 neg_lo:[0,0,1]
v_dot2_f32_bf16 v218, v91, s93, v208 neg_lo:[0,0,1]
v_dot2_f32_bf16 v219, v91, s94, v208 neg_lo:[0,0,1]
v_cvt_pk_bf16_f32 v88, v212, v213
v_cvt_pk_bf16_f32 v89, v214, v215
v_dot2_f32_bf16 v212, v92, s93, v208 neg_lo:[0,0,1]
v_dot2_f32_bf16 v213, v92, s94, v208 neg_lo:[0,0,1]
v_dot2_f32_bf16 v214, v93, s93, v208 neg_lo:[0,0,1]
v_dot2_f32_bf16 v215, v93, s94, v208 neg_lo:[0,0,1]
v_cvt_pk_bf16_f32 v90, v216, v217
v_cvt_pk_bf16_f32 v91, v218, v219
s_add_u32 m0, s72, 28672
s_nop 0
buffer_load_dwordx4 v2, s[28:31], s49 offen offset:1024 lds
s_nop 0
v_dot2_f32_bf16 v216, v94, s93, v208 neg_lo:[0,0,1]
v_dot2_f32_bf16 v217, v94, s94, v208 neg_lo:[0,0,1]
v_dot2_f32_bf16 v218, v95, s93, v208 neg_lo:[0,0,1]
v_dot2_f32_bf16 v219, v95, s94, v208 neg_lo:[0,0,1]
v_cvt_pk_bf16_f32 v92, v212, v213
v_cvt_pk_bf16_f32 v93, v214, v215
v_dot2_f32_bf16 v212, v96, s93, v208 neg_lo:[0,0,1]
v_dot2_f32_bf16 v213, v96, s94, v208 neg_lo:[0,0,1]
v_dot2_f32_bf16 v214, v97, s93, v208 neg_lo:[0,0,1]
v_dot2_f32_bf16 v215, v97, s94, v208 neg_lo:[0,0,1]
v_cvt_pk_bf16_f32 v94, v216, v217
v_cvt_pk_bf16_f32 v95, v218, v219
v_dot2_f32_bf16 v216, v98, s93, v208 neg_lo:[0,0,1]
v_dot2_f32_bf16 v217, v98, s94, v208 neg_lo:[0,0,1]
v_dot2_f32_bf16 v218, v99, s93, v208 neg_lo:[0,0,1]
v_dot2_f32_bf16 v219, v99, s94, v208 neg_lo:[0,0,1]
v_cvt_pk_bf16_f32 v96, v212, v213
v_cvt_pk_bf16_f32 v97, v214, v215
v_dot2_f32_bf16 v212, v100, s93, v208 neg_lo:[0,0,1]
v_dot2_f32_bf16 v213, v100, s94, v208 neg_lo:[0,0,1]
v_dot2_f32_bf16 v214, v101, s93, v208 neg_lo:[0,0,1]
v_dot2_f32_bf16 v215, v101, s94, v208 neg_lo:[0,0,1]
v_cvt_pk_bf16_f32 v98, v216, v217
v_cvt_pk_bf16_f32 v99, v218, v219
s_add_u32 m0, s72, 28672
s_nop 0
buffer_load_dwordx4 v2, s[28:31], s50 offen offset:2048 lds
s_nop 0
v_dot2_f32_bf16 v216, v102, s93, v208 neg_lo:[0,0,1]
v_dot2_f32_bf16 v217, v102, s94, v208 neg_lo:[0,0,1]
v_dot2_f32_bf16 v218, v103, s93, v208 neg_lo:[0,0,1]
v_dot2_f32_bf16 v219, v103, s94, v208 neg_lo:[0,0,1]
v_cvt_pk_bf16_f32 v100, v212, v213
v_cvt_pk_bf16_f32 v101, v214, v215
v_dot2_f32_bf16 v212, v104, s93, v208 neg_lo:[0,0,1]
v_dot2_f32_bf16 v213, v104, s94, v208 neg_lo:[0,0,1]
v_dot2_f32_bf16 v214, v105, s93, v208 neg_lo:[0,0,1]
v_dot2_f32_bf16 v215, v105, s94, v208 neg_lo:[0,0,1]
v_cvt_pk_bf16_f32 v102, v216, v217
v_cvt_pk_bf16_f32 v103, v218, v219
v_dot2_f32_bf16 v216, v106, s93, v208 neg_lo:[0,0,1]
v_dot2_f32_bf16 v217, v106, s94, v208 neg_lo:[0,0,1]
v_dot2_f32_bf16 v218, v107, s93, v208 neg_lo:[0,0,1]
v_dot2_f32_bf16 v219, v107, s94, v208 neg_lo:[0,0,1]
v_cvt_pk_bf16_f32 v104, v212, v213
v_cvt_pk_bf16_f32 v105, v214, v215
v_dot2_f32_bf16 v212, v108, s93, v208 neg_lo:[0,0,1]
v_dot2_f32_bf16 v213, v108, s94, v208 neg_lo:[0,0,1]
v_dot2_f32_bf16 v214, v109, s93, v208 neg_lo:[0,0,1]
v_dot2_f32_bf16 v215, v109, s94, v208 neg_lo:[0,0,1]
v_cvt_pk_bf16_f32 v106, v216, v217
v_cvt_pk_bf16_f32 v107, v218, v219
v_dot2_f32_bf16 v216, v110, s93, v208 neg_lo:[0,0,1]
v_dot2_f32_bf16 v217, v110, s94, v208 neg_lo:[0,0,1]
v_dot2_f32_bf16 v218, v111, s93, v208 neg_lo:[0,0,1]
v_dot2_f32_bf16 v219, v111, s94, v208 neg_lo:[0,0,1]
v_cvt_pk_bf16_f32 v108, v212, v213
v_cvt_pk_bf16_f32 v109, v214, v215
s_add_u32 m0, s72, 28672
s_nop 0
buffer_load_dwordx4 v2, s[28:31], s51 offen offset:3072 lds
s_nop 0
v_dot2_f32_bf16 v212, v112, s93, v208 neg_lo:[0,0,1]
v_dot2_f32_bf16 v213, v112, s94, v208 neg_lo:[0,0,1]
v_dot2_f32_bf16 v214, v113, s93, v208 neg_lo:[0,0,1]
v_dot2_f32_bf16 v215, v113, s94, v208 neg_lo:[0,0,1]
v_cvt_pk_bf16_f32 v110, v216, v217
v_cvt_pk_bf16_f32 v111, v218, v219
v_dot2_f32_bf16 v216, v114, s93, v208 neg_lo:[0,0,1]
v_dot2_f32_bf16 v217, v114, s94, v208 neg_lo:[0,0,1]
v_dot2_f32_bf16 v218, v115, s93, v208 neg_lo:[0,0,1]
v_dot2_f32_bf16 v219, v115, s94, v208 neg_lo:[0,0,1]
v_cvt_pk_bf16_f32 v112, v212, v213
v_cvt_pk_bf16_f32 v113, v214, v215
v_dot2_f32_bf16 v212, v116, s93, v208 neg_lo:[0,0,1]
v_dot2_f32_bf16 v213, v116, s94, v208 neg_lo:[0,0,1]
v_dot2_f32_bf16 v214, v117, s93, v208 neg_lo:[0,0,1]
v_dot2_f32_bf16 v215, v117, s94, v208 neg_lo:[0,0,1]
v_cvt_pk_bf16_f32 v114, v216, v217
v_cvt_pk_bf16_f32 v115, v218, v219
v_dot2_f32_bf16 v216, v118, s93, v208 neg_lo:[0,0,1]
v_dot2_f32_bf16 v217, v118, s94, v208 neg_lo:[0,0,1]
v_dot2_f32_bf16 v218, v119, s93, v208 neg_lo:[0,0,1]
v_dot2_f32_bf16 v219, v119, s94, v208 neg_lo:[0,0,1]
v_cvt_pk_bf16_f32 v116, v212, v213
v_cvt_pk_bf16_f32 v117, v214, v215
v_dot2_f32_bf16 v212, v120, s93, v208 neg_lo:[0,0,1]
v_dot2_f32_bf16 v213, v120, s94, v208 neg_lo:[0,0,1]
v_dot2_f32_bf16 v214, v121, s93, v208 neg_lo:[0,0,1]
v_dot2_f32_bf16 v215, v121, s94, v208 neg_lo:[0,0,1]
v_cvt_pk_bf16_f32 v118, v216, v217
v_cvt_pk_bf16_f32 v119, v218, v219
s_add_u32 m0, s72, 32768
s_nop 0
buffer_load_dwordx4 v2, s[28:31], s52 offen offset:0 lds
s_nop 0
v_dot2_f32_bf16 v216, v122, s93, v208 neg_lo:[0,0,1]
v_dot2_f32_bf16 v217, v122, s94, v208 neg_lo:[0,0,1]
v_dot2_f32_bf16 v218, v123, s93, v208 neg_lo:[0,0,1]
v_dot2_f32_bf16 v219, v123, s94, v208 neg_lo:[0,0,1]
v_cvt_pk_bf16_f32 v120, v212, v213
v_cvt_pk_bf16_f32 v121, v214, v215
v_dot2_f32_bf16 v212, v124, s93, v208 neg_lo:[0,0,1]
v_dot2_f32_bf16 v213, v124, s94, v208 neg_lo:[0,0,1]
v_dot2_f32_bf16 v214, v125, s93, v208 neg_lo:[0,0,1]
v_dot2_f32_bf16 v215, v125, s94, v208 neg_lo:[0,0,1]
v_cvt_pk_bf16_f32 v122, v216, v217
v_cvt_pk_bf16_f32 v123, v218, v219
v_dot2_f32_bf16 v216, v126, s93, v208 neg_lo:[0,0,1]
v_dot2_f32_bf16 v217, v126, s94, v208 neg_lo:[0,0,1]
v_dot2_f32_bf16 v218, v127, s93, v208 neg_lo:[0,0,1]
v_dot2_f32_bf16 v219, v127, s94, v208 neg_lo:[0,0,1]
v_cvt_pk_bf16_f32 v124, v212, v213
v_cvt_pk_bf16_f32 v125, v214, v215
v_cvt_pk_bf16_f32 v126, v216, v217
v_cvt_pk_bf16_f32 v127, v218, v219
s_mov_b32 s93, s98
s_waitcnt vmcnt(5)
s_barrier
ds_read_b64_tr_b16 a[0:1], v8 offset:0
ds_read_b64_tr_b16 a[2:3], v8 offset:256
ds_read_b64_tr_b16 a[4:5], v8 offset:7168
ds_read_b64_tr_b16 a[6:7], v8 offset:7424
ds_read_b64_tr_b16 a[8:9], v8 offset:1024
ds_read_b64_tr_b16 a[10:11], v8 offset:1280
ds_read_b64_tr_b16 a[12:13], v8 offset:8192
ds_read_b64_tr_b16 a[14:15], v8 offset:8448
ds_read_b64_tr_b16 a[16:17], v8 offset:2048
ds_read_b64_tr_b16 a[18:19], v8 offset:2304
ds_read_b64_tr_b16 a[20:21], v8 offset:9216
ds_read_b64_tr_b16 a[22:23], v8 offset:9472
s_waitcnt lgkmcnt(4)
v_mfma_f32_32x32x16_bf16 v[160:175], v[16:19], a[0:3], 0
ds_read_b64_tr_b16 a[24:25], v8 offset:3072
ds_read_b64_tr_b16 a[26:27], v8 offset:3328
s_add_u32 m0, s72, 32768
v_mfma_f32_32x32x16_bf16 v[176:191], v[16:19], a[4:7], 0
ds_read_b64_tr_b16 a[28:29], v8 offset:10240
ds_read_b64_tr_b16 a[30:31], v8 offset:10496
buffer_load_dwordx4 v2, s[28:31], s53 offen offset:1024 lds
v_mfma_f32_32x32x16_bf16 v[160:175], v[20:23], a[8:11], v[160:175]
ds_read_b64_tr_b16 a[0:1], v8 offset:4096
ds_read_b64_tr_b16 a[2:3], v8 offset:4352
s_mov_b32 s88, 0x10000000
s_mov_b32 s89, 0x10000000
v_mfma_f32_32x32x16_bf16 v[176:191], v[20:23], a[12:15], v[176:191]
ds_read_b64_tr_b16 a[4:5], v8 offset:11264
ds_read_b64_tr_b16 a[6:7], v8 offset:11520
buffer_load_dwordx4 v2, s[28:31], s54 offen offset:2048 lds
s_mov_b32 s90, 0
s_waitcnt lgkmcnt(4)
v_mfma_f32_32x32x16_bf16 v[160:175], v[24:27], a[16:19], v[160:175]
ds_read_b64_tr_b16 a[8:9], v8 offset:5120
ds_read_b64_tr_b16 a[10:11], v8 offset:5376
s_mov_b32 s91, -1
s_add_u32 s11, s83, s78
v_mfma_f32_32x32x16_bf16 v[176:191], v[24:27], a[20:23], v[176:191]
ds_read_b64_tr_b16 a[12:13], v8 offset:12288
ds_read_b64_tr_b16 a[14:15], v8 offset:12544
s_add_u32 s99, s11, 0
v_add_u32 v2, s62, v3
s_add_u32 m0, s72, 57344
v_mfma_f32_32x32x16_bf16 v[160:175], v[28:31], a[24:27], v[160:175]
ds_read_b64_tr_b16 a[16:17], v8 offset:6144
ds_read_b64_tr_b16 a[18:19], v8 offset:6400
buffer_load_dwordx4 v2, s[32:35], s55 offen offset:0 lds
s_and_b32 s99, s99, 1
v_mfma_f32_32x32x16_bf16 v[176:191], v[28:31], a[28:31], v[176:191]
ds_read_b64_tr_b16 a[20:21], v8 offset:13312
ds_read_b64_tr_b16 a[22:23], v8 offset:13568
buffer_load_dwordx4 v2, s[32:35], s56 offen offset:1024 lds
s_mul_i32 s101, s99, 86016
s_lshl_b32 s92, s10, 1
s_waitcnt lgkmcnt(4)
v_mfma_f32_32x32x16_bf16 v[160:175], v[32:35], a[0:3], v[160:175]
ds_read_b64_tr_b16 a[24:25], v8 offset:14336
ds_read_b64_tr_b16 a[26:27], v8 offset:14592
s_add_u32 s99, s99, s92
v_mfma_f32_32x32x16_bf16 v[176:191], v[32:35], a[4:7], v[176:191]
ds_read_b64_tr_b16 a[28:29], v8 offset:21504
ds_read_b64_tr_b16 a[30:31], v8 offset:21760
buffer_load_dwordx4 v2, s[32:35], s57 offen offset:2048 lds
s_mul_i32 s92, s99, 200704
v_mfma_f32_32x32x16_bf16 v[160:175], v[36:39], a[8:11], v[160:175]
ds_read_b64_tr_b16 a[0:1], v8 offset:15360
ds_read_b64_tr_b16 a[2:3], v8 offset:15616
s_add_u32 s12, s92, s101
s_sub_u32 s14, s92, s101
s_mov_b32 s28, s16
s_and_b32 s29, s17, 0xffff
s_mov_b32 s30, 1605632
s_mul_i32 s94, s93, 3136
v_lshlrev_b32 v231, 3, v1
s_mov_b64 exec, 0x1ffffff
buffer_load_dword a255, v231, s[28:31], s94 offen
s_mov_b64 exec, -1
s_mul_i32 s30, s77, 1605632
v_mfma_f32_32x32x16_bf16 v[176:191], v[36:39], a[12:15], v[176:191]
ds_read_b64_tr_b16 a[4:5], v8 offset:22528
ds_read_b64_tr_b16 a[6:7], v8 offset:22784
buffer_load_dwordx4 v2, s[32:35], s58 offen offset:3072 lds
s_sub_u32 s20, s14, s101
s_waitcnt lgkmcnt(4)
v_mfma_f32_32x32x16_bf16 v[160:175], v[40:43], a[16:19], v[160:175]
ds_read_b64_tr_b16 a[8:9], v8 offset:16384
ds_read_b64_tr_b16 a[10:11], v8 offset:16640
s_add_u32 s14, s14, 114688
s_add_u32 m0, s72, 61440
v_mfma_f32_32x32x16_bf16 v[176:191], v[40:43], a[20:23], v[176:191]
ds_read_b64_tr_b16 a[12:13], v8 offset:23552
ds_read_b64_tr_b16 a[14:15], v8 offset:23808
buffer_load_dwordx4 v2, s[32:35], s59 offen offset:0 lds
s_add_u32 s20, s20, 172032
s_mul_i32 s22, s99, 50176
v_mfma_f32_32x32x16_bf16 v[160:175], v[44:47], a[24:27], v[160:175]
ds_read_b64_tr_b16 a[16:17], v8 offset:17408
ds_read_b64_tr_b16 a[18:19], v8 offset:17664
s_lshl_b32 s4, s83, 4
v_mfma_f32_32x32x16_bf16 v[176:191], v[44:47], a[28:31], v[176:191]
ds_read_b64_tr_b16 a[20:21], v8 offset:24576
ds_read_b64_tr_b16 a[22:23], v8 offset:24832
buffer_load_dwordx4 v2, s[32:35], s60 offen offset:1024 lds
s_add_u32 s4, s4, s99
s_mul_i32 s4, s4, 18432
s_waitcnt lgkmcnt(4)
v_mfma_f32_32x32x16_bf16 v[160:175], v[48:51], a[0:3], v[160:175]
ds_read_b64_tr_b16 a[24:25], v8 offset:18432
ds_read_b64_tr_b16 a[26:27], v8 offset:18688
s_add_u32 s99, s11, 1
v_mfma_f32_32x32x16_bf16 v[176:191], v[48:51], a[4:7], v[176:191]
ds_read_b64_tr_b16 a[28:29], v8 offset:25600
ds_read_b64_tr_b16 a[30:31], v8 offset:25856
buffer_load_dwordx4 v2, s[32:35], s61 offen offset:2048 lds
s_and_b32 s99, s99, 1
v_mfma_f32_32x32x16_bf16 v[160:175], v[52:55], a[8:11], v[160:175]
ds_read_b64_tr_b16 a[0:1], v8 offset:19456
ds_read_b64_tr_b16 a[2:3], v8 offset:19712
buffer_load_dword v227, off, s[44:47], 0 offset:128 sc1
s_mul_i32 s101, s99, 86016
s_lshl_b32 s92, s10, 1
v_mfma_f32_32x32x16_bf16 v[176:191], v[52:55], a[12:15], v[176:191]
ds_read_b64_tr_b16 a[4:5], v8 offset:26624
ds_read_b64_tr_b16 a[6:7], v8 offset:26880
s_add_u32 s99, s99, s92
v_add_u32 v2, s63, v3
s_add_u32 m0, s72, 86016
s_waitcnt lgkmcnt(4)
v_mfma_f32_32x32x16_bf16 v[160:175], v[56:59], a[16:19], v[160:175]
ds_read_b64_tr_b16 a[8:9], v8 offset:20480
ds_read_b64_tr_b16 a[10:11], v8 offset:20736
buffer_load_dwordx4 v2, s[32:35], s55 offen offset:0 lds
s_mul_i32 s92, s99, 200704
v_mfma_f32_32x32x16_bf16 v[176:191], v[56:59], a[20:23], v[176:191]
ds_read_b64_tr_b16 a[12:13], v8 offset:27648
ds_read_b64_tr_b16 a[14:15], v8 offset:27904
s_add_u32 s13, s92, s101
s_sub_u32 s15, s92, s101
v_mfma_f32_32x32x16_bf16 v[160:175], v[60:63], a[24:27], v[160:175]
s_waitcnt vmcnt(10) lgkmcnt(0)
s_barrier
ds_read_b64_tr_b16 a[16:17], v8 offset:28672
ds_read_b64_tr_b16 a[18:19], v8 offset:28928
buffer_load_dwordx4 v2, s[32:35], s56 offen offset:1024 lds
s_sub_u32 s21, s15, s101
v_mfma_f32_32x32x16_bf16 v[176:191], v[60:63], a[28:31], v[176:191]
ds_read_b64_tr_b16 a[20:21], v8 offset:35840
ds_read_b64_tr_b16 a[22:23], v8 offset:36096
s_add_u32 s15, s15, 114688
v_mfma_f32_32x32x16_bf16 v[160:175], v[64:67], a[0:3], v[160:175]
ds_read_b64_tr_b16 a[24:25], v8 offset:29696
ds_read_b64_tr_b16 a[26:27], v8 offset:29952
v_mov_b32 v248, -1
s_add_u32 s21, s21, 172032
s_mul_i32 s23, s99, 50176
v_mfma_f32_32x32x16_bf16 v[176:191], v[64:67], a[4:7], v[176:191]
ds_read_b64_tr_b16 a[28:29], v8 offset:36864
ds_read_b64_tr_b16 a[30:31], v8 offset:37120
buffer_load_dwordx4 v2, s[32:35], s57 offen offset:2048 lds
s_lshl_b32 s5, s83, 4
v_mfma_f32_32x32x16_bf16 v[160:175], v[68:71], a[8:11], v[160:175]
ds_read_b64_tr_b16 a[0:1], v8 offset:30720
ds_read_b64_tr_b16 a[2:3], v8 offset:30976
s_add_u32 s5, s5, s99
s_mul_i32 s5, s5, 18432
v_mfma_f32_32x32x16_bf16 v[176:191], v[68:71], a[12:15], v[176:191]
ds_read_b64_tr_b16 a[4:5], v8 offset:37888
ds_read_b64_tr_b16 a[6:7], v8 offset:38144
s_lshl_b32 s11, s80, 2
s_waitcnt lgkmcnt(4)
v_mfma_f32_32x32x16_bf16 v[160:175], v[72:75], a[16:19], v[160:175]
ds_read_b64_tr_b16 a[8:9], v8 offset:31744
ds_read_b64_tr_b16 a[10:11], v8 offset:32000
buffer_load_dwordx4 v2, s[32:35], s58 offen offset:3072 lds
v_mov_b32 v249, -1
s_cmp_eq_u32 s82, 0
s_cselect_b32 s48, s55, s48
s_cselect_b32 s49, s56, s49
s_cselect_b32 s50, s57, s50
s_cselect_b32 s51, s58, s51
s_cselect_b32 s52, s59, s52
s_cselect_b32 s53, s60, s53
s_cselect_b32 s54, s61, s54
s_add_u32 s11, s11, s10
v_mfma_f32_32x32x16_bf16 v[176:191], v[72:75], a[20:23], v[176:191]
ds_read_b64_tr_b16 a[12:13], v8 offset:38912
ds_read_b64_tr_b16 a[14:15], v8 offset:39168
s_lshr_b32 s92, s11, 1
s_lshl_b32 s92, s92, 2
s_add_u32 m0, s72, 90112
v_mfma_f32_32x32x16_bf16 v[160:175], v[76:79], a[24:27], v[160:175]
ds_read_b64_tr_b16 a[16:17], v8 offset:32768
ds_read_b64_tr_b16 a[18:19], v8 offset:33024
buffer_load_dwordx4 v2, s[32:35], s59 offen offset:0 lds
v_mov_b32 v6, v7
v_add_u32 v7, 6144, v7
s_lshr_b32 s101, s81, 2
v_mfma_f32_32x32x16_bf16 v[176:191], v[76:79], a[28:31], v[176:191]
ds_read_b64_tr_b16 a[20:21], v8 offset:39936
ds_read_b64_tr_b16 a[22:23], v8 offset:40192
s_add_u32 s92, s92, s101
s_waitcnt lgkmcnt(4)
v_mfma_f32_32x32x16_bf16 v[160:175], v[80:83], a[0:3], v[160:175]
ds_read_b64_tr_b16 a[24:25], v8 offset:33792
ds_read_b64_tr_b16 a[26:27], v8 offset:34048
v_mov_b32 v250, -1
s_lshl_b32 s84, s92, 7
s_and_b32 s11, s11, 1
v_mfma_f32_32x32x16_bf16 v[176:191], v[80:83], a[4:7], v[176:191]
ds_read_b64_tr_b16 a[28:29], v8 offset:40960
ds_read_b64_tr_b16 a[30:31], v8 offset:41216
buffer_load_dwordx4 v2, s[32:35], s60 offen offset:1024 lds
s_lshl_b32 s11, s11, 2
v_mfma_f32_32x32x16_bf16 v[160:175], v[84:87], a[8:11], v[160:175]
ds_read_b64_tr_b16 a[0:1], v8 offset:34816
ds_read_b64_tr_b16 a[2:3], v8 offset:35072
s_and_b32 s101, s81, 3
v_mfma_f32_32x32x16_bf16 v[176:191], v[84:87], a[12:15], v[176:191]
ds_read_b64_tr_b16 a[4:5], v8 offset:41984
ds_read_b64_tr_b16 a[6:7], v8 offset:42240
s_add_u32 s11, s11, s101
s_lshl_b32 s11, s11, 2
s_waitcnt lgkmcnt(4)
v_mfma_f32_32x32x16_bf16 v[160:175], v[88:91], a[16:19], v[160:175]
ds_read_b64_tr_b16 a[8:9], v8 offset:43008
ds_read_b64_tr_b16 a[10:11], v8 offset:43264
buffer_load_dwordx4 v2, s[32:35], s61 offen offset:2048 lds
s_add_u32 s84, s84, s11
v_mfma_f32_32x32x16_bf16 v[176:191], v[88:91], a[20:23], v[176:191]
ds_read_b64_tr_b16 a[12:13], v8 offset:50176
ds_read_b64_tr_b16 a[14:15], v8 offset:50432
v_mov_b32 v251, -1
s_add_u32 s84, s84, 10551296
s_lshl_b32 s85, s83, 2
v_mfma_f32_32x32x16_bf16 v[160:175], v[92:95], a[24:27], v[160:175]
ds_read_b64_tr_b16 a[16:17], v8 offset:44032
ds_read_b64_tr_b16 a[18:19], v8 offset:44288
buffer_store_dwordx4 v[248:251], v1, s[40:43], s74 offen offset:2048 sc1
s_add_u32 s85, s85, s10
v_mfma_f32_32x32x16_bf16 v[176:191], v[92:95], a[28:31], v[176:191]
ds_read_b64_tr_b16 a[20:21], v8 offset:51200
ds_read_b64_tr_b16 a[22:23], v8 offset:51456
s_lshl_b32 s85, s85, 7
v_add_u32 v2, s64, v3
s_add_u32 m0, s72, 114688
s_waitcnt lgkmcnt(4)
v_mfma_f32_32x32x16_bf16 v[160:175], v[96:99], a[0:3], v[160:175]
ds_read_b64_tr_b16 a[24:25], v8 offset:45056
ds_read_b64_tr_b16 a[26:27], v8 offset:45312
buffer_load_dwordx4 v2, s[32:35], s55 offen offset:0 lds
s_add_u32 s85, s85, 10551296
s_cmp_eq_u32 s77, 0
s_cselect_b32 s85, 10551296, s85
v_mfma_f32_32x32x16_bf16 v[176:191], v[96:99], a[4:7], v[176:191]
ds_read_b64_tr_b16 a[28:29], v8 offset:52224
ds_read_b64_tr_b16 a[30:31], v8 offset:52480
s_lshl_b32 s87, s100, 7
v_mfma_f32_32x32x16_bf16 v[160:175], v[100:103], a[8:11], v[160:175]
ds_read_b64_tr_b16 a[0:1], v8 offset:46080
ds_read_b64_tr_b16 a[2:3], v8 offset:46336
buffer_load_dwordx4 v2, s[32:35], s56 offen offset:1024 lds
s_add_u32 s87, s87, 10567680
v_mfma_f32_32x32x16_bf16 v[176:191], v[100:103], a[12:15], v[176:191]
ds_read_b64_tr_b16 a[4:5], v8 offset:53248
ds_read_b64_tr_b16 a[6:7], v8 offset:53504
s_lshl_b32 s11, s82, 4
s_add_u32 s11, s11, s80
s_waitcnt lgkmcnt(4)
v_mfma_f32_32x32x16_bf16 v[160:175], v[104:107], a[16:19], v[160:175]
ds_read_b64_tr_b16 a[8:9], v8 offset:47104
ds_read_b64_tr_b16 a[10:11], v8 offset:47360
s_lshl_b32 s11, s11, 2
v_mfma_f32_32x32x16_bf16 v[176:191], v[104:107], a[20:23], v[176:191]
ds_read_b64_tr_b16 a[12:13], v8 offset:54272
ds_read_b64_tr_b16 a[14:15], v8 offset:54528
buffer_store_dwordx4 v[248:251], v1, s[40:43], s74 offen offset:3072 sc1
buffer_load_dwordx4 v2, s[32:35], s57 offen offset:2048 lds
s_add_u32 s86, s87, s11
v_mfma_f32_32x32x16_bf16 v[160:175], v[108:111], a[24:27], v[160:175]
ds_read_b64_tr_b16 a[16:17], v8 offset:48128
ds_read_b64_tr_b16 a[18:19], v8 offset:48384
v_mfma_f32_32x32x16_bf16 v[176:191], v[108:111], a[28:31], v[176:191]
ds_read_b64_tr_b16 a[20:21], v8 offset:55296
ds_read_b64_tr_b16 a[22:23], v8 offset:55552
s_waitcnt lgkmcnt(4)
v_mfma_f32_32x32x16_bf16 v[160:175], v[112:115], a[0:3], v[160:175]
ds_read_b64_tr_b16 a[24:25], v8 offset:49152
ds_read_b64_tr_b16 a[26:27], v8 offset:49408
buffer_load_dwordx4 v2, s[32:35], s58 offen offset:3072 lds
v_mfma_f32_32x32x16_bf16 v[176:191], v[112:115], a[4:7], v[176:191]
ds_read_b64_tr_b16 a[28:29], v8 offset:56320
ds_read_b64_tr_b16 a[30:31], v8 offset:56576
s_add_u32 m0, s72, 118784
v_mfma_f32_32x32x16_bf16 v[160:175], v[116:119], a[8:11], v[160:175]
s_waitcnt vmcnt(14) lgkmcnt(0)
s_barrier
ds_read_b64_tr_b16 a[0:1], v232 offset:0
ds_read_b64_tr_b16 a[2:3], v232 offset:512
buffer_store_dwordx4 v[248:251], v1, s[40:43], s75 offen offset:0 sc1
buffer_load_dwordx4 v2, s[32:35], s59 offen offset:0 lds
v_mfma_f32_32x32x16_bf16 v[176:191], v[116:119], a[12:15], v[176:191]
ds_read_b64_tr_b16 a[4:5], v232 offset:7168
ds_read_b64_tr_b16 a[6:7], v232 offset:7680
s_waitcnt vmcnt(15)
v_cmp_eq_u32 vcc, 0, v227
s_cbranch_vccnz L_spin0
L_ok0:
s_cmp_lg_u32 s10, 0
s_cselect_b32 s86, 0x40000000, s86
v_mfma_f32_32x32x16_bf16 v[160:175], v[120:123], a[16:19], v[160:175]
ds_read_b64_tr_b16 a[8:9], v234 offset:0
ds_read_b64_tr_b16 a[10:11], v234 offset:512
buffer_store_dword v225, v224, s[40:43], s86 offen sc1
v_mfma_f32_32x32x16_bf16 v[176:191], v[120:123], a[20:23], v[176:191]
ds_read_b64_tr_b16 a[12:13], v234 offset:7168
ds_read_b64_tr_b16 a[14:15], v234 offset:7680
buffer_load_dwordx4 v2, s[32:35], s60 offen offset:1024 lds
v_mfma_f32_32x32x16_bf16 v[160:175], v[124:127], a[24:27], v[160:175]
ds_read_b64_tr_b16 a[16:17], v232 offset:1024
ds_read_b64_tr_b16 a[18:19], v232 offset:1536
buffer_store_dwordx4 v[248:251], v1, s[40:43], s75 offen offset:1024 sc1
v_mfma_f32_32x32x16_bf16 v[176:191], v[124:127], a[28:31], v[176:191]
ds_read_b64_tr_b16 a[20:21], v232 offset:8192
ds_read_b64_tr_b16 a[22:23], v232 offset:8704
s_waitcnt lgkmcnt(4)
v_mfma_f32_32x32x16_bf16 v[128:143], a[0:3], v[16:19], 0
ds_read_b64_tr_b16 a[24:25], v234 offset:1024
ds_read_b64_tr_b16 a[26:27], v234 offset:1536
buffer_load_dwordx4 v2, s[32:35], s61 offen offset:2048 lds
v_mfma_f32_32x32x16_bf16 a[32:47], a[4:7], v[16:19], 0
ds_read_b64_tr_b16 a[28:29], v234 offset:8192
ds_read_b64_tr_b16 a[30:31], v234 offset:8704
ds_read_b128 v[192:195], v240 offset:0
ds_read_b128 v[196:199], v240 offset:32
ds_read_b128 v[200:203], v240 offset:64
ds_read_b128 v[204:207], v240 offset:96
s_waitcnt lgkmcnt(0)
v_mul_f32 v160, v160, v192
v_mul_f32 v161, v161, v193
v_mul_f32 v162, v162, v194
v_mul_f32 v163, v163, v195
v_mfma_f32_32x32x16_bf16 v[144:159], a[8:11], v[16:19], 0
ds_read_b64_tr_b16 a[0:1], v232 offset:2048
ds_read_b64_tr_b16 a[2:3], v232 offset:2560
buffer_store_dwordx4 v[248:251], v1, s[40:43], s75 offen offset:2048 sc1
v_exp_f32_e64 v244, v160 clamp
v_exp_f32_e64 v245, v161 clamp
v_exp_f32_e64 v246, v162 clamp
v_exp_f32_e64 v247, v163 clamp
v_max_f32 v160, 0, v160
v_max_f32 v161, 0, v161
v_mfma_f32_32x32x16_bf16 a[48:63], a[12:15], v[16:19], 0
ds_read_b64_tr_b16 a[4:5], v232 offset:9216
ds_read_b64_tr_b16 a[6:7], v232 offset:9728
v_max_f32 v162, 0, v162
v_max_f32 v163, 0, v163
v_fmac_f32 v244, 0x3f317218, v160
v_fmac_f32 v245, 0x3f317218, v161
v_fmac_f32 v246, 0x3f317218, v162
v_fmac_f32 v247, 0x3f317218, v163
v_add_f32 v160, 0x358637bd, v244
v_add_f32 v161, 0x358637bd, v245
v_add_f32 v162, 0x358637bd, v246
v_add_f32 v163, 0x358637bd, v247
v_mfma_f32_32x32x16_bf16 v[128:143], a[16:19], v[20:23], v[128:143]
ds_read_b64_tr_b16 a[8:9], v234 offset:2048
ds_read_b64_tr_b16 a[10:11], v234 offset:2560
v_mul_f32 v176, v176, v192
v_mul_f32 v177, v177, v193
v_mul_f32 v178, v178, v194
v_mul_f32 v179, v179, v195
v_cvt_pk_bf16_f32 v208, v160, v161
v_cvt_pk_bf16_f32 v209, v162, v163
v_cvt_pk_bf16_f32 v216, v176, v177
v_cvt_pk_bf16_f32 v217, v178, v179
v_mul_f32 v164, v164, v196
v_mul_f32 v165, v165, v197
v_mul_f32 v166, v166, v198
s_add_u32 m0, s73, 0
s_add_u32 s11, s12, 0
v_mfma_f32_32x32x16_bf16 a[32:47], a[20:23], v[20:23], a[32:47]
ds_read_b64_tr_b16 a[12:13], v234 offset:9216
ds_read_b64_tr_b16 a[14:15], v234 offset:9728
buffer_load_dwordx4 v6, s[28:31], s11 offen lds
buffer_load_dwordx4 v7, s[28:31], s11 offen offset:1024 lds
v_mul_f32 v167, v167, v199
v_exp_f32_e64 v244, v164 clamp
v_exp_f32_e64 v245, v165 clamp
v_exp_f32_e64 v246, v166 clamp
v_exp_f32_e64 v247, v167 clamp
v_max_f32 v164, 0, v164
v_mfma_f32_32x32x16_bf16 v[144:159], a[24:27], v[20:23], v[144:159]
ds_read_b64_tr_b16 a[16:17], v232 offset:3072
ds_read_b64_tr_b16 a[18:19], v232 offset:3584
v_max_f32 v165, 0, v165
v_max_f32 v166, 0, v166
v_max_f32 v167, 0, v167
v_fmac_f32 v244, 0x3f317218, v164
v_fmac_f32 v245, 0x3f317218, v165
v_fmac_f32 v246, 0x3f317218, v166
v_fmac_f32 v247, 0x3f317218, v167
v_add_f32 v164, 0x358637bd, v244
v_add_f32 v165, 0x358637bd, v245
v_add_f32 v166, 0x358637bd, v246
v_mfma_f32_32x32x16_bf16 a[48:63], a[28:31], v[20:23], a[48:63]
ds_read_b64_tr_b16 a[20:21], v232 offset:10240
ds_read_b64_tr_b16 a[22:23], v232 offset:10752
buffer_store_dwordx4 v[248:251], v1, s[40:43], s75 offen offset:3072 sc1
v_add_f32 v167, 0x358637bd, v247
v_mul_f32 v180, v180, v196
v_mul_f32 v181, v181, v197
v_mul_f32 v182, v182, v198
v_mul_f32 v183, v183, v199
v_cvt_pk_bf16_f32 v210, v164, v165
v_cvt_pk_bf16_f32 v211, v166, v167
v_cvt_pk_bf16_f32 v218, v180, v181
v_cvt_pk_bf16_f32 v219, v182, v183
v_mul_f32 v168, v168, v200
s_waitcnt lgkmcnt(4)
v_mfma_f32_32x32x16_bf16 v[128:143], a[0:3], v[24:27], v[128:143]
ds_read_b64_tr_b16 a[24:25], v234 offset:3072
ds_read_b64_tr_b16 a[26:27], v234 offset:3584
v_mul_f32 v169, v169, v201
v_mul_f32 v170, v170, v202
v_mul_f32 v171, v171, v203
v_exp_f32_e64 v244, v168 clamp
v_exp_f32_e64 v245, v169 clamp
v_exp_f32_e64 v246, v170 clamp
v_exp_f32_e64 v247, v171 clamp
s_add_u32 m0, s73, 8192
s_add_u32 s11, s12, 14336
v_mfma_f32_32x32x16_bf16 a[32:47], a[4:7], v[24:27], a[32:47]
ds_read_b64_tr_b16 a[28:29], v234 offset:10240
ds_read_b64_tr_b16 a[30:31], v234 offset:10752
buffer_load_dwordx4 v6, s[28:31], s11 offen lds
buffer_load_dwordx4 v7, s[28:31], s11 offen offset:1024 lds
v_max_f32 v168, 0, v168
v_max_f32 v169, 0, v169
v_max_f32 v170, 0, v170
v_max_f32 v171, 0, v171
s_nop 0
v_fmac_f32 v244, 0x3f317218, v168
v_fmac_f32 v245, 0x3f317218, v169
v_fmac_f32 v246, 0x3f317218, v170
v_fmac_f32 v247, 0x3f317218, v171
v_add_f32 v168, 0x358637bd, v244
v_add_f32 v169, 0x358637bd, v245
v_mfma_f32_32x32x16_bf16 v[144:159], a[8:11], v[24:27], v[144:159]
ds_read_b64_tr_b16 a[0:1], v232 offset:4096
ds_read_b64_tr_b16 a[2:3], v232 offset:4608
v_add_f32 v170, 0x358637bd, v246
v_add_f32 v171, 0x358637bd, v247
v_mul_f32 v184, v184, v200
v_mul_f32 v185, v185, v201
v_mul_f32 v186, v186, v202
v_mul_f32 v187, v187, v203
v_cvt_pk_bf16_f32 v212, v168, v169
v_cvt_pk_bf16_f32 v213, v170, v171
v_cvt_pk_bf16_f32 v220, v184, v185
v_cvt_pk_bf16_f32 v221, v186, v187
v_mfma_f32_32x32x16_bf16 a[48:63], a[12:15], v[24:27], a[48:63]
ds_read_b64_tr_b16 a[4:5], v232 offset:11264
ds_read_b64_tr_b16 a[6:7], v232 offset:11776
buffer_store_dwordx4 v[248:251], v1, s[40:43], s0 offen offset:0 sc1
v_mul_f32 v172, v172, v204
v_mul_f32 v173, v173, v205
v_mul_f32 v174, v174, v206
v_mul_f32 v175, v175, v207
v_exp_f32_e64 v244, v172 clamp
v_exp_f32_e64 v245, v173 clamp
v_exp_f32_e64 v246, v174 clamp
v_exp_f32_e64 v247, v175 clamp
s_waitcnt lgkmcnt(4)
v_mfma_f32_32x32x16_bf16 v[128:143], a[16:19], v[28:31], v[128:143]
ds_read_b64_tr_b16 a[8:9], v234 offset:4096
ds_read_b64_tr_b16 a[10:11], v234 offset:4608
v_max_f32 v172, 0, v172
v_max_f32 v173, 0, v173
v_max_f32 v174, 0, v174
v_max_f32 v175, 0, v175
v_fmac_f32 v244, 0x3f317218, v172
v_fmac_f32 v245, 0x3f317218, v173
v_fmac_f32 v246, 0x3f317218, v174
v_fmac_f32 v247, 0x3f317218, v175
v_add_f32 v172, 0x358637bd, v244
s_add_u32 m0, s73, 16384
s_add_u32 s11, s14, 0
v_mfma_f32_32x32x16_bf16 a[32:47], a[20:23], v[28:31], a[32:47]
ds_read_b64_tr_b16 a[12:13], v234 offset:11264
ds_read_b64_tr_b16 a[14:15], v234 offset:11776
buffer_load_dwordx4 v6, s[28:31], s11 offen lds
buffer_load_dwordx4 v7, s[28:31], s11 offen offset:1024 lds
v_add_f32 v173, 0x358637bd, v245
v_add_f32 v174, 0x358637bd, v246
v_add_f32 v175, 0x358637bd, v247
v_mul_f32 v188, v188, v204
v_mul_f32 v189, v189, v205
v_mul_f32 v190, v190, v206
v_mul_f32 v191, v191, v207
v_cvt_pk_bf16_f32 v214, v172, v173
v_cvt_pk_bf16_f32 v215, v174, v175
v_cvt_pk_bf16_f32 v222, v188, v189
v_mfma_f32_32x32x16_bf16 v[144:159], a[24:27], v[28:31], v[144:159]
ds_read_b64_tr_b16 a[16:17], v232 offset:5120
ds_read_b64_tr_b16 a[18:19], v232 offset:5632
v_cvt_pk_bf16_f32 v223, v190, v191
v_mov_b32 v244, 0x3f803f80
v_cndmask_b32 v216, v216, v244, s[88:89]
v_cndmask_b32 v217, v217, v244, s[88:89]
v_cndmask_b32 v218, v218, v244, s[88:89]
v_cndmask_b32 v219, v219, v244, s[88:89]
v_cndmask_b32 v220, v220, v244, s[88:89]
v_cndmask_b32 v221, v221, v244, s[88:89]
v_cndmask_b32 v222, v222, v244, s[88:89]
v_cndmask_b32 v223, v223, v244, s[88:89]
v_mfma_f32_32x32x16_bf16 a[48:63], a[28:31], v[28:31], a[48:63]
ds_read_b64_tr_b16 a[20:21], v232 offset:12288
ds_read_b64_tr_b16 a[22:23], v232 offset:12800
buffer_store_dwordx4 v[248:251], v1, s[40:43], s0 offen offset:1024 sc1
v_mfma_f32_32x32x16_bf16 v[160:175], v[208:211], v[216:219], 0
s_waitcnt lgkmcnt(4)
v_mfma_f32_32x32x16_bf16 v[128:143], a[0:3], v[32:35], v[128:143]
ds_read_b64_tr_b16 a[24:25], v234 offset:5120
ds_read_b64_tr_b16 a[26:27], v234 offset:5632
v_mfma_f32_32x32x16_bf16 v[160:175], v[212:215], v[220:223], v[160:175]
s_add_u32 m0, s73, 24576
s_add_u32 s11, s14, 14336
v_mfma_f32_32x32x16_bf16 a[32:47], a[4:7], v[32:35], a[32:47]
ds_read_b64_tr_b16 a[28:29], v234 offset:12288
ds_read_b64_tr_b16 a[30:31], v234 offset:12800
buffer_load_dwordx4 v6, s[28:31], s11 offen lds
buffer_load_dwordx4 v7, s[28:31], s11 offen offset:1024 lds
v_mfma_f32_32x32x16_bf16 v[144:159], a[8:11], v[32:35], v[144:159]
ds_read_b64_tr_b16 a[0:1], v232 offset:6144
ds_read_b64_tr_b16 a[2:3], v232 offset:6656
v_mfma_f32_32x32x16_bf16 a[48:63], a[12:15], v[32:35], a[48:63]
ds_read_b64_tr_b16 a[4:5], v232 offset:13312
ds_read_b64_tr_b16 a[6:7], v232 offset:13824
s_waitcnt lgkmcnt(4)
v_mfma_f32_32x32x16_bf16 v[128:143], a[16:19], v[36:39], v[128:143]
ds_read_b64_tr_b16 a[8:9], v234 offset:6144
ds_read_b64_tr_b16 a[10:11], v234 offset:6656
ds_write_b128 v241, v[160:163] offset:0
ds_write_b128 v241, v[164:167] offset:1024
ds_write_b128 v241, v[168:171] offset:2048
ds_write_b128 v241, v[172:175] offset:3072
s_add_u32 m0, s73, 32768
s_add_u32 s11, s13, 0
v_mfma_f32_32x32x16_bf16 a[32:47], a[20:23], v[36:39], a[32:47]
ds_read_b64_tr_b16 a[12:13], v234 offset:13312
ds_read_b64_tr_b16 a[14:15], v234 offset:13824
buffer_load_dwordx4 v6, s[28:31], s11 offen lds
buffer_load_dwordx4 v7, s[28:31], s11 offen offset:1024 lds
v_mfma_f32_32x32x16_bf16 v[144:159], a[24:27], v[36:39], v[144:159]
s_waitcnt vmcnt(26) lgkmcnt(0)
s_barrier
ds_read_b64_tr_b16 a[16:17], v232 offset:28672
ds_read_b64_tr_b16 a[18:19], v232 offset:29184
v_mfma_f32_32x32x16_bf16 a[48:63], a[28:31], v[36:39], a[48:63]
ds_read_b64_tr_b16 a[20:21], v232 offset:35840
ds_read_b64_tr_b16 a[22:23], v232 offset:36352
ds_read_b128 v[192:195], v242 offset:0
ds_read_b128 v[196:199], v242 offset:4096
v_mfma_f32_32x32x16_bf16 v[128:143], a[0:3], v[40:43], v[128:143]
ds_read_b64_tr_b16 a[24:25], v234 offset:28672
ds_read_b64_tr_b16 a[26:27], v234 offset:29184
ds_read_b128 v[200:203], v242 offset:8192
ds_read_b128 v[204:207], v242 offset:12288
v_mfma_f32_32x32x16_bf16 a[32:47], a[4:7], v[40:43], a[32:47]
ds_read_b64_tr_b16 a[28:29], v234 offset:35840
ds_read_b64_tr_b16 a[30:31], v234 offset:36352
s_waitcnt lgkmcnt(2)
v_add_f32 v192, v192, v196
v_add_f32 v193, v193, v197
v_add_u32 v2, s65, v3
s_add_u32 m0, s72, 57344
v_mfma_f32_32x32x16_bf16 v[144:159], a[8:11], v[40:43], v[144:159]
ds_read_b64_tr_b16 a[0:1], v232 offset:29696
ds_read_b64_tr_b16 a[2:3], v232 offset:30208
buffer_load_dwordx4 v2, s[32:35], s55 offen offset:0 lds
v_add_f32 v194, v194, v198
v_add_f32 v195, v195, v199
v_add_f32 v200, v200, v204
v_mfma_f32_32x32x16_bf16 a[48:63], a[12:15], v[40:43], a[48:63]
ds_read_b64_tr_b16 a[4:5], v232 offset:36864
ds_read_b64_tr_b16 a[6:7], v232 offset:37376
buffer_load_dwordx4 v2, s[32:35], s56 offen offset:1024 lds
v_add_f32 v201, v201, v205
v_add_f32 v202, v202, v206
v_add_f32 v203, v203, v207
s_waitcnt lgkmcnt(4)
v_mfma_f32_32x32x16_bf16 v[128:143], a[16:19], v[44:47], v[128:143]
ds_read_b64_tr_b16 a[8:9], v234 offset:29696
ds_read_b64_tr_b16 a[10:11], v234 offset:30208
buffer_load_dwordx4 v2, s[32:35], s57 offen offset:2048 lds
v_add_f32 v192, v192, v200
v_add_f32 v193, v193, v201
v_add_f32 v194, v194, v202
v_mfma_f32_32x32x16_bf16 a[32:47], a[20:23], v[44:47], a[32:47]
ds_read_b64_tr_b16 a[12:13], v234 offset:36864
ds_read_b64_tr_b16 a[14:15], v234 offset:37376
v_add_f32 v195, v195, v203
v_mfma_f32_32x32x16_bf16 v[144:159], a[24:27], v[44:47], v[144:159]
ds_read_b64_tr_b16 a[16:17], v232 offset:30720
ds_read_b64_tr_b16 a[18:19], v232 offset:31232
buffer_store_dwordx4 v[192:195], v243, s[40:43], s6 offen sc1
buffer_load_dwordx4 v2, s[32:35], s58 offen offset:3072 lds
s_add_u32 m0, s72, 61440
v_mfma_f32_32x32x16_bf16 a[48:63], a[28:31], v[44:47], a[48:63]
ds_read_b64_tr_b16 a[20:21], v232 offset:37888
ds_read_b64_tr_b16 a[22:23], v232 offset:38400
buffer_load_dwordx4 v2, s[32:35], s59 offen offset:0 lds
s_waitcnt lgkmcnt(4)
v_mfma_f32_32x32x16_bf16 v[128:143], a[0:3], v[48:51], v[128:143]
ds_read_b64_tr_b16 a[24:25], v234 offset:30720
ds_read_b64_tr_b16 a[26:27], v234 offset:31232
s_cmp_eq_u32 s82, 0
s_cselect_b32 s88, 0xffff, 0
s_cselect_b32 s89, 0, 0xffff0000
v_mfma_f32_32x32x16_bf16 a[32:47], a[4:7], v[48:51], a[32:47]
ds_read_b64_tr_b16 a[28:29], v234 offset:37888
ds_read_b64_tr_b16 a[30:31], v234 offset:38400
buffer_load_dwordx4 v2, s[32:35], s60 offen offset:1024 lds
v_mfma_f32_32x32x16_bf16 v[144:159], a[8:11], v[48:51], v[144:159]
ds_read_b64_tr_b16 a[0:1], v232 offset:31744
ds_read_b64_tr_b16 a[2:3], v232 offset:32256
buffer_load_dwordx4 v2, s[32:35], s61 offen offset:2048 lds
s_waitcnt vmcnt(19)
v_mfma_f32_32x32x16_bf16 a[48:63], a[12:15], v[48:51], a[48:63]
ds_read_b64_tr_b16 a[4:5], v232 offset:38912
ds_read_b64_tr_b16 a[6:7], v232 offset:39424
ds_read_b64_tr_b16 a[96:97], v236 offset:0
ds_read_b64_tr_b16 a[98:99], v236 offset:1024
ds_read_b64_tr_b16 a[100:101], v237 offset:0
ds_read_b64_tr_b16 a[102:103], v237 offset:1024
s_waitcnt lgkmcnt(8)
v_mfma_f32_32x32x16_bf16 v[128:143], a[16:19], v[52:55], v[128:143]
ds_read_b64_tr_b16 a[8:9], v234 offset:31744
ds_read_b64_tr_b16 a[10:11], v234 offset:32256
v_mfma_f32_32x32x16_bf16 a[32:47], a[20:23], v[52:55], a[32:47]
ds_read_b64_tr_b16 a[12:13], v234 offset:38912
ds_read_b64_tr_b16 a[14:15], v234 offset:39424
s_add_u32 m0, s73, 40960
s_add_u32 s11, s13, 14336
v_mfma_f32_32x32x16_bf16 v[144:159], a[24:27], v[52:55], v[144:159]
ds_read_b64_tr_b16 a[16:17], v232 offset:32768
ds_read_b64_tr_b16 a[18:19], v232 offset:33280
buffer_load_dwordx4 v6, s[28:31], s11 offen lds
buffer_load_dwordx4 v7, s[28:31], s11 offen offset:1024 lds
s_waitcnt vmcnt(18)
v_mfma_f32_32x32x16_bf16 a[48:63], a[28:31], v[52:55], a[48:63]
ds_read_b64_tr_b16 a[20:21], v232 offset:39936
ds_read_b64_tr_b16 a[22:23], v232 offset:40448
ds_read_b64_tr_b16 a[104:105], v236 offset:8192
ds_read_b64_tr_b16 a[106:107], v236 offset:9216
ds_read_b64_tr_b16 a[108:109], v237 offset:8192
ds_read_b64_tr_b16 a[110:111], v237 offset:9216
s_waitcnt lgkmcnt(8)
v_mfma_f32_32x32x16_bf16 v[128:143], a[0:3], v[56:59], v[128:143]
ds_read_b64_tr_b16 a[24:25], v234 offset:32768
ds_read_b64_tr_b16 a[26:27], v234 offset:33280
v_mfma_f32_32x32x16_bf16 a[32:47], a[4:7], v[56:59], a[32:47]
ds_read_b64_tr_b16 a[28:29], v234 offset:39936
ds_read_b64_tr_b16 a[30:31], v234 offset:40448
s_add_u32 m0, s73, 0
s_add_u32 s11, s15, 0
v_mfma_f32_32x32x16_bf16 v[144:159], a[8:11], v[56:59], v[144:159]
ds_read_b64_tr_b16 a[0:1], v232 offset:33792
ds_read_b64_tr_b16 a[2:3], v232 offset:34304
buffer_load_dwordx4 v6, s[28:31], s11 offen lds
buffer_load_dwordx4 v7, s[28:31], s11 offen offset:1024 lds
s_waitcnt vmcnt(17)
v_mfma_f32_32x32x16_bf16 a[48:63], a[12:15], v[56:59], a[48:63]
ds_read_b64_tr_b16 a[4:5], v232 offset:40960
ds_read_b64_tr_b16 a[6:7], v232 offset:41472
ds_read_b64_tr_b16 a[112:113], v236 offset:16384
ds_read_b64_tr_b16 a[114:115], v236 offset:17408
ds_read_b64_tr_b16 a[116:117], v237 offset:16384
ds_read_b64_tr_b16 a[118:119], v237 offset:17408
s_waitcnt lgkmcnt(8)
v_mfma_f32_32x32x16_bf16 v[128:143], a[16:19], v[60:63], v[128:143]
ds_read_b64_tr_b16 a[8:9], v234 offset:33792
ds_read_b64_tr_b16 a[10:11], v234 offset:34304
v_mfma_f32_32x32x16_bf16 a[32:47], a[20:23], v[60:63], a[32:47]
ds_read_b64_tr_b16 a[12:13], v234 offset:40960
ds_read_b64_tr_b16 a[14:15], v234 offset:41472
s_add_u32 m0, s73, 8192
s_add_u32 s11, s15, 14336
v_mfma_f32_32x32x16_bf16 v[144:159], a[24:27], v[60:63], v[144:159]
ds_read_b64_tr_b16 a[16:17], v232 offset:34816
ds_read_b64_tr_b16 a[18:19], v232 offset:35328
buffer_load_dwordx4 v6, s[28:31], s11 offen lds
buffer_load_dwordx4 v7, s[28:31], s11 offen offset:1024 lds
s_waitcnt vmcnt(16)
v_mfma_f32_32x32x16_bf16 a[48:63], a[28:31], v[60:63], a[48:63]
ds_read_b64_tr_b16 a[20:21], v232 offset:41984
ds_read_b64_tr_b16 a[22:23], v232 offset:42496
ds_read_b64_tr_b16 a[120:121], v236 offset:24576
ds_read_b64_tr_b16 a[122:123], v236 offset:25600
ds_read_b64_tr_b16 a[124:125], v237 offset:24576
ds_read_b64_tr_b16 a[126:127], v237 offset:25600
s_waitcnt lgkmcnt(8)
v_mfma_f32_32x32x16_bf16 v[128:143], a[0:3], v[64:67], v[128:143]
ds_read_b64_tr_b16 a[24:25], v234 offset:34816
ds_read_b64_tr_b16 a[26:27], v234 offset:35328
v_mfma_f32_32x32x16_bf16 a[32:47], a[4:7], v[64:67], a[32:47]
ds_read_b64_tr_b16 a[28:29], v234 offset:41984
ds_read_b64_tr_b16 a[30:31], v234 offset:42496
v_mfma_f32_32x32x16_bf16 v[144:159], a[8:11], v[64:67], v[144:159]
s_waitcnt lgkmcnt(0)
s_barrier
ds_read_b64_tr_b16 a[0:1], v233 offset:0
ds_read_b64_tr_b16 a[2:3], v233 offset:512
s_waitcnt vmcnt(14)
v_mfma_f32_32x32x16_bf16 a[48:63], a[12:15], v[64:67], a[48:63]
ds_read_b64_tr_b16 a[4:5], v233 offset:7168
ds_read_b64_tr_b16 a[6:7], v233 offset:7680
ds_read_b64_tr_b16 a[128:129], v236 offset:32768
ds_read_b64_tr_b16 a[130:131], v236 offset:33792
ds_read_b64_tr_b16 a[132:133], v237 offset:32768
ds_read_b64_tr_b16 a[134:135], v237 offset:33792
v_mfma_f32_32x32x16_bf16 v[128:143], a[16:19], v[68:71], v[128:143]
ds_read_b64_tr_b16 a[8:9], v235 offset:0
ds_read_b64_tr_b16 a[10:11], v235 offset:512
v_mfma_f32_32x32x16_bf16 a[32:47], a[20:23], v[68:71], a[32:47]
ds_read_b64_tr_b16 a[12:13], v235 offset:7168
ds_read_b64_tr_b16 a[14:15], v235 offset:7680
v_add_u32 v2, s68, v4
s_add_u32 m0, s72, 86016
v_mfma_f32_32x32x16_bf16 v[144:159], a[24:27], v[68:71], v[144:159]
ds_read_b64_tr_b16 a[16:17], v233 offset:1024
ds_read_b64_tr_b16 a[18:19], v233 offset:1536
buffer_load_dwordx4 v2, s[32:35], s55 offen offset:0 lds
v_mfma_f32_32x32x16_bf16 a[48:63], a[28:31], v[68:71], a[48:63]
ds_read_b64_tr_b16 a[20:21], v233 offset:8192
ds_read_b64_tr_b16 a[22:23], v233 offset:8704
buffer_load_dwordx4 v2, s[32:35], s56 offen offset:1024 lds
s_waitcnt lgkmcnt(4)
v_mfma_f32_32x32x16_bf16 v[128:143], a[0:3], v[72:75], v[128:143]
ds_read_b64_tr_b16 a[24:25], v235 offset:1024
ds_read_b64_tr_b16 a[26:27], v235 offset:1536
buffer_load_dwordx4 v2, s[32:35], s57 offen offset:2048 lds
v_mfma_f32_32x32x16_bf16 a[32:47], a[4:7], v[72:75], a[32:47]
ds_read_b64_tr_b16 a[28:29], v235 offset:8192
ds_read_b64_tr_b16 a[30:31], v235 offset:8704
v_mfma_f32_32x32x16_bf16 v[144:159], a[8:11], v[72:75], v[144:159]
ds_read_b64_tr_b16 a[0:1], v233 offset:2048
ds_read_b64_tr_b16 a[2:3], v233 offset:2560
buffer_load_dwordx4 v2, s[32:35], s58 offen offset:3072 lds
s_add_u32 m0, s72, 90112
v_mfma_f32_32x32x16_bf16 a[48:63], a[12:15], v[72:75], a[48:63]
ds_read_b64_tr_b16 a[4:5], v233 offset:9216
ds_read_b64_tr_b16 a[6:7], v233 offset:9728
buffer_load_dwordx4 v2, s[32:35], s59 offen offset:0 lds
s_waitcnt lgkmcnt(4)
v_mfma_f32_32x32x16_bf16 v[128:143], a[16:19], v[76:79], v[128:143]
ds_read_b64_tr_b16 a[8:9], v235 offset:2048
ds_read_b64_tr_b16 a[10:11], v235 offset:2560
v_mfma_f32_32x32x16_bf16 a[32:47], a[20:23], v[76:79], a[32:47]
ds_read_b64_tr_b16 a[12:13], v235 offset:9216
ds_read_b64_tr_b16 a[14:15], v235 offset:9728
buffer_load_dwordx4 v2, s[32:35], s60 offen offset:1024 lds
v_mfma_f32_32x32x16_bf16 v[144:159], a[24:27], v[76:79], v[144:159]
ds_read_b64_tr_b16 a[16:17], v233 offset:3072
ds_read_b64_tr_b16 a[18:19], v233 offset:3584
buffer_load_dwordx4 v2, s[32:35], s61 offen offset:2048 lds
v_mfma_f32_32x32x16_bf16 a[48:63], a[28:31], v[76:79], a[48:63]
ds_read_b64_tr_b16 a[20:21], v233 offset:10240
ds_read_b64_tr_b16 a[22:23], v233 offset:10752
s_waitcnt lgkmcnt(4)
v_mfma_f32_32x32x16_bf16 v[128:143], a[0:3], v[80:83], v[128:143]
ds_read_b64_tr_b16 a[24:25], v235 offset:3072
ds_read_b64_tr_b16 a[26:27], v235 offset:3584
buffer_load_dword v227, v229, s[40:43], s87 offen sc1
v_mfma_f32_32x32x16_bf16 a[32:47], a[4:7], v[80:83], a[32:47]
ds_read_b64_tr_b16 a[28:29], v235 offset:10240
ds_read_b64_tr_b16 a[30:31], v235 offset:10752
s_add_u32 m0, s73, 16384
s_add_u32 s11, s12, 28672
v_mfma_f32_32x32x16_bf16 v[144:159], a[8:11], v[80:83], v[144:159]
ds_read_b64_tr_b16 a[0:1], v233 offset:4096
ds_read_b64_tr_b16 a[2:3], v233 offset:4608
buffer_load_dwordx4 v6, s[28:31], s11 offen lds
buffer_load_dwordx4 v7, s[28:31], s11 offen offset:1024 lds
v_mfma_f32_32x32x16_bf16 a[48:63], a[12:15], v[80:83], a[48:63]
ds_read_b64_tr_b16 a[4:5], v233 offset:11264
ds_read_b64_tr_b16 a[6:7], v233 offset:11776
s_waitcnt vmcnt(14) lgkmcnt(4)
v_mfma_f32_32x32x16_bf16 v[128:143], a[16:19], v[84:87], v[128:143]
ds_read_b64_tr_b16 a[8:9], v235 offset:4096
ds_read_b64_tr_b16 a[10:11], v235 offset:4608
ds_read_b64_tr_b16 a[136:137], v236 offset:40960
ds_read_b64_tr_b16 a[138:139], v236 offset:41984
ds_read_b64_tr_b16 a[140:141], v237 offset:40960
ds_read_b64_tr_b16 a[142:143], v237 offset:41984
v_mfma_f32_32x32x16_bf16 a[32:47], a[20:23], v[84:87], a[32:47]
ds_read_b64_tr_b16 a[12:13], v235 offset:11264
ds_read_b64_tr_b16 a[14:15], v235 offset:11776
s_add_u32 m0, s73, 24576
s_add_u32 s11, s12, 43008
v_mfma_f32_32x32x16_bf16 v[144:159], a[24:27], v[84:87], v[144:159]
ds_read_b64_tr_b16 a[16:17], v233 offset:5120
ds_read_b64_tr_b16 a[18:19], v233 offset:5632
buffer_load_dwordx4 v6, s[28:31], s11 offen lds
buffer_load_dwordx4 v7, s[28:31], s11 offen offset:1024 lds
v_mfma_f32_32x32x16_bf16 a[48:63], a[28:31], v[84:87], a[48:63]
ds_read_b64_tr_b16 a[20:21], v233 offset:12288
ds_read_b64_tr_b16 a[22:23], v233 offset:12800
s_waitcnt vmcnt(14) lgkmcnt(4)
v_mfma_f32_32x32x16_bf16 v[128:143], a[0:3], v[88:91], v[128:143]
ds_read_b64_tr_b16 a[24:25], v235 offset:5120
ds_read_b64_tr_b16 a[26:27], v235 offset:5632
ds_read_b64_tr_b16 a[144:145], v236 offset:0
ds_read_b64_tr_b16 a[146:147], v236 offset:1024
ds_read_b64_tr_b16 a[148:149], v237 offset:0
ds_read_b64_tr_b16 a[150:151], v237 offset:1024
v_mfma_f32_32x32x16_bf16 a[32:47], a[4:7], v[88:91], a[32:47]
ds_read_b64_tr_b16 a[28:29], v235 offset:12288
ds_read_b64_tr_b16 a[30:31], v235 offset:12800
s_add_u32 m0, s73, 32768
s_add_u32 s11, s14, 28672
v_mfma_f32_32x32x16_bf16 v[144:159], a[8:11], v[88:91], v[144:159]
ds_read_b64_tr_b16 a[0:1], v233 offset:6144
ds_read_b64_tr_b16 a[2:3], v233 offset:6656
buffer_load_dwordx4 v6, s[28:31], s11 offen lds
buffer_load_dwordx4 v7, s[28:31], s11 offen offset:1024 lds
v_mfma_f32_32x32x16_bf16 a[48:63], a[12:15], v[88:91], a[48:63]
ds_read_b64_tr_b16 a[4:5], v233 offset:13312
ds_read_b64_tr_b16 a[6:7], v233 offset:13824
s_waitcnt vmcnt(14) lgkmcnt(4)
v_mfma_f32_32x32x16_bf16 v[128:143], a[16:19], v[92:95], v[128:143]
ds_read_b64_tr_b16 a[8:9], v235 offset:6144
ds_read_b64_tr_b16 a[10:11], v235 offset:6656
ds_read_b64_tr_b16 a[152:153], v236 offset:8192
ds_read_b64_tr_b16 a[154:155], v236 offset:9216
ds_read_b64_tr_b16 a[156:157], v237 offset:8192
ds_read_b64_tr_b16 a[158:159], v237 offset:9216
v_mfma_f32_32x32x16_bf16 a[32:47], a[20:23], v[92:95], a[32:47]
ds_read_b64_tr_b16 a[12:13], v235 offset:13312
ds_read_b64_tr_b16 a[14:15], v235 offset:13824
v_mfma_f32_32x32x16_bf16 v[144:159], a[24:27], v[92:95], v[144:159]
s_waitcnt lgkmcnt(0)
s_barrier
ds_read_b64_tr_b16 a[16:17], v232 offset:0
ds_read_b64_tr_b16 a[18:19], v232 offset:512
v_mfma_f32_32x32x16_bf16 a[48:63], a[28:31], v[92:95], a[48:63]
ds_read_b64_tr_b16 a[20:21], v232 offset:7168
ds_read_b64_tr_b16 a[22:23], v232 offset:7680
v_mfma_f32_32x32x16_bf16 v[128:143], a[0:3], v[96:99], v[128:143]
ds_read_b64_tr_b16 a[24:25], v234 offset:0
ds_read_b64_tr_b16 a[26:27], v234 offset:512
v_mfma_f32_32x32x16_bf16 a[32:47], a[4:7], v[96:99], a[32:47]
ds_read_b64_tr_b16 a[28:29], v234 offset:7168
ds_read_b64_tr_b16 a[30:31], v234 offset:7680
v_add_u32 v2, s69, v4
s_add_u32 m0, s72, 114688
v_mfma_f32_32x32x16_bf16 v[144:159], a[8:11], v[96:99], v[144:159]
ds_read_b64_tr_b16 a[0:1], v232 offset:1024
ds_read_b64_tr_b16 a[2:3], v232 offset:1536
buffer_load_dwordx4 v2, s[32:35], s55 offen offset:0 lds
v_mfma_f32_32x32x16_bf16 a[48:63], a[12:15], v[96:99], a[48:63]
ds_read_b64_tr_b16 a[4:5], v232 offset:8192
ds_read_b64_tr_b16 a[6:7], v232 offset:8704
buffer_load_dwordx4 v2, s[32:35], s56 offen offset:1024 lds
s_waitcnt lgkmcnt(4)
v_mfma_f32_32x32x16_bf16 v[128:143], a[16:19], v[100:103], v[128:143]
ds_read_b64_tr_b16 a[8:9], v234 offset:1024
ds_read_b64_tr_b16 a[10:11], v234 offset:1536
buffer_load_dwordx4 v2, s[32:35], s57 offen offset:2048 lds
v_mfma_f32_32x32x16_bf16 a[32:47], a[20:23], v[100:103], a[32:47]
ds_read_b64_tr_b16 a[12:13], v234 offset:8192
ds_read_b64_tr_b16 a[14:15], v234 offset:8704
v_mfma_f32_32x32x16_bf16 v[144:159], a[24:27], v[100:103], v[144:159]
ds_read_b64_tr_b16 a[16:17], v232 offset:2048
ds_read_b64_tr_b16 a[18:19], v232 offset:2560
buffer_load_dwordx4 v2, s[32:35], s58 offen offset:3072 lds
s_add_u32 m0, s72, 118784
v_mfma_f32_32x32x16_bf16 a[48:63], a[28:31], v[100:103], a[48:63]
ds_read_b64_tr_b16 a[20:21], v232 offset:9216
ds_read_b64_tr_b16 a[22:23], v232 offset:9728
buffer_load_dwordx4 v2, s[32:35], s59 offen offset:0 lds
s_waitcnt lgkmcnt(4)
v_mfma_f32_32x32x16_bf16 v[128:143], a[0:3], v[104:107], v[128:143]
ds_read_b64_tr_b16 a[24:25], v234 offset:2048
ds_read_b64_tr_b16 a[26:27], v234 offset:2560
v_mfma_f32_32x32x16_bf16 a[32:47], a[4:7], v[104:107], a[32:47]
ds_read_b64_tr_b16 a[28:29], v234 offset:9216
ds_read_b64_tr_b16 a[30:31], v234 offset:9728
buffer_load_dwordx4 v2, s[32:35], s60 offen offset:1024 lds
v_mfma_f32_32x32x16_bf16 v[144:159], a[8:11], v[104:107], v[144:159]
ds_read_b64_tr_b16 a[0:1], v232 offset:3072
ds_read_b64_tr_b16 a[2:3], v232 offset:3584
buffer_load_dwordx4 v2, s[32:35], s61 offen offset:2048 lds
v_mfma_f32_32x32x16_bf16 a[48:63], a[12:15], v[104:107], a[48:63]
ds_read_b64_tr_b16 a[4:5], v232 offset:10240
ds_read_b64_tr_b16 a[6:7], v232 offset:10752
s_waitcnt lgkmcnt(4)
v_mfma_f32_32x32x16_bf16 v[128:143], a[16:19], v[108:111], v[128:143]
ds_read_b64_tr_b16 a[8:9], v234 offset:3072
ds_read_b64_tr_b16 a[10:11], v234 offset:3584
v_mfma_f32_32x32x16_bf16 a[32:47], a[20:23], v[108:111], a[32:47]
ds_read_b64_tr_b16 a[12:13], v234 offset:10240
ds_read_b64_tr_b16 a[14:15], v234 offset:10752
s_waitcnt vmcnt(13)
v_cmp_eq_u32 vcc, 0, v227
s_nop 0
s_and_b64 vcc, vcc, s[88:89]
s_cbranch_vccnz L_spin2
L_ok2:
s_add_u32 m0, s73, 0
s_add_u32 s11, s14, 43008
v_mfma_f32_32x32x16_bf16 v[144:159], a[24:27], v[108:111], v[144:159]
ds_read_b64_tr_b16 a[16:17], v232 offset:4096
ds_read_b64_tr_b16 a[18:19], v232 offset:4608
buffer_load_dwordx4 v[192:195], v239, s[40:43], s2 offen sc1
buffer_load_dwordx4 v6, s[28:31], s11 offen lds
buffer_load_dwordx4 v7, s[28:31], s11 offen offset:1024 lds
v_mfma_f32_32x32x16_bf16 a[48:63], a[28:31], v[108:111], a[48:63]
ds_read_b64_tr_b16 a[20:21], v232 offset:11264
ds_read_b64_tr_b16 a[22:23], v232 offset:11776
s_waitcnt vmcnt(14) lgkmcnt(4)
v_mfma_f32_32x32x16_bf16 v[128:143], a[0:3], v[112:115], v[128:143]
ds_read_b64_tr_b16 a[24:25], v234 offset:4096
ds_read_b64_tr_b16 a[26:27], v234 offset:4608
ds_read_b64_tr_b16 a[160:161], v236 offset:16384
ds_read_b64_tr_b16 a[162:163], v236 offset:17408
ds_read_b64_tr_b16 a[164:165], v237 offset:16384
ds_read_b64_tr_b16 a[166:167], v237 offset:17408
v_mfma_f32_32x32x16_bf16 a[32:47], a[4:7], v[112:115], a[32:47]
ds_read_b64_tr_b16 a[28:29], v234 offset:11264
ds_read_b64_tr_b16 a[30:31], v234 offset:11776
s_add_u32 m0, s73, 8192
s_add_u32 s11, s13, 28672
v_mfma_f32_32x32x16_bf16 v[144:159], a[8:11], v[112:115], v[144:159]
ds_read_b64_tr_b16 a[0:1], v232 offset:5120
ds_read_b64_tr_b16 a[2:3], v232 offset:5632
buffer_load_dwordx4 v6, s[28:31], s11 offen lds
buffer_load_dwordx4 v7, s[28:31], s11 offen offset:1024 lds
v_mfma_f32_32x32x16_bf16 a[48:63], a[12:15], v[112:115], a[48:63]
ds_read_b64_tr_b16 a[4:5], v232 offset:12288
ds_read_b64_tr_b16 a[6:7], v232 offset:12800
s_waitcnt vmcnt(14) lgkmcnt(4)
v_mfma_f32_32x32x16_bf16 v[128:143], a[16:19], v[116:119], v[128:143]
ds_read_b64_tr_b16 a[8:9], v234 offset:5120
ds_read_b64_tr_b16 a[10:11], v234 offset:5632
ds_read_b64_tr_b16 a[168:169], v236 offset:24576
ds_read_b64_tr_b16 a[170:171], v236 offset:25600
ds_read_b64_tr_b16 a[172:173], v237 offset:24576
ds_read_b64_tr_b16 a[174:175], v237 offset:25600
v_mfma_f32_32x32x16_bf16 a[32:47], a[20:23], v[116:119], a[32:47]
ds_read_b64_tr_b16 a[12:13], v234 offset:12288
ds_read_b64_tr_b16 a[14:15], v234 offset:12800
s_add_u32 m0, s73, 16384
s_add_u32 s11, s13, 43008
v_mfma_f32_32x32x16_bf16 v[144:159], a[24:27], v[116:119], v[144:159]
ds_read_b64_tr_b16 a[16:17], v232 offset:6144
ds_read_b64_tr_b16 a[18:19], v232 offset:6656
buffer_load_dwordx4 v6, s[28:31], s11 offen lds
buffer_load_dwordx4 v7, s[28:31], s11 offen offset:1024 lds
v_mfma_f32_32x32x16_bf16 a[48:63], a[28:31], v[116:119], a[48:63]
ds_read_b64_tr_b16 a[20:21], v232 offset:13312
ds_read_b64_tr_b16 a[22:23], v232 offset:13824
s_waitcnt vmcnt(14) lgkmcnt(4)
v_mfma_f32_32x32x16_bf16 v[128:143], a[0:3], v[120:123], v[128:143]
ds_read_b64_tr_b16 a[24:25], v234 offset:6144
ds_read_b64_tr_b16 a[26:27], v234 offset:6656
ds_read_b64_tr_b16 a[176:177], v236 offset:32768
ds_read_b64_tr_b16 a[178:179], v236 offset:33792
ds_read_b64_tr_b16 a[180:181], v237 offset:32768
ds_read_b64_tr_b16 a[182:183], v237 offset:33792
v_mfma_f32_32x32x16_bf16 a[32:47], a[4:7], v[120:123], a[32:47]
ds_read_b64_tr_b16 a[28:29], v234 offset:13312
ds_read_b64_tr_b16 a[30:31], v234 offset:13824
v_mfma_f32_32x32x16_bf16 v[144:159], a[8:11], v[120:123], v[144:159]
s_waitcnt lgkmcnt(0)
s_barrier
s_cmp_lg_u32 s82, 0
s_cbranch_scc1 L_typeB
ds_read_b64_tr_b16 a[0:1], v232 offset:28672
ds_read_b64_tr_b16 a[2:3], v232 offset:29184
v_mfma_f32_32x32x16_bf16 a[48:63], a[12:15], v[120:123], a[48:63]
ds_read_b64_tr_b16 a[4:5], v232 offset:35840
ds_read_b64_tr_b16 a[6:7], v232 offset:36352
v_mfma_f32_32x32x16_bf16 v[128:143], a[16:19], v[124:127], v[128:143]
ds_read_b64_tr_b16 a[8:9], v234 offset:28672
ds_read_b64_tr_b16 a[10:11], v234 offset:29184
v_mfma_f32_32x32x16_bf16 a[32:47], a[20:23], v[124:127], a[32:47]
ds_read_b64_tr_b16 a[12:13], v234 offset:35840
ds_read_b64_tr_b16 a[14:15], v234 offset:36352
v_add_u32 v2, s70, v5
s_add_u32 m0, s72, 57344
v_mfma_f32_32x32x16_bf16 v[144:159], a[24:27], v[124:127], v[144:159]
ds_read_b64_tr_b16 a[16:17], v232 offset:29696
ds_read_b64_tr_b16 a[18:19], v232 offset:30208
buffer_load_dwordx4 v2, s[36:39], s48 offen offset:0 lds
v_add_u32 v8, 0x10000, v236
v_mfma_f32_32x32x16_bf16 a[48:63], a[28:31], v[124:127], a[48:63]
ds_read_b64_tr_b16 a[20:21], v232 offset:36864
ds_read_b64_tr_b16 a[22:23], v232 offset:37376
buffer_load_dwordx4 v2, s[36:39], s49 offen offset:1024 lds
v_add_u32 v9, 0x10000, v237
s_waitcnt lgkmcnt(4)
v_mfma_f32_32x32x16_bf16 v[160:175], a[0:3], v[16:19], 0
ds_read_b64_tr_b16 a[24:25], v234 offset:29696
ds_read_b64_tr_b16 a[26:27], v234 offset:30208
buffer_load_dwordx4 v2, s[36:39], s50 offen offset:2048 lds
v_mfma_f32_32x32x16_bf16 a[64:79], a[4:7], v[16:19], 0
ds_read_b64_tr_b16 a[28:29], v234 offset:36864
ds_read_b64_tr_b16 a[30:31], v234 offset:37376
v_mfma_f32_32x32x16_bf16 v[176:191], a[8:11], v[16:19], 0
ds_read_b64_tr_b16 a[0:1], v232 offset:30720
ds_read_b64_tr_b16 a[2:3], v232 offset:31232
buffer_load_dwordx4 v2, s[36:39], s51 offen offset:3072 lds
s_add_u32 m0, s72, 61440
v_mfma_f32_32x32x16_bf16 a[80:95], a[12:15], v[16:19], 0
ds_read_b64_tr_b16 a[4:5], v232 offset:37888
ds_read_b64_tr_b16 a[6:7], v232 offset:38400
buffer_load_dwordx4 v2, s[36:39], s52 offen offset:0 lds
v_mul_f32 v244, v128, v128
v_mul_f32 v245, v129, v129
v_mul_f32 v246, v130, v130
v_mul_f32 v247, v131, v131
v_fma_f32 v244, v244, v12, v11
v_fma_f32 v245, v245, v12, v11
v_fma_f32 v246, v246, v12, v11
v_fma_f32 v247, v247, v12, v11
v_mul_f32 v244, v244, v128
v_mul_f32 v245, v245, v129
v_mul_f32 v246, v246, v130
s_waitcnt lgkmcnt(4)
v_mfma_f32_32x32x16_bf16 v[160:175], a[16:19], v[20:23], v[160:175]
ds_read_b64_tr_b16 a[8:9], v234 offset:30720
ds_read_b64_tr_b16 a[10:11], v234 offset:31232
v_mul_f32 v247, v247, v131
v_accvgpr_read_b32 v240, a32
v_accvgpr_read_b32 v241, a33
v_accvgpr_read_b32 v242, a34
v_accvgpr_read_b32 v243, a35
v_exp_f32 v244, v244
v_exp_f32 v245, v245
v_exp_f32 v246, v246
v_mfma_f32_32x32x16_bf16 a[64:79], a[20:23], v[20:23], a[64:79]
ds_read_b64_tr_b16 a[12:13], v234 offset:37888
ds_read_b64_tr_b16 a[14:15], v234 offset:38400
buffer_load_dwordx4 v2, s[36:39], s53 offen offset:1024 lds
v_exp_f32 v247, v247
v_mul_f32 v128, v128, v240
v_mul_f32 v129, v129, v241
v_mul_f32 v130, v130, v242
v_mul_f32 v131, v131, v243
v_fma_f32 v244, v244, v13, v13
v_fma_f32 v245, v245, v13, v13
v_fma_f32 v246, v246, v13, v13
v_fma_f32 v247, v247, v13, v13
v_rcp_f32 v244, v244
v_mfma_f32_32x32x16_bf16 v[176:191], a[24:27], v[20:23], v[176:191]
ds_read_b64_tr_b16 a[16:17], v232 offset:31744
ds_read_b64_tr_b16 a[18:19], v232 offset:32256
buffer_load_dwordx4 v2, s[36:39], s54 offen offset:2048 lds
v_rcp_f32 v245, v245
v_rcp_f32 v246, v246
v_rcp_f32 v247, v247
v_mul_f32 v128, v128, v244
v_mul_f32 v129, v129, v245
v_mul_f32 v130, v130, v246
v_mul_f32 v131, v131, v247
v_mfma_f32_32x32x16_bf16 a[80:95], a[28:31], v[20:23], a[80:95]
ds_read_b64_tr_b16 a[20:21], v232 offset:38912
ds_read_b64_tr_b16 a[22:23], v232 offset:39424
v_cvt_pk_bf16_f32 v248, v128, v129
v_cvt_pk_bf16_f32 v249, v130, v131
v_mul_f32 v244, v132, v132
v_mul_f32 v245, v133, v133
v_mul_f32 v246, v134, v134
v_mul_f32 v247, v135, v135
v_fma_f32 v244, v244, v12, v11
v_fma_f32 v245, v245, v12, v11
v_fma_f32 v246, v246, v12, v11
v_fma_f32 v247, v247, v12, v11
v_mul_f32 v244, v244, v132
s_waitcnt lgkmcnt(4)
v_mfma_f32_32x32x16_bf16 v[160:175], a[0:3], v[24:27], v[160:175]
ds_read_b64_tr_b16 a[24:25], v234 offset:31744
ds_read_b64_tr_b16 a[26:27], v234 offset:32256
v_mul_f32 v245, v245, v133
v_mul_f32 v246, v246, v134
v_mul_f32 v247, v247, v135
v_accvgpr_read_b32 v240, a36
v_accvgpr_read_b32 v241, a37
v_accvgpr_read_b32 v242, a38
v_accvgpr_read_b32 v243, a39
v_exp_f32 v244, v244
v_exp_f32 v245, v245
v_mfma_f32_32x32x16_bf16 a[64:79], a[4:7], v[24:27], a[64:79]
ds_read_b64_tr_b16 a[28:29], v234 offset:38912
ds_read_b64_tr_b16 a[30:31], v234 offset:39424
v_exp_f32 v246, v246
v_exp_f32 v247, v247
v_mul_f32 v132, v132, v240
v_mul_f32 v133, v133, v241
v_mul_f32 v134, v134, v242
v_mul_f32 v135, v135, v243
v_fma_f32 v244, v244, v13, v13
v_fma_f32 v245, v245, v13, v13
v_fma_f32 v246, v246, v13, v13
s_add_u32 m0, s73, 24576
s_add_u32 s11, s15, 28672
v_mfma_f32_32x32x16_bf16 v[176:191], a[8:11], v[24:27], v[176:191]
ds_read_b64_tr_b16 a[0:1], v232 offset:32768
ds_read_b64_tr_b16 a[2:3], v232 offset:33280
buffer_load_dwordx4 v6, s[28:31], s11 offen lds
buffer_load_dwordx4 v7, s[28:31], s11 offen offset:1024 lds
v_fma_f32 v247, v247, v13, v13
v_rcp_f32 v244, v244
v_rcp_f32 v245, v245
v_rcp_f32 v246, v246
v_rcp_f32 v247, v247
v_mul_f32 v132, v132, v244
v_mul_f32 v133, v133, v245
v_mfma_f32_32x32x16_bf16 a[80:95], a[12:15], v[24:27], a[80:95]
ds_read_b64_tr_b16 a[4:5], v232 offset:39936
ds_read_b64_tr_b16 a[6:7], v232 offset:40448
v_mul_f32 v134, v134, v246
v_mul_f32 v135, v135, v247
v_cvt_pk_bf16_f32 v250, v132, v133
v_cvt_pk_bf16_f32 v251, v134, v135
s_waitcnt vmcnt(13) lgkmcnt(4)
v_mfma_f32_32x32x16_bf16 v[160:175], a[16:19], v[28:31], v[160:175]
ds_read_b64_tr_b16 a[8:9], v234 offset:32768
ds_read_b64_tr_b16 a[10:11], v234 offset:33280
ds_read_b64_tr_b16 a[184:185], v236 offset:0
ds_read_b64_tr_b16 a[186:187], v236 offset:1024
ds_read_b64_tr_b16 a[188:189], v237 offset:0
ds_read_b64_tr_b16 a[190:191], v237 offset:1024
buffer_store_dwordx4 v[248:251], v1, s[40:43], s74 offen offset:0 sc1
v_mul_f32 v244, v136, v136
v_mul_f32 v245, v137, v137
v_mul_f32 v246, v138, v138
v_mul_f32 v247, v139, v139
v_fma_f32 v244, v244, v12, v11
v_fma_f32 v245, v245, v12, v11
v_fma_f32 v246, v246, v12, v11
v_fma_f32 v247, v247, v12, v11
v_mul_f32 v244, v244, v136
v_mul_f32 v245, v245, v137
v_mul_f32 v246, v246, v138
v_mul_f32 v247, v247, v139
v_accvgpr_read_b32 v240, a40
v_accvgpr_read_b32 v241, a41
v_accvgpr_read_b32 v242, a42
v_accvgpr_read_b32 v243, a43
v_exp_f32 v244, v244
v_max3_u32 v230, v192, v193, v194
v_mov_b32 v231, v195
v_max_u32 v230, v230, v231
v_cmp_eq_u32 vcc, -1, v230
v_mfma_f32_32x32x16_bf16 a[64:79], a[20:23], v[28:31], a[64:79]
ds_read_b64_tr_b16 a[12:13], v234 offset:39936
ds_read_b64_tr_b16 a[14:15], v234 offset:40448
v_exp_f32 v245, v245
v_exp_f32 v246, v246
v_exp_f32 v247, v247
v_mul_f32 v136, v136, v240
v_mul_f32 v137, v137, v241
v_mul_f32 v138, v138, v242
v_mul_f32 v139, v139, v243
s_cbranch_vccnz L_spin1
L_ok1:
v_add_f32_dpp v192, v192, v192 row_ror:4 row_mask:0xf bank_mask:0xf
v_add_f32_dpp v193, v193, v193 row_ror:4 row_mask:0xf bank_mask:0xf
v_add_f32_dpp v194, v194, v194 row_ror:4 row_mask:0xf bank_mask:0xf
s_add_u32 m0, s73, 32768
s_add_u32 s11, s15, 43008
v_mfma_f32_32x32x16_bf16 v[176:191], a[24:27], v[28:31], v[176:191]
ds_read_b64_tr_b16 a[16:17], v232 offset:33792
ds_read_b64_tr_b16 a[18:19], v232 offset:34304
buffer_load_dwordx4 v6, s[28:31], s11 offen lds
buffer_load_dwordx4 v7, s[28:31], s11 offen offset:1024 lds
v_fma_f32 v244, v244, v13, v13
v_fma_f32 v245, v245, v13, v13
v_fma_f32 v246, v246, v13, v13
v_fma_f32 v247, v247, v13, v13
v_rcp_f32 v244, v244
v_rcp_f32 v245, v245
v_rcp_f32 v246, v246
v_rcp_f32 v247, v247
v_add_f32_dpp v195, v195, v195 row_ror:4 row_mask:0xf bank_mask:0xf
v_add_f32_dpp v192, v192, v192 row_ror:8 row_mask:0xf bank_mask:0xf
v_add_f32_dpp v193, v193, v193 row_ror:8 row_mask:0xf bank_mask:0xf
v_add_f32_dpp v194, v194, v194 row_ror:8 row_mask:0xf bank_mask:0xf
v_mfma_f32_32x32x16_bf16 a[80:95], a[28:31], v[28:31], a[80:95]
ds_read_b64_tr_b16 a[20:21], v232 offset:40960
ds_read_b64_tr_b16 a[22:23], v232 offset:41472
v_mul_f32 v136, v136, v244
v_mul_f32 v137, v137, v245
v_mul_f32 v138, v138, v246
v_mul_f32 v139, v139, v247
v_cvt_pk_bf16_f32 v252, v136, v137
v_cvt_pk_bf16_f32 v253, v138, v139
v_mul_f32 v244, v140, v140
v_mul_f32 v245, v141, v141
v_mul_f32 v246, v142, v142
v_mul_f32 v247, v143, v143
v_add_f32_dpp v195, v195, v195 row_ror:8 row_mask:0xf bank_mask:0xf
v_mov_b32 v196, v192
v_mov_b32 v197, v193
v_mov_b32 v198, v194
s_waitcnt vmcnt(14) lgkmcnt(4)
v_mfma_f32_32x32x16_bf16 v[160:175], a[0:3], v[32:35], v[160:175]
ds_read_b64_tr_b16 a[24:25], v234 offset:33792
ds_read_b64_tr_b16 a[26:27], v234 offset:34304
ds_read_b64_tr_b16 a[192:193], v236 offset:8192
ds_read_b64_tr_b16 a[194:195], v236 offset:9216
ds_read_b64_tr_b16 a[196:197], v237 offset:8192
ds_read_b64_tr_b16 a[198:199], v237 offset:9216
v_fma_f32 v244, v244, v12, v11
v_fma_f32 v245, v245, v12, v11
v_fma_f32 v246, v246, v12, v11
v_fma_f32 v247, v247, v12, v11
v_mul_f32 v244, v244, v140
v_mul_f32 v245, v245, v141
v_mul_f32 v246, v246, v142
v_mul_f32 v247, v247, v143
v_accvgpr_read_b32 v240, a44
v_accvgpr_read_b32 v241, a45
v_accvgpr_read_b32 v242, a46
v_mov_b32 v199, v195
v_permlane16_swap_b32 v192, v196
v_permlane16_swap_b32 v193, v197
v_permlane16_swap_b32 v194, v198
v_mfma_f32_32x32x16_bf16 a[64:79], a[4:7], v[32:35], a[64:79]
ds_read_b64_tr_b16 a[28:29], v234 offset:40960
ds_read_b64_tr_b16 a[30:31], v234 offset:41472
v_accvgpr_read_b32 v243, a47
v_exp_f32 v244, v244
v_exp_f32 v245, v245
v_exp_f32 v246, v246
v_exp_f32 v247, v247
v_mul_f32 v140, v140, v240
v_mul_f32 v141, v141, v241
v_permlane16_swap_b32 v195, v199
v_add_f32 v192, v192, v196
v_add_f32 v193, v193, v197
v_add_f32 v194, v194, v198
s_add_u32 m0, s73, 0
s_add_u32 s11, s20, 0
v_mfma_f32_32x32x16_bf16 v[176:191], a[8:11], v[32:35], v[176:191]
ds_read_b64_tr_b16 a[0:1], v232 offset:34816
ds_read_b64_tr_b16 a[2:3], v232 offset:35328
buffer_load_dwordx4 v6, s[28:31], s11 offen lds
buffer_load_dwordx4 v7, s[28:31], s11 offen offset:1024 lds
v_mul_f32 v142, v142, v242
v_mul_f32 v143, v143, v243
v_fma_f32 v244, v244, v13, v13
v_fma_f32 v245, v245, v13, v13
v_fma_f32 v246, v246, v13, v13
v_fma_f32 v247, v247, v13, v13
v_rcp_f32 v244, v244
v_rcp_f32 v245, v245
v_rcp_f32 v246, v246
v_add_f32 v195, v195, v199
v_mov_b32 v196, v192
v_mov_b32 v197, v193
v_mov_b32 v198, v194
v_mfma_f32_32x32x16_bf16 a[80:95], a[12:15], v[32:35], a[80:95]
ds_read_b64_tr_b16 a[4:5], v232 offset:41984
ds_read_b64_tr_b16 a[6:7], v232 offset:42496
v_rcp_f32 v247, v247
v_mul_f32 v140, v140, v244
v_mul_f32 v141, v141, v245
v_mul_f32 v142, v142, v246
v_mul_f32 v143, v143, v247
v_cvt_pk_bf16_f32 v254, v140, v141
v_cvt_pk_bf16_f32 v255, v142, v143
v_mov_b32 v199, v195
v_permlane32_swap_b32 v192, v196
v_permlane32_swap_b32 v193, v197
v_permlane32_swap_b32 v194, v198
s_waitcnt vmcnt(14) lgkmcnt(4)
v_mfma_f32_32x32x16_bf16 v[160:175], a[16:19], v[36:39], v[160:175]
ds_read_b64_tr_b16 a[8:9], v234 offset:34816
ds_read_b64_tr_b16 a[10:11], v234 offset:35328
ds_read_b64_tr_b16 a[200:201], v236 offset:16384
ds_read_b64_tr_b16 a[202:203], v236 offset:17408
ds_read_b64_tr_b16 a[204:205], v237 offset:16384
ds_read_b64_tr_b16 a[206:207], v237 offset:17408
buffer_store_dwordx4 v[252:255], v1, s[40:43], s74 offen offset:1024 sc1
v_mul_f32 v244, v144, v144
v_mul_f32 v245, v145, v145
v_mul_f32 v246, v146, v146
v_permlane32_swap_b32 v195, v199
v_add_f32 v192, v192, v196
v_add_f32 v193, v193, v197
v_add_f32 v194, v194, v198
v_mfma_f32_32x32x16_bf16 a[64:79], a[20:23], v[36:39], a[64:79]
ds_read_b64_tr_b16 a[12:13], v234 offset:41984
ds_read_b64_tr_b16 a[14:15], v234 offset:42496
v_mul_f32 v247, v147, v147
v_fma_f32 v244, v244, v12, v11
v_fma_f32 v245, v245, v12, v11
v_add_f32 v195, v195, v199
v_cvt_pk_bf16_f32 v196, v192, v193
v_cvt_pk_bf16_f32 v197, v194, v195
v_mfma_f32_32x32x16_bf16 v[176:191], a[24:27], v[36:39], v[176:191]
s_waitcnt lgkmcnt(0)
s_barrier
ds_read_b64_tr_b16 a[16:17], v233 offset:0
ds_read_b64_tr_b16 a[18:19], v233 offset:512
buffer_store_dwordx2 v[196:197], v238, s[40:43], s7 offen sc1
v_fma_f32 v246, v246, v12, v11
v_fma_f32 v247, v247, v12, v11
v_mul_f32 v244, v244, v144
v_mfma_f32_32x32x16_bf16 a[80:95], a[28:31], v[36:39], a[80:95]
ds_read_b64_tr_b16 a[20:21], v233 offset:7168
ds_read_b64_tr_b16 a[22:23], v233 offset:7680
v_mul_f32 v245, v245, v145
v_mul_f32 v246, v246, v146
v_mul_f32 v247, v247, v147
v_mfma_f32_32x32x16_bf16 v[160:175], a[0:3], v[40:43], v[160:175]
ds_read_b64_tr_b16 a[24:25], v235 offset:0
ds_read_b64_tr_b16 a[26:27], v235 offset:512
v_accvgpr_read_b32 v240, a48
v_accvgpr_read_b32 v241, a49
v_accvgpr_read_b32 v242, a50
v_mfma_f32_32x32x16_bf16 a[64:79], a[4:7], v[40:43], a[64:79]
ds_read_b64_tr_b16 a[28:29], v235 offset:7168
ds_read_b64_tr_b16 a[30:31], v235 offset:7680
v_accvgpr_read_b32 v243, a51
v_exp_f32 v244, v244
v_add_u32 v2, s71, v5
s_add_u32 m0, s72, 86016
v_mfma_f32_32x32x16_bf16 v[176:191], a[8:11], v[40:43], v[176:191]
ds_read_b64_tr_b16 a[0:1], v233 offset:1024
ds_read_b64_tr_b16 a[2:3], v233 offset:1536
buffer_load_dwordx4 v2, s[36:39], s48 offen offset:0 lds
v_exp_f32 v245, v245
v_mfma_f32_32x32x16_bf16 a[80:95], a[12:15], v[40:43], a[80:95]
ds_read_b64_tr_b16 a[4:5], v233 offset:8192
ds_read_b64_tr_b16 a[6:7], v233 offset:8704
buffer_load_dwordx4 v2, s[36:39], s49 offen offset:1024 lds
v_exp_f32 v246, v246
v_exp_f32 v247, v247
s_waitcnt lgkmcnt(4)
v_mfma_f32_32x32x16_bf16 v[160:175], a[16:19], v[44:47], v[160:175]
ds_read_b64_tr_b16 a[8:9], v235 offset:1024
ds_read_b64_tr_b16 a[10:11], v235 offset:1536
buffer_load_dwordx4 v2, s[36:39], s50 offen offset:2048 lds
v_mul_f32 v144, v144, v240
v_mul_f32 v145, v145, v241
v_mfma_f32_32x32x16_bf16 a[64:79], a[20:23], v[44:47], a[64:79]
ds_read_b64_tr_b16 a[12:13], v235 offset:8192
ds_read_b64_tr_b16 a[14:15], v235 offset:8704
v_mul_f32 v146, v146, v242
v_mul_f32 v147, v147, v243
v_fma_f32 v244, v244, v13, v13
v_mfma_f32_32x32x16_bf16 v[176:191], a[24:27], v[44:47], v[176:191]
ds_read_b64_tr_b16 a[16:17], v233 offset:2048
ds_read_b64_tr_b16 a[18:19], v233 offset:2560
buffer_load_dwordx4 v2, s[36:39], s51 offen offset:3072 lds
v_fma_f32 v245, v245, v13, v13
v_fma_f32 v246, v246, v13, v13
s_add_u32 m0, s72, 90112
v_mfma_f32_32x32x16_bf16 a[80:95], a[28:31], v[44:47], a[80:95]
ds_read_b64_tr_b16 a[20:21], v233 offset:9216
ds_read_b64_tr_b16 a[22:23], v233 offset:9728
buffer_load_dwordx4 v2, s[36:39], s52 offen offset:0 lds
v_fma_f32 v247, v247, v13, v13
v_rcp_f32 v244, v244
s_waitcnt lgkmcnt(4)
v_mfma_f32_32x32x16_bf16 v[160:175], a[0:3], v[48:51], v[160:175]
ds_read_b64_tr_b16 a[24:25], v235 offset:2048
ds_read_b64_tr_b16 a[26:27], v235 offset:2560
v_rcp_f32 v245, v245
v_rcp_f32 v246, v246
v_mfma_f32_32x32x16_bf16 a[64:79], a[4:7], v[48:51], a[64:79]
ds_read_b64_tr_b16 a[28:29], v235 offset:9216
ds_read_b64_tr_b16 a[30:31], v235 offset:9728
buffer_load_dwordx4 v2, s[36:39], s53 offen offset:1024 lds
v_rcp_f32 v247, v247
v_mfma_f32_32x32x16_bf16 v[176:191], a[8:11], v[48:51], v[176:191]
ds_read_b64_tr_b16 a[0:1], v233 offset:3072
ds_read_b64_tr_b16 a[2:3], v233 offset:3584
buffer_load_dwordx4 v2, s[36:39], s54 offen offset:2048 lds
v_mul_f32 v144, v144, v244
v_mul_f32 v145, v145, v245
v_mul_f32 v146, v146, v246
v_mfma_f32_32x32x16_bf16 a[80:95], a[12:15], v[48:51], a[80:95]
ds_read_b64_tr_b16 a[4:5], v233 offset:10240
ds_read_b64_tr_b16 a[6:7], v233 offset:10752
v_mul_f32 v147, v147, v247
v_cvt_pk_bf16_f32 v248, v144, v145
v_cvt_pk_bf16_f32 v249, v146, v147
s_waitcnt lgkmcnt(4)
v_mfma_f32_32x32x16_bf16 v[160:175], a[16:19], v[52:55], v[160:175]
ds_read_b64_tr_b16 a[8:9], v235 offset:3072
ds_read_b64_tr_b16 a[10:11], v235 offset:3584
v_mul_f32 v244, v148, v148
v_mul_f32 v245, v149, v149
v_mfma_f32_32x32x16_bf16 a[64:79], a[20:23], v[52:55], a[64:79]
ds_read_b64_tr_b16 a[12:13], v235 offset:10240
ds_read_b64_tr_b16 a[14:15], v235 offset:10752
v_mul_f32 v246, v150, v150
v_mul_f32 v247, v151, v151
v_fma_f32 v244, v244, v12, v11
s_add_u32 m0, s73, 8192
s_add_u32 s11, s20, 14336
v_mfma_f32_32x32x16_bf16 v[176:191], a[24:27], v[52:55], v[176:191]
ds_read_b64_tr_b16 a[16:17], v233 offset:4096
ds_read_b64_tr_b16 a[18:19], v233 offset:4608
buffer_load_dwordx4 v6, s[28:31], s11 offen lds
buffer_load_dwordx4 v7, s[28:31], s11 offen offset:1024 lds
v_fma_f32 v245, v245, v12, v11
v_fma_f32 v246, v246, v12, v11
v_fma_f32 v247, v247, v12, v11
v_mfma_f32_32x32x16_bf16 a[80:95], a[28:31], v[52:55], a[80:95]
ds_read_b64_tr_b16 a[20:21], v233 offset:11264
ds_read_b64_tr_b16 a[22:23], v233 offset:11776
v_mul_f32 v244, v244, v148
v_mul_f32 v245, v245, v149
v_mul_f32 v246, v246, v150
s_waitcnt vmcnt(16) lgkmcnt(4)
v_mfma_f32_32x32x16_bf16 v[160:175], a[0:3], v[56:59], v[160:175]
ds_read_b64_tr_b16 a[24:25], v235 offset:4096
ds_read_b64_tr_b16 a[26:27], v235 offset:4608
ds_read_b64_tr_b16 a[208:209], v236 offset:24576
ds_read_b64_tr_b16 a[210:211], v236 offset:25600
ds_read_b64_tr_b16 a[212:213], v237 offset:24576
ds_read_b64_tr_b16 a[214:215], v237 offset:25600
v_mul_f32 v247, v247, v151
v_accvgpr_read_b32 v240, a52
v_accvgpr_read_b32 v241, a53
v_mfma_f32_32x32x16_bf16 a[64:79], a[4:7], v[56:59], a[64:79]
ds_read_b64_tr_b16 a[28:29], v235 offset:11264
ds_read_b64_tr_b16 a[30:31], v235 offset:11776
v_accvgpr_read_b32 v242, a54
v_accvgpr_read_b32 v243, a55
s_add_u32 m0, s73, 16384
s_add_u32 s11, s21, 0
v_mfma_f32_32x32x16_bf16 v[176:191], a[8:11], v[56:59], v[176:191]
ds_read_b64_tr_b16 a[0:1], v233 offset:5120
ds_read_b64_tr_b16 a[2:3], v233 offset:5632
buffer_load_dwordx4 v6, s[28:31], s11 offen lds
buffer_load_dwordx4 v7, s[28:31], s11 offen offset:1024 lds
v_exp_f32 v244, v244
v_exp_f32 v245, v245
v_mfma_f32_32x32x16_bf16 a[80:95], a[12:15], v[56:59], a[80:95]
ds_read_b64_tr_b16 a[4:5], v233 offset:12288
ds_read_b64_tr_b16 a[6:7], v233 offset:12800
v_exp_f32 v246, v246
s_waitcnt vmcnt(15) lgkmcnt(4)
v_mfma_f32_32x32x16_bf16 v[160:175], a[16:19], v[60:63], v[160:175]
ds_read_b64_tr_b16 a[8:9], v235 offset:5120
ds_read_b64_tr_b16 a[10:11], v235 offset:5632
ds_read_b64_tr_b16 a[216:217], v236 offset:32768
ds_read_b64_tr_b16 a[218:219], v236 offset:33792
ds_read_b64_tr_b16 a[220:221], v237 offset:32768
ds_read_b64_tr_b16 a[222:223], v237 offset:33792
v_exp_f32 v247, v247
v_mul_f32 v148, v148, v240
v_mfma_f32_32x32x16_bf16 a[64:79], a[20:23], v[60:63], a[64:79]
ds_read_b64_tr_b16 a[12:13], v235 offset:12288
ds_read_b64_tr_b16 a[14:15], v235 offset:12800
v_mul_f32 v149, v149, v241
v_mul_f32 v150, v150, v242
v_mul_f32 v151, v151, v243
s_add_u32 m0, s73, 24576
s_add_u32 s11, s21, 14336
v_mfma_f32_32x32x16_bf16 v[176:191], a[24:27], v[60:63], v[176:191]
ds_read_b64_tr_b16 a[16:17], v233 offset:6144
ds_read_b64_tr_b16 a[18:19], v233 offset:6656
buffer_load_dwordx4 v6, s[28:31], s11 offen lds
buffer_load_dwordx4 v7, s[28:31], s11 offen offset:1024 lds
v_fma_f32 v244, v244, v13, v13
v_fma_f32 v245, v245, v13, v13
v_fma_f32 v246, v246, v13, v13
v_mfma_f32_32x32x16_bf16 a[80:95], a[28:31], v[60:63], a[80:95]
ds_read_b64_tr_b16 a[20:21], v233 offset:13312
ds_read_b64_tr_b16 a[22:23], v233 offset:13824
v_fma_f32 v247, v247, v13, v13
v_rcp_f32 v244, v244
s_waitcnt vmcnt(15) lgkmcnt(4)
v_mfma_f32_32x32x16_bf16 v[160:175], a[0:3], v[64:67], v[160:175]
ds_read_b64_tr_b16 a[24:25], v235 offset:6144
ds_read_b64_tr_b16 a[26:27], v235 offset:6656
ds_read_b64_tr_b16 a[224:225], v236 offset:0
ds_read_b64_tr_b16 a[226:227], v236 offset:1024
ds_read_b64_tr_b16 a[228:229], v237 offset:0
ds_read_b64_tr_b16 a[230:231], v237 offset:1024
v_rcp_f32 v245, v245
s_waitcnt vmcnt(14)
v_mov_b32 v225, 1
v_mfma_f32_32x32x16_bf16 a[64:79], a[4:7], v[64:67], a[64:79]
ds_read_b64_tr_b16 a[28:29], v235 offset:13312
ds_read_b64_tr_b16 a[30:31], v235 offset:13824
buffer_store_dword v225, v224, s[40:43], s84 offen sc1
v_rcp_f32 v246, v246
v_rcp_f32 v247, v247
s_add_u32 m0, s73, 32768
s_add_u32 s11, s12, 57344
v_mfma_f32_32x32x16_bf16 v[176:191], a[8:11], v[64:67], v[176:191]
s_waitcnt lgkmcnt(0)
s_barrier
ds_read_b64_tr_b16 a[0:1], v232 offset:0
ds_read_b64_tr_b16 a[2:3], v232 offset:512
buffer_load_dwordx4 v6, s[28:31], s11 offen lds
buffer_load_dwordx4 v7, s[28:31], s11 offen offset:1024 lds
v_mul_f32 v148, v148, v244
v_mul_f32 v149, v149, v245
v_mfma_f32_32x32x16_bf16 a[80:95], a[12:15], v[64:67], a[80:95]
ds_read_b64_tr_b16 a[4:5], v232 offset:7168
ds_read_b64_tr_b16 a[6:7], v232 offset:7680
v_mul_f32 v150, v150, v246
v_mul_f32 v151, v151, v247
v_cvt_pk_bf16_f32 v250, v148, v149
v_mfma_f32_32x32x16_bf16 v[160:175], a[16:19], v[68:71], v[160:175]
ds_read_b64_tr_b16 a[8:9], v234 offset:0
ds_read_b64_tr_b16 a[10:11], v234 offset:512
v_cvt_pk_bf16_f32 v251, v150, v151
v_mfma_f32_32x32x16_bf16 a[64:79], a[20:23], v[68:71], a[64:79]
ds_read_b64_tr_b16 a[12:13], v234 offset:7168
ds_read_b64_tr_b16 a[14:15], v234 offset:7680
buffer_store_dwordx4 v[248:251], v1, s[40:43], s74 offen offset:2048 sc1
v_mul_f32 v244, v152, v152
v_mul_f32 v245, v153, v153
v_mul_f32 v246, v154, v154
s_add_u32 m0, s73, 0
s_add_u32 s11, s12, 71680
v_mfma_f32_32x32x16_bf16 v[176:191], a[24:27], v[68:71], v[176:191]
ds_read_b64_tr_b16 a[16:17], v232 offset:1024
ds_read_b64_tr_b16 a[18:19], v232 offset:1536
buffer_load_dwordx4 v6, s[28:31], s11 offen lds
buffer_load_dwordx4 v7, s[28:31], s11 offen offset:1024 lds
v_mul_f32 v247, v155, v155
v_fma_f32 v244, v244, v12, v11
v_fma_f32 v245, v245, v12, v11
s_mov_b32 s32, s8
s_and_b32 s33, s9, 0xffff
s_mul_i32 s34, s77, 401408
v_mfma_f32_32x32x16_bf16 a[80:95], a[28:31], v[68:71], a[80:95]
ds_read_b64_tr_b16 a[20:21], v232 offset:8192
ds_read_b64_tr_b16 a[22:23], v232 offset:8704
v_fma_f32 v246, v246, v12, v11
v_fma_f32 v247, v247, v12, v11
v_mul_f32 v244, v244, v152
s_mov_b32 s36, s18
s_and_b32 s37, s19, 0xffff
s_mov_b32 s38, 1835008
s_waitcnt lgkmcnt(4)
v_mfma_f32_32x32x16_bf16 v[160:175], a[0:3], v[72:75], v[160:175]
ds_read_b64_tr_b16 a[24:25], v234 offset:1024
ds_read_b64_tr_b16 a[26:27], v234 offset:1536
v_mul_f32 v245, v245, v153
v_mul_f32 v246, v246, v154
v_mul_f32 v247, v247, v155
v_mfma_f32_32x32x16_bf16 a[64:79], a[4:7], v[72:75], a[64:79]
ds_read_b64_tr_b16 a[28:29], v234 offset:8192
ds_read_b64_tr_b16 a[30:31], v234 offset:8704
v_accvgpr_read_b32 v240, a56
v_accvgpr_read_b32 v241, a57
v_accvgpr_read_b32 v242, a58
s_add_u32 m0, s73, 40960
s_add_u32 s11, s13, 57344
v_mfma_f32_32x32x16_bf16 v[176:191], a[8:11], v[72:75], v[176:191]
ds_read_b64_tr_b16 a[0:1], v232 offset:2048
ds_read_b64_tr_b16 a[2:3], v232 offset:2560
buffer_load_dwordx4 v6, s[28:31], s11 offen lds
buffer_load_dwordx4 v7, s[28:31], s11 offen offset:1024 lds
v_accvgpr_read_b32 v243, a59
v_exp_f32 v244, v244
v_mfma_f32_32x32x16_bf16 a[80:95], a[12:15], v[72:75], a[80:95]
ds_read_b64_tr_b16 a[4:5], v232 offset:9216
ds_read_b64_tr_b16 a[6:7], v232 offset:9728
v_exp_f32 v245, v245
s_waitcnt lgkmcnt(4)
v_mfma_f32_32x32x16_bf16 v[160:175], a[16:19], v[76:79], v[160:175]
ds_read_b64_tr_b16 a[8:9], v234 offset:2048
ds_read_b64_tr_b16 a[10:11], v234 offset:2560
v_exp_f32 v246, v246
v_exp_f32 v247, v247
v_mfma_f32_32x32x16_bf16 a[64:79], a[20:23], v[76:79], a[64:79]
ds_read_b64_tr_b16 a[12:13], v234 offset:9216
ds_read_b64_tr_b16 a[14:15], v234 offset:9728
v_mul_f32 v152, v152, v240
v_mul_f32 v153, v153, v241
s_add_u32 m0, s73, 49152
s_add_u32 s11, s13, 71680
v_mfma_f32_32x32x16_bf16 v[176:191], a[24:27], v[76:79], v[176:191]
ds_read_b64_tr_b16 a[16:17], v232 offset:3072
ds_read_b64_tr_b16 a[18:19], v232 offset:3584
buffer_load_dwordx4 v6, s[28:31], s11 offen lds
buffer_load_dwordx4 v7, s[28:31], s11 offen offset:1024 lds
v_mul_f32 v154, v154, v242
v_mul_f32 v155, v155, v243
v_fma_f32 v244, v244, v13, v13
v_mfma_f32_32x32x16_bf16 a[80:95], a[28:31], v[76:79], a[80:95]
ds_read_b64_tr_b16 a[20:21], v232 offset:10240
ds_read_b64_tr_b16 a[22:23], v232 offset:10752
v_fma_f32 v245, v245, v13, v13
v_fma_f32 v246, v246, v13, v13
s_waitcnt lgkmcnt(4)
v_mfma_f32_32x32x16_bf16 v[160:175], a[0:3], v[80:83], v[160:175]
ds_read_b64_tr_b16 a[24:25], v234 offset:3072
ds_read_b64_tr_b16 a[26:27], v234 offset:3584
v_fma_f32 v247, v247, v13, v13
v_rcp_f32 v244, v244
v_mfma_f32_32x32x16_bf16 a[64:79], a[4:7], v[80:83], a[64:79]
ds_read_b64_tr_b16 a[28:29], v234 offset:10240
ds_read_b64_tr_b16 a[30:31], v234 offset:10752
v_rcp_f32 v245, v245
v_rcp_f32 v246, v246
s_add_u32 m0, s73, 114688
s_add_u32 s11, s22, 0
v_mfma_f32_32x32x16_bf16 v[176:191], a[8:11], v[80:83], v[176:191]
ds_read_b64_tr_b16 a[0:1], v232 offset:4096
ds_read_b64_tr_b16 a[2:3], v232 offset:4608
buffer_load_dwordx4 v6, s[32:35], s11 offen lds
buffer_load_dwordx4 v7, s[32:35], s11 offen offset:1024 lds
v_rcp_f32 v247, v247
v_mfma_f32_32x32x16_bf16 a[80:95], a[12:15], v[80:83], a[80:95]
ds_read_b64_tr_b16 a[4:5], v232 offset:11264
ds_read_b64_tr_b16 a[6:7], v232 offset:11776
v_mul_f32 v152, v152, v244
v_mul_f32 v153, v153, v245
v_mul_f32 v154, v154, v246
s_waitcnt vmcnt(16) lgkmcnt(4)
v_mfma_f32_32x32x16_bf16 v[160:175], a[16:19], v[84:87], v[160:175]
ds_read_b64_tr_b16 a[8:9], v234 offset:4096
ds_read_b64_tr_b16 a[10:11], v234 offset:4608
ds_read_b64_tr_b16 a[232:233], v236 offset:8192
ds_read_b64_tr_b16 a[234:235], v236 offset:9216
ds_read_b64_tr_b16 a[236:237], v237 offset:8192
ds_read_b64_tr_b16 a[238:239], v237 offset:9216
v_mul_f32 v155, v155, v247
v_cvt_pk_bf16_f32 v252, v152, v153
v_cvt_pk_bf16_f32 v253, v154, v155
v_mfma_f32_32x32x16_bf16 a[64:79], a[20:23], v[84:87], a[64:79]
ds_read_b64_tr_b16 a[12:13], v234 offset:11264
ds_read_b64_tr_b16 a[14:15], v234 offset:11776
v_mul_f32 v244, v156, v156
v_mul_f32 v245, v157, v157
s_add_u32 m0, s73, 122880
s_add_u32 s11, s22, 14336
v_mfma_f32_32x32x16_bf16 v[176:191], a[24:27], v[84:87], v[176:191]
ds_read_b64_tr_b16 a[16:17], v232 offset:5120
ds_read_b64_tr_b16 a[18:19], v232 offset:5632
buffer_load_dwordx4 v6, s[32:35], s11 offen lds
buffer_load_dwordx4 v7, s[32:35], s11 offen offset:1024 lds
v_mul_f32 v246, v158, v158
v_mul_f32 v247, v159, v159
v_fma_f32 v244, v244, v12, v11
v_mfma_f32_32x32x16_bf16 a[80:95], a[28:31], v[84:87], a[80:95]
ds_read_b64_tr_b16 a[20:21], v232 offset:12288
ds_read_b64_tr_b16 a[22:23], v232 offset:12800
v_fma_f32 v245, v245, v12, v11
v_fma_f32 v246, v246, v12, v11
v_fma_f32 v247, v247, v12, v11
s_waitcnt vmcnt(16) lgkmcnt(4)
v_mfma_f32_32x32x16_bf16 v[160:175], a[0:3], v[88:91], v[160:175]
ds_read_b64_tr_b16 a[24:25], v234 offset:5120
ds_read_b64_tr_b16 a[26:27], v234 offset:5632
ds_read_b64_tr_b16 a[240:241], v236 offset:16384
ds_read_b64_tr_b16 a[242:243], v236 offset:17408
ds_read_b64_tr_b16 a[244:245], v237 offset:16384
ds_read_b64_tr_b16 a[246:247], v237 offset:17408
v_mul_f32 v244, v244, v156
v_mul_f32 v245, v245, v157
v_mul_f32 v246, v246, v158
v_mfma_f32_32x32x16_bf16 a[64:79], a[4:7], v[88:91], a[64:79]
ds_read_b64_tr_b16 a[28:29], v234 offset:12288
ds_read_b64_tr_b16 a[30:31], v234 offset:12800
v_mul_f32 v247, v247, v159
v_accvgpr_read_b32 v240, a60
v_accvgpr_read_b32 v241, a61
s_add_u32 m0, s73, 8192
s_add_u32 s11, s23, 0
v_mfma_f32_32x32x16_bf16 v[176:191], a[8:11], v[88:91], v[176:191]
ds_read_b64_tr_b16 a[0:1], v232 offset:6144
ds_read_b64_tr_b16 a[2:3], v232 offset:6656
buffer_load_dwordx4 v6, s[32:35], s11 offen lds
buffer_load_dwordx4 v7, s[32:35], s11 offen offset:1024 lds
v_accvgpr_read_b32 v242, a62
v_accvgpr_read_b32 v243, a63
v_mfma_f32_32x32x16_bf16 a[80:95], a[12:15], v[88:91], a[80:95]
ds_read_b64_tr_b16 a[4:5], v232 offset:13312
ds_read_b64_tr_b16 a[6:7], v232 offset:13824
v_exp_f32 v244, v244
v_exp_f32 v245, v245
s_waitcnt lgkmcnt(4)
v_mfma_f32_32x32x16_bf16 v[160:175], a[16:19], v[92:95], v[160:175]
ds_read_b64_tr_b16 a[8:9], v234 offset:6144
ds_read_b64_tr_b16 a[10:11], v234 offset:6656
v_exp_f32 v246, v246
v_mfma_f32_32x32x16_bf16 a[64:79], a[20:23], v[92:95], a[64:79]
ds_read_b64_tr_b16 a[12:13], v234 offset:13312
ds_read_b64_tr_b16 a[14:15], v234 offset:13824
v_exp_f32 v247, v247
v_mul_f32 v156, v156, v240
s_add_u32 m0, s73, 16384
s_add_u32 s11, s23, 14336
v_mfma_f32_32x32x16_bf16 v[176:191], a[24:27], v[92:95], v[176:191]
s_waitcnt lgkmcnt(0)
s_barrier
ds_read_b64_tr_b16 a[16:17], v232 offset:28672
ds_read_b64_tr_b16 a[18:19], v232 offset:29184
buffer_load_dwordx4 v6, s[32:35], s11 offen lds
buffer_load_dwordx4 v7, s[32:35], s11 offen offset:1024 lds
v_mul_f32 v157, v157, v241
v_mul_f32 v158, v158, v242
v_mul_f32 v159, v159, v243
v_mfma_f32_32x32x16_bf16 a[80:95], a[28:31], v[92:95], a[80:95]
ds_read_b64_tr_b16 a[20:21], v232 offset:35840
ds_read_b64_tr_b16 a[22:23], v232 offset:36352
v_fma_f32 v244, v244, v13, v13
v_fma_f32 v245, v245, v13, v13
v_fma_f32 v246, v246, v13, v13
v_mfma_f32_32x32x16_bf16 v[160:175], a[0:3], v[96:99], v[160:175]
ds_read_b64_tr_b16 a[24:25], v234 offset:28672
ds_read_b64_tr_b16 a[26:27], v234 offset:29184
v_fma_f32 v247, v247, v13, v13
v_rcp_f32 v244, v244
v_mfma_f32_32x32x16_bf16 a[64:79], a[4:7], v[96:99], a[64:79]
ds_read_b64_tr_b16 a[28:29], v234 offset:35840
ds_read_b64_tr_b16 a[30:31], v234 offset:36352
v_rcp_f32 v245, v245
s_add_u32 m0, s73, 57344
s_add_u32 s11, s12, 86016
v_mfma_f32_32x32x16_bf16 v[176:191], a[8:11], v[96:99], v[176:191]
ds_read_b64_tr_b16 a[0:1], v232 offset:29696
ds_read_b64_tr_b16 a[2:3], v232 offset:30208
buffer_load_dwordx4 v6, s[28:31], s11 offen lds
buffer_load_dwordx4 v7, s[28:31], s11 offen offset:1024 lds
v_rcp_f32 v246, v246
v_rcp_f32 v247, v247
v_mfma_f32_32x32x16_bf16 a[80:95], a[12:15], v[96:99], a[80:95]
ds_read_b64_tr_b16 a[4:5], v232 offset:36864
ds_read_b64_tr_b16 a[6:7], v232 offset:37376
v_mul_f32 v156, v156, v244
v_mul_f32 v157, v157, v245
s_waitcnt lgkmcnt(4)
v_mfma_f32_32x32x16_bf16 v[160:175], a[16:19], v[100:103], v[160:175]
ds_read_b64_tr_b16 a[8:9], v234 offset:29696
ds_read_b64_tr_b16 a[10:11], v234 offset:30208
v_mul_f32 v158, v158, v246
v_mul_f32 v159, v159, v247
v_cvt_pk_bf16_f32 v254, v156, v157
v_mfma_f32_32x32x16_bf16 a[64:79], a[20:23], v[100:103], a[64:79]
ds_read_b64_tr_b16 a[12:13], v234 offset:36864
ds_read_b64_tr_b16 a[14:15], v234 offset:37376
v_cvt_pk_bf16_f32 v255, v158, v159
s_add_u32 m0, s73, 65536
s_add_u32 s11, s12, 100352
v_mfma_f32_32x32x16_bf16 v[176:191], a[24:27], v[100:103], v[176:191]
ds_read_b64_tr_b16 a[16:17], v232 offset:30720
ds_read_b64_tr_b16 a[18:19], v232 offset:31232
buffer_store_dwordx4 v[252:255], v1, s[40:43], s74 offen offset:3072 sc1
buffer_load_dwordx4 v6, s[28:31], s11 offen lds
buffer_load_dwordx4 v7, s[28:31], s11 offen offset:1024 lds
v_mfma_f32_32x32x16_bf16 a[80:95], a[28:31], v[100:103], a[80:95]
ds_read_b64_tr_b16 a[20:21], v232 offset:37888
ds_read_b64_tr_b16 a[22:23], v232 offset:38400
s_waitcnt lgkmcnt(4)
v_mfma_f32_32x32x16_bf16 v[160:175], a[0:3], v[104:107], v[160:175]
ds_read_b64_tr_b16 a[24:25], v234 offset:30720
ds_read_b64_tr_b16 a[26:27], v234 offset:31232
v_mfma_f32_32x32x16_bf16 a[64:79], a[4:7], v[104:107], a[64:79]
ds_read_b64_tr_b16 a[28:29], v234 offset:37888
ds_read_b64_tr_b16 a[30:31], v234 offset:38400
s_add_u32 m0, s73, 73728
s_add_u32 s11, s13, 86016
v_mfma_f32_32x32x16_bf16 v[176:191], a[8:11], v[104:107], v[176:191]
ds_read_b64_tr_b16 a[0:1], v232 offset:31744
ds_read_b64_tr_b16 a[2:3], v232 offset:32256
buffer_load_dwordx4 v6, s[28:31], s11 offen lds
buffer_load_dwordx4 v7, s[28:31], s11 offen offset:1024 lds
v_mfma_f32_32x32x16_bf16 a[80:95], a[12:15], v[104:107], a[80:95]
ds_read_b64_tr_b16 a[4:5], v232 offset:38912
ds_read_b64_tr_b16 a[6:7], v232 offset:39424
s_waitcnt lgkmcnt(4)
v_mfma_f32_32x32x16_bf16 v[160:175], a[16:19], v[108:111], v[160:175]
ds_read_b64_tr_b16 a[8:9], v234 offset:31744
ds_read_b64_tr_b16 a[10:11], v234 offset:32256
v_mfma_f32_32x32x16_bf16 a[64:79], a[20:23], v[108:111], a[64:79]
ds_read_b64_tr_b16 a[12:13], v234 offset:38912
ds_read_b64_tr_b16 a[14:15], v234 offset:39424
s_add_u32 m0, s73, 131072
s_add_u32 s11, s13, 100352
v_mfma_f32_32x32x16_bf16 v[176:191], a[24:27], v[108:111], v[176:191]
ds_read_b64_tr_b16 a[16:17], v232 offset:32768
ds_read_b64_tr_b16 a[18:19], v232 offset:33280
buffer_load_dwordx4 v6, s[28:31], s11 offen lds
buffer_load_dwordx4 v7, s[28:31], s11 offen offset:1024 lds
v_mfma_f32_32x32x16_bf16 a[80:95], a[28:31], v[108:111], a[80:95]
ds_read_b64_tr_b16 a[20:21], v232 offset:39936
ds_read_b64_tr_b16 a[22:23], v232 offset:40448
s_waitcnt lgkmcnt(4)
v_mfma_f32_32x32x16_bf16 v[160:175], a[0:3], v[112:115], v[160:175]
ds_read_b64_tr_b16 a[24:25], v234 offset:32768
ds_read_b64_tr_b16 a[26:27], v234 offset:33280
v_mfma_f32_32x32x16_bf16 a[64:79], a[4:7], v[112:115], a[64:79]
ds_read_b64_tr_b16 a[28:29], v234 offset:39936
ds_read_b64_tr_b16 a[30:31], v234 offset:40448
s_add_u32 m0, s73, 143360
s_add_u32 s11, s22, 25088
v_mfma_f32_32x32x16_bf16 v[176:191], a[8:11], v[112:115], v[176:191]
ds_read_b64_tr_b16 a[0:1], v232 offset:33792
ds_read_b64_tr_b16 a[2:3], v232 offset:34304
buffer_load_dwordx4 v6, s[32:35], s11 offen lds
buffer_load_dwordx4 v7, s[32:35], s11 offen offset:1024 lds
v_mfma_f32_32x32x16_bf16 a[80:95], a[12:15], v[112:115], a[80:95]
ds_read_b64_tr_b16 a[4:5], v232 offset:40960
ds_read_b64_tr_b16 a[6:7], v232 offset:41472
s_waitcnt lgkmcnt(4)
v_mfma_f32_32x32x16_bf16 v[160:175], a[16:19], v[116:119], v[160:175]
ds_read_b64_tr_b16 a[8:9], v234 offset:33792
ds_read_b64_tr_b16 a[10:11], v234 offset:34304
v_mfma_f32_32x32x16_bf16 a[64:79], a[20:23], v[116:119], a[64:79]
ds_read_b64_tr_b16 a[12:13], v234 offset:40960
ds_read_b64_tr_b16 a[14:15], v234 offset:41472
s_add_u32 m0, s73, 151552
s_add_u32 s11, s22, 39424
v_mfma_f32_32x32x16_bf16 v[176:191], a[24:27], v[116:119], v[176:191]
ds_read_b64_tr_b16 a[16:17], v232 offset:34816
ds_read_b64_tr_b16 a[18:19], v232 offset:35328
buffer_load_dwordx4 v6, s[32:35], s11 offen lds
buffer_load_dwordx4 v7, s[32:35], s11 offen offset:1024 lds
v_mfma_f32_32x32x16_bf16 a[80:95], a[28:31], v[116:119], a[80:95]
ds_read_b64_tr_b16 a[20:21], v232 offset:41984
ds_read_b64_tr_b16 a[22:23], v232 offset:42496
s_waitcnt lgkmcnt(4)
v_mfma_f32_32x32x16_bf16 v[160:175], a[0:3], v[120:123], v[160:175]
ds_read_b64_tr_b16 a[24:25], v234 offset:34816
ds_read_b64_tr_b16 a[26:27], v234 offset:35328
v_mfma_f32_32x32x16_bf16 a[64:79], a[4:7], v[120:123], a[64:79]
ds_read_b64_tr_b16 a[28:29], v234 offset:41984
ds_read_b64_tr_b16 a[30:31], v234 offset:42496
v_mfma_f32_32x32x16_bf16 v[176:191], a[8:11], v[120:123], v[176:191]
s_waitcnt lgkmcnt(0)
s_barrier
v_and_b32 v4, 28, v229
v_mfma_f32_32x32x16_bf16 a[80:95], a[12:15], v[120:123], a[80:95]
buffer_load_dword v227, v4, s[40:43], s85 offen sc1
s_add_u32 m0, s73, 81920
s_add_u32 s11, s23, 25088
v_mfma_f32_32x32x16_bf16 v[160:175], a[16:19], v[124:127], v[160:175]
buffer_load_dwordx4 v6, s[32:35], s11 offen lds
buffer_load_dwordx4 v7, s[32:35], s11 offen offset:1024 lds
v_mfma_f32_32x32x16_bf16 a[64:79], a[20:23], v[124:127], a[64:79]
v_mfma_f32_32x32x16_bf16 v[176:191], a[24:27], v[124:127], v[176:191]
v_mfma_f32_32x32x16_bf16 a[80:95], a[28:31], v[124:127], a[80:95]
v_add_u32 v198, 147456, v1
s_cmp_eq_u32 s77, 0
s_cselect_b32 s92, 0x40000000, 0
s_add_u32 s4, s4, s92
s_add_u32 s5, s5, s92
s_nop 4
s_nop 0
v_accvgpr_read_b32 v240, a64
v_accvgpr_read_b32 v241, a65
v_accvgpr_read_b32 v242, a66
v_accvgpr_read_b32 v243, a67
v_pk_mul_f32 v[244:245], v[160:161], v[160:161]
v_pk_mul_f32 v[246:247], v[162:163], v[162:163]
v_pk_fma_f32 v[244:245], v[244:245], v[12:13], v[10:11] op_sel:[0,0,1] op_sel_hi:[1,0,1]
v_pk_fma_f32 v[246:247], v[246:247], v[12:13], v[10:11] op_sel:[0,0,1] op_sel_hi:[1,0,1]
v_pk_mul_f32 v[244:245], v[244:245], v[160:161]
v_pk_mul_f32 v[246:247], v[246:247], v[162:163]
v_pk_mul_f32 v[160:161], v[160:161], v[240:241]
v_pk_mul_f32 v[162:163], v[162:163], v[242:243]
v_exp_f32 v244, v244
v_exp_f32 v245, v245
v_exp_f32 v246, v246
v_exp_f32 v247, v247
v_pk_fma_f32 v[244:245], v[244:245], v[12:13], v[12:13] op_sel:[0,1,1] op_sel_hi:[1,1,1]
v_pk_fma_f32 v[246:247], v[246:247], v[12:13], v[12:13] op_sel:[0,1,1] op_sel_hi:[1,1,1]
v_rcp_f32 v244, v244
v_rcp_f32 v245, v245
v_rcp_f32 v246, v246
v_rcp_f32 v247, v247
s_waitcnt vmcnt(2)
v_cmp_gt_u32 vcc, 1, v227
s_cbranch_vccnz L_spin3
L_ok3:
s_nop 0
v_pk_mul_f32 v[160:161], v[160:161], v[244:245]
v_pk_mul_f32 v[162:163], v[162:163], v[246:247]
v_cvt_pk_bf16_f32 v248, v160, v161
v_cvt_pk_bf16_f32 v249, v162, v163
v_accvgpr_read_b32 v240, a68
v_accvgpr_read_b32 v241, a69
v_accvgpr_read_b32 v242, a70
v_accvgpr_read_b32 v243, a71
v_pk_mul_f32 v[244:245], v[164:165], v[164:165]
v_pk_mul_f32 v[246:247], v[166:167], v[166:167]
v_pk_fma_f32 v[244:245], v[244:245], v[12:13], v[10:11] op_sel:[0,0,1] op_sel_hi:[1,0,1]
v_pk_fma_f32 v[246:247], v[246:247], v[12:13], v[10:11] op_sel:[0,0,1] op_sel_hi:[1,0,1]
v_pk_mul_f32 v[244:245], v[244:245], v[164:165]
v_pk_mul_f32 v[246:247], v[246:247], v[166:167]
v_pk_mul_f32 v[164:165], v[164:165], v[240:241]
v_pk_mul_f32 v[166:167], v[166:167], v[242:243]
v_exp_f32 v244, v244
v_exp_f32 v245, v245
v_exp_f32 v246, v246
buffer_load_dwordx4 v[16:19], v1, s[40:43], s4 offen offset:0 sc1
buffer_load_dwordx4 v[20:23], v198, s[40:43], s4 offen offset:0 sc1
v_exp_f32 v247, v247
v_pk_fma_f32 v[244:245], v[244:245], v[12:13], v[12:13] op_sel:[0,1,1] op_sel_hi:[1,1,1]
v_pk_fma_f32 v[246:247], v[246:247], v[12:13], v[12:13] op_sel:[0,1,1] op_sel_hi:[1,1,1]
v_rcp_f32 v244, v244
v_rcp_f32 v245, v245
v_rcp_f32 v246, v246
v_rcp_f32 v247, v247
v_pk_mul_f32 v[164:165], v[164:165], v[244:245]
v_pk_mul_f32 v[166:167], v[166:167], v[246:247]
v_cvt_pk_bf16_f32 v250, v164, v165
v_cvt_pk_bf16_f32 v251, v166, v167
buffer_store_dwordx4 v[248:251], v1, s[40:43], s75 offen offset:0 sc1
v_accvgpr_read_b32 v240, a72
v_accvgpr_read_b32 v241, a73
v_accvgpr_read_b32 v242, a74
v_accvgpr_read_b32 v243, a75
v_pk_mul_f32 v[244:245], v[168:169], v[168:169]
buffer_load_dwordx4 v[24:27], v1, s[40:43], s4 offen offset:1024 sc1
buffer_load_dwordx4 v[28:31], v198, s[40:43], s4 offen offset:1024 sc1
v_pk_mul_f32 v[246:247], v[170:171], v[170:171]
v_pk_fma_f32 v[244:245], v[244:245], v[12:13], v[10:11] op_sel:[0,0,1] op_sel_hi:[1,0,1]
v_pk_fma_f32 v[246:247], v[246:247], v[12:13], v[10:11] op_sel:[0,0,1] op_sel_hi:[1,0,1]
v_pk_mul_f32 v[244:245], v[244:245], v[168:169]
v_pk_mul_f32 v[246:247], v[246:247], v[170:171]
v_pk_mul_f32 v[168:169], v[168:169], v[240:241]
v_pk_mul_f32 v[170:171], v[170:171], v[242:243]
v_exp_f32 v244, v244
v_exp_f32 v245, v245
v_exp_f32 v246, v246
v_exp_f32 v247, v247
v_pk_fma_f32 v[244:245], v[244:245], v[12:13], v[12:13] op_sel:[0,1,1] op_sel_hi:[1,1,1]
v_pk_fma_f32 v[246:247], v[246:247], v[12:13], v[12:13] op_sel:[0,1,1] op_sel_hi:[1,1,1]
v_rcp_f32 v244, v244
v_rcp_f32 v245, v245
v_rcp_f32 v246, v246
s_add_u32 s92, s4, 8192
buffer_load_dwordx4 v[32:35], v1, s[40:43], s92 offen offset:0 sc1
buffer_load_dwordx4 v[36:39], v198, s[40:43], s92 offen offset:0 sc1
v_rcp_f32 v247, v247
v_pk_mul_f32 v[168:169], v[168:169], v[244:245]
v_pk_mul_f32 v[170:171], v[170:171], v[246:247]
v_cvt_pk_bf16_f32 v252, v168, v169
v_cvt_pk_bf16_f32 v253, v170, v171
v_accvgpr_read_b32 v240, a76
v_accvgpr_read_b32 v241, a77
v_accvgpr_read_b32 v242, a78
v_accvgpr_read_b32 v243, a79
v_pk_mul_f32 v[244:245], v[172:173], v[172:173]
v_pk_mul_f32 v[246:247], v[174:175], v[174:175]
v_pk_fma_f32 v[244:245], v[244:245], v[12:13], v[10:11] op_sel:[0,0,1] op_sel_hi:[1,0,1]
v_pk_fma_f32 v[246:247], v[246:247], v[12:13], v[10:11] op_sel:[0,0,1] op_sel_hi:[1,0,1]
v_pk_mul_f32 v[244:245], v[244:245], v[172:173]
v_pk_mul_f32 v[246:247], v[246:247], v[174:175]
v_pk_mul_f32 v[172:173], v[172:173], v[240:241]
v_pk_mul_f32 v[174:175], v[174:175], v[242:243]
v_exp_f32 v244, v244
v_exp_f32 v245, v245
s_add_u32 s92, s4, 8192
buffer_load_dwordx4 v[40:43], v1, s[40:43], s92 offen offset:1024 sc1
buffer_load_dwordx4 v[44:47], v198, s[40:43], s92 offen offset:1024 sc1
v_exp_f32 v246, v246
v_exp_f32 v247, v247
v_pk_fma_f32 v[244:245], v[244:245], v[12:13], v[12:13] op_sel:[0,1,1] op_sel_hi:[1,1,1]
v_pk_fma_f32 v[246:247], v[246:247], v[12:13], v[12:13] op_sel:[0,1,1] op_sel_hi:[1,1,1]
v_rcp_f32 v244, v244
v_rcp_f32 v245, v245
v_rcp_f32 v246, v246
v_rcp_f32 v247, v247
v_pk_mul_f32 v[172:173], v[172:173], v[244:245]
v_pk_mul_f32 v[174:175], v[174:175], v[246:247]
v_cvt_pk_bf16_f32 v254, v172, v173
v_cvt_pk_bf16_f32 v255, v174, v175
buffer_store_dwordx4 v[252:255], v1, s[40:43], s75 offen offset:1024 sc1
v_accvgpr_read_b32 v240, a80
v_accvgpr_read_b32 v241, a81
buffer_load_dwordx4 v[48:51], v1, s[40:43], s5 offen offset:0 sc1
buffer_load_dwordx4 v[52:55], v198, s[40:43], s5 offen offset:0 sc1
v_accvgpr_read_b32 v242, a82
v_accvgpr_read_b32 v243, a83
v_pk_mul_f32 v[244:245], v[176:177], v[176:177]
v_pk_mul_f32 v[246:247], v[178:179], v[178:179]
v_pk_fma_f32 v[244:245], v[244:245], v[12:13], v[10:11] op_sel:[0,0,1] op_sel_hi:[1,0,1]
v_pk_fma_f32 v[246:247], v[246:247], v[12:13], v[10:11] op_sel:[0,0,1] op_sel_hi:[1,0,1]
v_pk_mul_f32 v[244:245], v[244:245], v[176:177]
v_pk_mul_f32 v[246:247], v[246:247], v[178:179]
v_pk_mul_f32 v[176:177], v[176:177], v[240:241]
v_pk_mul_f32 v[178:179], v[178:179], v[242:243]
v_exp_f32 v244, v244
v_exp_f32 v245, v245
v_exp_f32 v246, v246
v_exp_f32 v247, v247
v_pk_fma_f32 v[244:245], v[244:245], v[12:13], v[12:13] op_sel:[0,1,1] op_sel_hi:[1,1,1]
v_pk_fma_f32 v[246:247], v[246:247], v[12:13], v[12:13] op_sel:[0,1,1] op_sel_hi:[1,1,1]
v_rcp_f32 v244, v244
buffer_load_dwordx4 v[56:59], v1, s[40:43], s5 offen offset:1024 sc1
buffer_load_dwordx4 v[60:63], v198, s[40:43], s5 offen offset:1024 sc1
v_rcp_f32 v245, v245
v_rcp_f32 v246, v246
v_rcp_f32 v247, v247
v_pk_mul_f32 v[176:177], v[176:177], v[244:245]
v_pk_mul_f32 v[178:179], v[178:179], v[246:247]
v_cvt_pk_bf16_f32 v248, v176, v177
v_cvt_pk_bf16_f32 v249, v178, v179
v_accvgpr_read_b32 v240, a84
v_accvgpr_read_b32 v241, a85
v_accvgpr_read_b32 v242, a86
v_accvgpr_read_b32 v243, a87
v_pk_mul_f32 v[244:245], v[180:181], v[180:181]
v_pk_mul_f32 v[246:247], v[182:183], v[182:183]
v_pk_fma_f32 v[244:245], v[244:245], v[12:13], v[10:11] op_sel:[0,0,1] op_sel_hi:[1,0,1]
v_pk_fma_f32 v[246:247], v[246:247], v[12:13], v[10:11] op_sel:[0,0,1] op_sel_hi:[1,0,1]
v_pk_mul_f32 v[244:245], v[244:245], v[180:181]
v_pk_mul_f32 v[246:247], v[246:247], v[182:183]
v_pk_mul_f32 v[180:181], v[180:181], v[240:241]
v_pk_mul_f32 v[182:183], v[182:183], v[242:243]
s_add_u32 s92, s5, 8192
buffer_load_dwordx4 v[64:67], v1, s[40:43], s92 offen offset:0 sc1
buffer_load_dwordx4 v[68:71], v198, s[40:43], s92 offen offset:0 sc1
v_exp_f32 v244, v244
v_exp_f32 v245, v245
v_exp_f32 v246, v246
v_exp_f32 v247, v247
v_pk_fma_f32 v[244:245], v[244:245], v[12:13], v[12:13] op_sel:[0,1,1] op_sel_hi:[1,1,1]
v_pk_fma_f32 v[246:247], v[246:247], v[12:13], v[12:13] op_sel:[0,1,1] op_sel_hi:[1,1,1]
v_rcp_f32 v244, v244
v_rcp_f32 v245, v245
v_rcp_f32 v246, v246
v_rcp_f32 v247, v247
v_pk_mul_f32 v[180:181], v[180:181], v[244:245]
v_pk_mul_f32 v[182:183], v[182:183], v[246:247]
v_cvt_pk_bf16_f32 v250, v180, v181
v_cvt_pk_bf16_f32 v251, v182, v183
buffer_store_dwordx4 v[248:251], v1, s[40:43], s75 offen offset:2048 sc1
s_add_u32 s92, s5, 8192
buffer_load_dwordx4 v[72:75], v1, s[40:43], s92 offen offset:1024 sc1
buffer_load_dwordx4 v[76:79], v198, s[40:43], s92 offen offset:1024 sc1
v_accvgpr_read_b32 v240, a88
v_accvgpr_read_b32 v241, a89
v_accvgpr_read_b32 v242, a90
v_accvgpr_read_b32 v243, a91
v_pk_mul_f32 v[244:245], v[184:185], v[184:185]
v_pk_mul_f32 v[246:247], v[186:187], v[186:187]
v_pk_fma_f32 v[244:245], v[244:245], v[12:13], v[10:11] op_sel:[0,0,1] op_sel_hi:[1,0,1]
v_pk_fma_f32 v[246:247], v[246:247], v[12:13], v[10:11] op_sel:[0,0,1] op_sel_hi:[1,0,1]
v_pk_mul_f32 v[244:245], v[244:245], v[184:185]
v_pk_mul_f32 v[246:247], v[246:247], v[186:187]
v_pk_mul_f32 v[184:185], v[184:185], v[240:241]
v_pk_mul_f32 v[186:187], v[186:187], v[242:243]
v_exp_f32 v244, v244
v_exp_f32 v245, v245
v_exp_f32 v246, v246
v_exp_f32 v247, v247
v_pk_fma_f32 v[244:245], v[244:245], v[12:13], v[12:13] op_sel:[0,1,1] op_sel_hi:[1,1,1]
s_add_u32 m0, s73, 90112
s_add_u32 s11, s23, 39424
buffer_load_dwordx4 v6, s[32:35], s11 offen lds
buffer_load_dwordx4 v7, s[32:35], s11 offen offset:1024 lds
v_pk_fma_f32 v[246:247], v[246:247], v[12:13], v[12:13] op_sel:[0,1,1] op_sel_hi:[1,1,1]
v_rcp_f32 v244, v244
v_rcp_f32 v245, v245
v_rcp_f32 v246, v246
v_rcp_f32 v247, v247
v_pk_mul_f32 v[184:185], v[184:185], v[244:245]
v_pk_mul_f32 v[186:187], v[186:187], v[246:247]
v_cvt_pk_bf16_f32 v252, v184, v185
v_cvt_pk_bf16_f32 v253, v186, v187
v_accvgpr_read_b32 v240, a92
v_accvgpr_read_b32 v241, a93
v_accvgpr_read_b32 v242, a94
v_accvgpr_read_b32 v243, a95
v_pk_mul_f32 v[244:245], v[188:189], v[188:189]
v_pk_mul_f32 v[246:247], v[190:191], v[190:191]
v_pk_fma_f32 v[244:245], v[244:245], v[12:13], v[10:11] op_sel:[0,0,1] op_sel_hi:[1,0,1]
v_pk_fma_f32 v[246:247], v[246:247], v[12:13], v[10:11] op_sel:[0,0,1] op_sel_hi:[1,0,1]
v_pk_mul_f32 v[244:245], v[244:245], v[188:189]
v_pk_mul_f32 v[246:247], v[246:247], v[190:191]
v_pk_mul_f32 v[188:189], v[188:189], v[240:241]
v_pk_mul_f32 v[190:191], v[190:191], v[242:243]
v_exp_f32 v244, v244
v_exp_f32 v245, v245
v_exp_f32 v246, v246
v_exp_f32 v247, v247
v_pk_fma_f32 v[244:245], v[244:245], v[12:13], v[12:13] op_sel:[0,1,1] op_sel_hi:[1,1,1]
v_pk_fma_f32 v[246:247], v[246:247], v[12:13], v[12:13] op_sel:[0,1,1] op_sel_hi:[1,1,1]
v_rcp_f32 v244, v244
v_rcp_f32 v245, v245
v_rcp_f32 v246, v246
v_rcp_f32 v247, v247
v_pk_mul_f32 v[188:189], v[188:189], v[244:245]
v_pk_mul_f32 v[190:191], v[190:191], v[246:247]
v_cvt_pk_bf16_f32 v254, v188, v189
v_cvt_pk_bf16_f32 v255, v190, v191
buffer_store_dwordx4 v[252:255], v1, s[40:43], s75 offen offset:3072 sc1
s_cmp_eq_u32 s77, 0
s_cbranch_scc1 L_fin
s_waitcnt vmcnt(20)
v_mfma_f32_32x32x16_bf16 v[128:143], a[96:99], v[16:19], 0
v_lshrrev_b32 v244, 7, v1
s_lshl_b32 s99, s10, 3
v_add_u32 v245, s99, v244
v_mfma_f32_32x32x16_bf16 v[144:159], a[96:99], v[20:23], 0
v_mul_u32_u24 v245, 896, v245
v_and_b32 v222, 0x70, v1
v_add_u32 v222, v222, v245
v_mfma_f32_32x32x16_bf16 v[176:191], a[100:103], v[20:23], 0
v_add_u32 v223, 28672, v222
v_bfe_u32 v245, v1, 4, 2
v_lshlrev_b32 v245, 1, v245
v_mfma_f32_32x32x16_bf16 v[160:175], a[100:103], v[16:19], 0
buffer_load_dwordx4 v[80:83], v1, s[40:43], s4 offen offset:2048 sc1
buffer_load_dwordx4 v[84:87], v198, s[40:43], s4 offen offset:2048 sc1
v_xor_b32 v245, v245, v244
v_lshlrev_b32 v245, 4, v245
v_lshl_add_u32 v245, v244, 8, v245
s_waitcnt vmcnt(19)
v_mfma_f32_32x32x16_bf16 v[128:143], a[104:107], v[24:27], v[128:143]
v_bfe_u32 v244, v1, 6, 1
v_lshl_add_u32 v245, v244, 7, v245
s_lshl_b32 s99, s10, 13
v_mfma_f32_32x32x16_bf16 v[144:159], a[104:107], v[28:31], v[144:159]
v_add_u32 v220, s99, v245
v_xor_b32 v221, 16, v220
v_bfe_u32 v244, v1, 4, 3
v_mfma_f32_32x32x16_bf16 v[176:191], a[108:111], v[28:31], v[176:191]
v_lshrrev_b32 v245, 9, v1
v_xor_b32 v245, v245, v244
v_lshlrev_b32 v245, 4, v245
v_mfma_f32_32x32x16_bf16 v[160:175], a[108:111], v[24:27], v[160:175]
buffer_load_dwordx4 v[88:91], v1, s[40:43], s4 offen offset:3072 sc1
buffer_load_dwordx4 v[92:95], v198, s[40:43], s4 offen offset:3072 sc1
v_lshl_add_u32 v245, v244, 8, v245
v_bfe_u32 v244, v1, 7, 2
v_lshl_add_u32 v245, v244, 13, v245
s_waitcnt vmcnt(19)
v_mfma_f32_32x32x16_bf16 v[128:143], a[112:115], v[32:35], v[128:143]
v_add_u32 v216, s73, v245
v_xor_b32 v217, 32, v216
v_xor_b32 v218, 64, v216
v_mfma_f32_32x32x16_bf16 v[144:159], a[112:115], v[36:39], v[144:159]
v_xor_b32 v219, 0x60, v216
v_mfma_f32_32x32x16_bf16 v[176:191], a[116:119], v[36:39], v[176:191]
s_add_u32 s92, s4, 8192
v_mfma_f32_32x32x16_bf16 v[160:175], a[116:119], v[32:35], v[160:175]
buffer_load_dwordx4 v[96:99], v1, s[40:43], s92 offen offset:2048 sc1
buffer_load_dwordx4 v[100:103], v198, s[40:43], s92 offen offset:2048 sc1
s_waitcnt vmcnt(19)
v_mfma_f32_32x32x16_bf16 v[128:143], a[120:123], v[40:43], v[128:143]
v_mfma_f32_32x32x16_bf16 v[144:159], a[120:123], v[44:47], v[144:159]
v_mfma_f32_32x32x16_bf16 v[176:191], a[124:127], v[44:47], v[176:191]
s_add_u32 s92, s4, 8192
v_mfma_f32_32x32x16_bf16 v[160:175], a[124:127], v[40:43], v[160:175]
buffer_load_dwordx4 v[104:107], v1, s[40:43], s92 offen offset:3072 sc1
buffer_load_dwordx4 v[108:111], v198, s[40:43], s92 offen offset:3072 sc1
s_waitcnt vmcnt(18)
v_mfma_f32_32x32x16_bf16 v[128:143], a[128:131], v[48:51], v[128:143]
v_mfma_f32_32x32x16_bf16 v[144:159], a[128:131], v[52:55], v[144:159]
v_mfma_f32_32x32x16_bf16 v[176:191], a[132:135], v[52:55], v[176:191]
v_mfma_f32_32x32x16_bf16 v[160:175], a[132:135], v[48:51], v[160:175]
buffer_load_dwordx4 v[112:115], v1, s[40:43], s5 offen offset:2048 sc1
buffer_load_dwordx4 v[116:119], v198, s[40:43], s5 offen offset:2048 sc1
s_waitcnt vmcnt(18)
v_mfma_f32_32x32x16_bf16 v[128:143], a[136:139], v[56:59], v[128:143]
v_mfma_f32_32x32x16_bf16 v[144:159], a[136:139], v[60:63], v[144:159]
v_mfma_f32_32x32x16_bf16 v[176:191], a[140:143], v[60:63], v[176:191]
v_mfma_f32_32x32x16_bf16 v[160:175], a[140:143], v[56:59], v[160:175]
buffer_load_dwordx4 v[120:123], v1, s[40:43], s5 offen offset:3072 sc1
buffer_load_dwordx4 v[124:127], v198, s[40:43], s5 offen offset:3072 sc1
s_waitcnt vmcnt(18)
v_mfma_f32_32x32x16_bf16 v[128:143], a[144:147], v[64:67], v[128:143]
v_mfma_f32_32x32x16_bf16 v[144:159], a[144:147], v[68:71], v[144:159]
v_mfma_f32_32x32x16_bf16 v[176:191], a[148:151], v[68:71], v[176:191]
s_add_u32 s92, s5, 8192
v_mfma_f32_32x32x16_bf16 v[160:175], a[148:151], v[64:67], v[160:175]
buffer_load_dwordx4 v[16:19], v1, s[40:43], s92 offen offset:2048 sc1
buffer_load_dwordx4 v[20:23], v198, s[40:43], s92 offen offset:2048 sc1
s_waitcnt vmcnt(17)
v_mfma_f32_32x32x16_bf16 v[128:143], a[152:155], v[72:75], v[128:143]
s_waitcnt vmcnt(10)
v_max3_u32 v230, v80, v81, v82
v_max3_u32 v231, v83, v84, v85
v_max3_u32 v230, v230, v86, v87
v_mfma_f32_32x32x16_bf16 v[144:159], a[152:155], v[76:79], v[144:159]
v_max3_u32 v231, v231, v88, v89
v_max3_u32 v230, v230, v90, v91
v_max3_u32 v231, v231, v92, v93
v_mfma_f32_32x32x16_bf16 v[176:191], a[156:159], v[76:79], v[176:191]
v_max3_u32 v230, v230, v94, v95
v_max_u32 v230, v230, v231
v_cmp_eq_u32 vcc, -1, v230
s_add_u32 s92, s5, 8192
v_mfma_f32_32x32x16_bf16 v[160:175], a[156:159], v[72:75], v[160:175]
s_cbranch_vccnz L_spin4
L_ok4:
buffer_load_dwordx4 v[24:27], v1, s[40:43], s92 offen offset:3072 sc1
buffer_load_dwordx4 v[28:31], v198, s[40:43], s92 offen offset:3072 sc1
v_mfma_f32_32x32x16_bf16 v[128:143], a[160:163], v[80:83], v[128:143]
v_mfma_f32_32x32x16_bf16 v[144:159], a[160:163], v[84:87], v[144:159]
v_mfma_f32_32x32x16_bf16 v[176:191], a[164:167], v[84:87], v[176:191]
s_add_u32 s92, s4, 12288
v_mfma_f32_32x32x16_bf16 v[160:175], a[164:167], v[80:83], v[160:175]
buffer_load_dwordx4 v[32:35], v1, s[40:43], s92 offen offset:0 sc1
buffer_load_dwordx4 v[36:39], v198, s[40:43], s92 offen offset:0 sc1
v_mfma_f32_32x32x16_bf16 v[128:143], a[168:171], v[88:91], v[128:143]
s_waitcnt vmcnt(10)
v_max3_u32 v230, v96, v97, v98
v_max3_u32 v231, v99, v100, v101
v_max3_u32 v230, v230, v102, v103
v_mfma_f32_32x32x16_bf16 v[144:159], a[168:171], v[92:95], v[144:159]
v_max3_u32 v231, v231, v104, v105
v_max3_u32 v230, v230, v106, v107
v_max3_u32 v231, v231, v108, v109
v_mfma_f32_32x32x16_bf16 v[176:191], a[172:175], v[92:95], v[176:191]
v_max3_u32 v230, v230, v110, v111
v_max_u32 v230, v230, v231
v_cmp_eq_u32 vcc, -1, v230
s_add_u32 s92, s4, 12288
v_mfma_f32_32x32x16_bf16 v[160:175], a[172:175], v[88:91], v[160:175]
s_cbranch_vccnz L_spin5
L_ok5:
buffer_load_dwordx4 v[40:43], v1, s[40:43], s92 offen offset:1024 sc1
buffer_load_dwordx4 v[44:47], v198, s[40:43], s92 offen offset:1024 sc1
v_mfma_f32_32x32x16_bf16 v[128:143], a[176:179], v[96:99], v[128:143]
v_mfma_f32_32x32x16_bf16 v[144:159], a[176:179], v[100:103], v[144:159]
v_mfma_f32_32x32x16_bf16 v[176:191], a[180:183], v[100:103], v[176:191]
s_add_u32 s92, s5, 12288
v_mfma_f32_32x32x16_bf16 v[160:175], a[180:183], v[96:99], v[160:175]
buffer_load_dwordx4 v[48:51], v1, s[40:43], s92 offen offset:0 sc1
buffer_load_dwordx4 v[52:55], v198, s[40:43], s92 offen offset:0 sc1
v_mfma_f32_32x32x16_bf16 v[128:143], a[184:187], v[104:107], v[128:143]
s_waitcnt vmcnt(10)
v_max3_u32 v230, v112, v113, v114
v_max3_u32 v231, v115, v116, v117
v_max3_u32 v230, v230, v118, v119
v_mfma_f32_32x32x16_bf16 v[144:159], a[184:187], v[108:111], v[144:159]
v_max3_u32 v231, v231, v120, v121
v_max3_u32 v230, v230, v122, v123
v_max3_u32 v231, v231, v124, v125
v_mfma_f32_32x32x16_bf16 v[176:191], a[188:191], v[108:111], v[176:191]
v_max3_u32 v230, v230, v126, v127
v_max_u32 v230, v230, v231
v_cmp_eq_u32 vcc, -1, v230
s_add_u32 s92, s5, 12288
v_mfma_f32_32x32x16_bf16 v[160:175], a[188:191], v[104:107], v[160:175]
s_cbranch_vccnz L_spin6
L_ok6:
buffer_load_dwordx4 v[56:59], v1, s[40:43], s92 offen offset:1024 sc1
buffer_load_dwordx4 v[60:63], v198, s[40:43], s92 offen offset:1024 sc1
v_mfma_f32_32x32x16_bf16 v[128:143], a[192:195], v[112:115], v[128:143]
v_mfma_f32_32x32x16_bf16 v[144:159], a[192:195], v[116:119], v[144:159]
v_mfma_f32_32x32x16_bf16 v[176:191], a[196:199], v[116:119], v[176:191]
s_add_u32 s92, s4, 4096
v_mfma_f32_32x32x16_bf16 v[160:175], a[196:199], v[112:115], v[160:175]
buffer_load_dwordx4 v[64:67], v1, s[40:43], s92 offen offset:0 sc1
buffer_load_dwordx4 v[68:71], v198, s[40:43], s92 offen offset:0 sc1
v_mfma_f32_32x32x16_bf16 v[128:143], a[200:203], v[120:123], v[128:143]
s_waitcnt vmcnt(10)
v_max3_u32 v230, v16, v17, v18
v_max3_u32 v231, v19, v20, v21
v_max3_u32 v230, v230, v22, v23
v_mfma_f32_32x32x16_bf16 v[144:159], a[200:203], v[124:127], v[144:159]
v_max3_u32 v231, v231, v24, v25
v_max3_u32 v230, v230, v26, v27
v_max3_u32 v231, v231, v28, v29
v_mfma_f32_32x32x16_bf16 v[176:191], a[204:207], v[124:127], v[176:191]
v_max3_u32 v230, v230, v30, v31
v_max_u32 v230, v230, v231
v_cmp_eq_u32 vcc, -1, v230
s_add_u32 s92, s4, 4096
v_mfma_f32_32x32x16_bf16 v[160:175], a[204:207], v[120:123], v[160:175]
s_cbranch_vccnz L_spin7
L_ok7:
buffer_load_dwordx4 v[72:75], v1, s[40:43], s92 offen offset:1024 sc1
buffer_load_dwordx4 v[76:79], v198, s[40:43], s92 offen offset:1024 sc1
v_mfma_f32_32x32x16_bf16 v[128:143], a[208:211], v[16:19], v[128:143]
v_mfma_f32_32x32x16_bf16 v[144:159], a[208:211], v[20:23], v[144:159]
v_mfma_f32_32x32x16_bf16 v[176:191], a[212:215], v[20:23], v[176:191]
s_add_u32 s92, s5, 4096
v_mfma_f32_32x32x16_bf16 v[160:175], a[212:215], v[16:19], v[160:175]
buffer_load_dwordx4 v[80:83], v1, s[40:43], s92 offen offset:0 sc1
buffer_load_dwordx4 v[84:87], v198, s[40:43], s92 offen offset:0 sc1
v_mfma_f32_32x32x16_bf16 v[128:143], a[216:219], v[24:27], v[128:143]
s_waitcnt vmcnt(10)
v_max3_u32 v230, v32, v33, v34
v_max3_u32 v231, v35, v36, v37
v_max3_u32 v230, v230, v38, v39
v_mfma_f32_32x32x16_bf16 v[144:159], a[216:219], v[28:31], v[144:159]
v_max3_u32 v231, v231, v40, v41
v_max3_u32 v230, v230, v42, v43
v_max3_u32 v231, v231, v44, v45
v_mfma_f32_32x32x16_bf16 v[176:191], a[220:223], v[28:31], v[176:191]
v_max3_u32 v230, v230, v46, v47
v_max_u32 v230, v230, v231
v_cmp_eq_u32 vcc, -1, v230
s_add_u32 s92, s5, 4096
v_mfma_f32_32x32x16_bf16 v[160:175], a[220:223], v[24:27], v[160:175]
s_cbranch_vccnz L_spin8
L_ok8:
buffer_load_dwordx4 v[88:91], v1, s[40:43], s92 offen offset:1024 sc1
buffer_load_dwordx4 v[92:95], v198, s[40:43], s92 offen offset:1024 sc1
v_mfma_f32_32x32x16_bf16 v[128:143], a[224:227], v[32:35], v[128:143]
v_mfma_f32_32x32x16_bf16 v[144:159], a[224:227], v[36:39], v[144:159]
v_mfma_f32_32x32x16_bf16 v[176:191], a[228:231], v[36:39], v[176:191]
s_add_u32 s92, s4, 12288
v_mfma_f32_32x32x16_bf16 v[160:175], a[228:231], v[32:35], v[160:175]
buffer_load_dwordx4 v[96:99], v1, s[40:43], s92 offen offset:2048 sc1
buffer_load_dwordx4 v[100:103], v198, s[40:43], s92 offen offset:2048 sc1
v_mfma_f32_32x32x16_bf16 v[128:143], a[232:235], v[40:43], v[128:143]
s_waitcnt vmcnt(10)
v_max3_u32 v230, v48, v49, v50
v_max3_u32 v231, v51, v52, v53
v_max3_u32 v230, v230, v54, v55
v_mfma_f32_32x32x16_bf16 v[144:159], a[232:235], v[44:47], v[144:159]
v_max3_u32 v231, v231, v56, v57
v_max3_u32 v230, v230, v58, v59
v_max3_u32 v231, v231, v60, v61
v_mfma_f32_32x32x16_bf16 v[176:191], a[236:239], v[44:47], v[176:191]
v_max3_u32 v230, v230, v62, v63
v_max_u32 v230, v230, v231
v_cmp_eq_u32 vcc, -1, v230
s_add_u32 s92, s4, 12288
v_mfma_f32_32x32x16_bf16 v[160:175], a[236:239], v[40:43], v[160:175]
s_cbranch_vccnz L_spin9
L_ok9:
buffer_load_dwordx4 v[104:107], v1, s[40:43], s92 offen offset:3072 sc1
buffer_load_dwordx4 v[108:111], v198, s[40:43], s92 offen offset:3072 sc1
v_mfma_f32_32x32x16_bf16 v[128:143], a[240:243], v[48:51], v[128:143]
ds_read_b64_tr_b16 a[24:25], v236 offset:24576
ds_read_b64_tr_b16 a[26:27], v236 offset:25600
v_mfma_f32_32x32x16_bf16 v[144:159], a[240:243], v[52:55], v[144:159]
ds_read_b64_tr_b16 a[28:29], v237 offset:24576
ds_read_b64_tr_b16 a[30:31], v237 offset:25600
v_mfma_f32_32x32x16_bf16 v[176:191], a[244:247], v[52:55], v[176:191]
s_add_u32 s92, s5, 12288
v_mfma_f32_32x32x16_bf16 v[160:175], a[244:247], v[48:51], v[160:175]
buffer_load_dwordx4 v[112:115], v1, s[40:43], s92 offen offset:2048 sc1
buffer_load_dwordx4 v[116:119], v198, s[40:43], s92 offen offset:2048 sc1
s_waitcnt lgkmcnt(0)
v_mfma_f32_32x32x16_bf16 v[128:143], a[24:27], v[56:59], v[128:143]
ds_read_b64_tr_b16 a[0:1], v236 offset:32768
ds_read_b64_tr_b16 a[2:3], v236 offset:33792
s_waitcnt vmcnt(10)
v_max3_u32 v230, v64, v65, v66
v_max3_u32 v231, v67, v68, v69
v_max3_u32 v230, v230, v70, v71
v_mfma_f32_32x32x16_bf16 v[144:159], a[24:27], v[60:63], v[144:159]
ds_read_b64_tr_b16 a[4:5], v237 offset:32768
ds_read_b64_tr_b16 a[6:7], v237 offset:33792
v_max3_u32 v231, v231, v72, v73
v_max3_u32 v230, v230, v74, v75
v_max3_u32 v231, v231, v76, v77
v_mfma_f32_32x32x16_bf16 v[176:191], a[28:31], v[60:63], v[176:191]
v_max3_u32 v230, v230, v78, v79
v_max_u32 v230, v230, v231
v_cmp_eq_u32 vcc, -1, v230
s_add_u32 s92, s5, 12288
v_mfma_f32_32x32x16_bf16 v[160:175], a[28:31], v[56:59], v[160:175]
s_cbranch_vccnz L_spin10
L_ok10:
buffer_load_dwordx4 v[120:123], v1, s[40:43], s92 offen offset:3072 sc1
buffer_load_dwordx4 v[124:127], v198, s[40:43], s92 offen offset:3072 sc1
s_waitcnt lgkmcnt(0)
v_mfma_f32_32x32x16_bf16 v[128:143], a[0:3], v[64:67], v[128:143]
ds_read_b64_tr_b16 a[8:9], v236 offset:0
ds_read_b64_tr_b16 a[10:11], v236 offset:1024
v_mfma_f32_32x32x16_bf16 v[144:159], a[0:3], v[68:71], v[144:159]
ds_read_b64_tr_b16 a[12:13], v237 offset:0
ds_read_b64_tr_b16 a[14:15], v237 offset:1024
v_mfma_f32_32x32x16_bf16 v[176:191], a[4:7], v[68:71], v[176:191]
s_add_u32 s92, s4, 4096
v_mfma_f32_32x32x16_bf16 v[160:175], a[4:7], v[64:67], v[160:175]
buffer_load_dwordx4 v[16:19], v1, s[40:43], s92 offen offset:2048 sc1
buffer_load_dwordx4 v[20:23], v198, s[40:43], s92 offen offset:2048 sc1
s_waitcnt lgkmcnt(0)
v_mfma_f32_32x32x16_bf16 v[128:143], a[8:11], v[72:75], v[128:143]
ds_read_b64_tr_b16 a[16:17], v236 offset:40960
ds_read_b64_tr_b16 a[18:19], v236 offset:41984
s_waitcnt vmcnt(10)
v_max3_u32 v230, v80, v81, v82
v_max3_u32 v231, v83, v84, v85
v_max3_u32 v230, v230, v86, v87
v_mfma_f32_32x32x16_bf16 v[144:159], a[8:11], v[76:79], v[144:159]
ds_read_b64_tr_b16 a[20:21], v237 offset:40960
ds_read_b64_tr_b16 a[22:23], v237 offset:41984
v_max3_u32 v231, v231, v88, v89
v_max3_u32 v230, v230, v90, v91
v_max3_u32 v231, v231, v92, v93
v_mfma_f32_32x32x16_bf16 v[176:191], a[12:15], v[76:79], v[176:191]
v_max3_u32 v230, v230, v94, v95
v_max_u32 v230, v230, v231
v_cmp_eq_u32 vcc, -1, v230
s_add_u32 s92, s4, 4096
v_mfma_f32_32x32x16_bf16 v[160:175], a[12:15], v[72:75], v[160:175]
s_cbranch_vccnz L_spin11
L_ok11:
buffer_load_dwordx4 v[24:27], v1, s[40:43], s92 offen offset:3072 sc1
buffer_load_dwordx4 v[28:31], v198, s[40:43], s92 offen offset:3072 sc1
s_waitcnt lgkmcnt(0)
v_mfma_f32_32x32x16_bf16 v[128:143], a[16:19], v[80:83], v[128:143]
ds_read_b64_tr_b16 a[24:25], v236 offset:49152
ds_read_b64_tr_b16 a[26:27], v236 offset:50176
v_mfma_f32_32x32x16_bf16 v[144:159], a[16:19], v[84:87], v[144:159]
ds_read_b64_tr_b16 a[28:29], v237 offset:49152
ds_read_b64_tr_b16 a[30:31], v237 offset:50176
v_mfma_f32_32x32x16_bf16 v[176:191], a[20:23], v[84:87], v[176:191]
s_add_u32 s92, s5, 4096
v_mfma_f32_32x32x16_bf16 v[160:175], a[20:23], v[80:83], v[160:175]
buffer_load_dwordx4 v[32:35], v1, s[40:43], s92 offen offset:2048 sc1
buffer_load_dwordx4 v[36:39], v198, s[40:43], s92 offen offset:2048 sc1
s_waitcnt lgkmcnt(0)
v_mfma_f32_32x32x16_bf16 v[128:143], a[24:27], v[88:91], v[128:143]
ds_read_b64_tr_b16 a[0:1], v8 offset:49152
ds_read_b64_tr_b16 a[2:3], v8 offset:50176
s_waitcnt vmcnt(10)
v_max3_u32 v230, v96, v97, v98
v_max3_u32 v231, v99, v100, v101
v_max3_u32 v230, v230, v102, v103
v_mfma_f32_32x32x16_bf16 v[144:159], a[24:27], v[92:95], v[144:159]
ds_read_b64_tr_b16 a[4:5], v9 offset:49152
ds_read_b64_tr_b16 a[6:7], v9 offset:50176
v_max3_u32 v231, v231, v104, v105
v_max3_u32 v230, v230, v106, v107
v_max3_u32 v231, v231, v108, v109
v_mfma_f32_32x32x16_bf16 v[176:191], a[28:31], v[92:95], v[176:191]
v_max3_u32 v230, v230, v110, v111
v_max_u32 v230, v230, v231
v_cmp_eq_u32 vcc, -1, v230
s_add_u32 s92, s5, 4096
v_mfma_f32_32x32x16_bf16 v[160:175], a[28:31], v[88:91], v[160:175]
s_cbranch_vccnz L_spin12
L_ok12:
buffer_load_dwordx4 v[40:43], v1, s[40:43], s92 offen offset:3072 sc1
buffer_load_dwordx4 v[44:47], v198, s[40:43], s92 offen offset:3072 sc1
s_waitcnt lgkmcnt(0)
v_mfma_f32_32x32x16_bf16 v[128:143], a[0:3], v[96:99], v[128:143]
ds_read_b64_tr_b16 a[8:9], v8 offset:57344
ds_read_b64_tr_b16 a[10:11], v8 offset:58368
v_mfma_f32_32x32x16_bf16 v[144:159], a[0:3], v[100:103], v[144:159]
ds_read_b64_tr_b16 a[12:13], v9 offset:57344
ds_read_b64_tr_b16 a[14:15], v9 offset:58368
v_mfma_f32_32x32x16_bf16 v[176:191], a[4:7], v[100:103], v[176:191]
s_add_u32 s92, s4, 16384
v_mfma_f32_32x32x16_bf16 v[160:175], a[4:7], v[96:99], v[160:175]
buffer_load_dwordx4 v[48:51], v1, s[40:43], s92 offen offset:0 sc1
buffer_load_dwordx4 v[52:55], v198, s[40:43], s92 offen offset:0 sc1
buffer_load_dwordx4 v[204:207], v222, s[24:27], s3 offen
buffer_load_dwordx4 v[208:211], v223, s[24:27], s3 offen
s_waitcnt lgkmcnt(0)
v_mfma_f32_32x32x16_bf16 v[128:143], a[8:11], v[104:107], v[128:143]
ds_read_b64_tr_b16 a[16:17], v236 offset:8192
ds_read_b64_tr_b16 a[18:19], v236 offset:9216
s_waitcnt vmcnt(12)
v_max3_u32 v230, v112, v113, v114
v_max3_u32 v231, v115, v116, v117
v_max3_u32 v230, v230, v118, v119
v_mfma_f32_32x32x16_bf16 v[144:159], a[8:11], v[108:111], v[144:159]
ds_read_b64_tr_b16 a[20:21], v237 offset:8192
ds_read_b64_tr_b16 a[22:23], v237 offset:9216
v_max3_u32 v231, v231, v120, v121
v_max3_u32 v230, v230, v122, v123
v_max3_u32 v231, v231, v124, v125
v_mfma_f32_32x32x16_bf16 v[176:191], a[12:15], v[108:111], v[176:191]
v_max3_u32 v230, v230, v126, v127
v_max_u32 v230, v230, v231
v_cmp_eq_u32 vcc, -1, v230
s_add_u32 s92, s4, 16384
v_mfma_f32_32x32x16_bf16 v[160:175], a[12:15], v[104:107], v[160:175]
s_cbranch_vccnz L_spin13
L_ok13:
buffer_load_dwordx4 v[56:59], v1, s[40:43], s92 offen offset:1024 sc1
buffer_load_dwordx4 v[60:63], v198, s[40:43], s92 offen offset:1024 sc1
s_waitcnt lgkmcnt(0)
v_mfma_f32_32x32x16_bf16 v[128:143], a[16:19], v[112:115], v[128:143]
ds_read_b64_tr_b16 a[24:25], v236 offset:16384
ds_read_b64_tr_b16 a[26:27], v236 offset:17408
v_mfma_f32_32x32x16_bf16 v[144:159], a[16:19], v[116:119], v[144:159]
ds_read_b64_tr_b16 a[28:29], v237 offset:16384
ds_read_b64_tr_b16 a[30:31], v237 offset:17408
v_mfma_f32_32x32x16_bf16 v[176:191], a[20:23], v[116:119], v[176:191]
s_add_u32 s92, s5, 16384
v_mfma_f32_32x32x16_bf16 v[160:175], a[20:23], v[112:115], v[160:175]
buffer_load_dwordx4 v[64:67], v1, s[40:43], s92 offen offset:0 sc1
buffer_load_dwordx4 v[68:71], v198, s[40:43], s92 offen offset:0 sc1
s_waitcnt lgkmcnt(0)
v_mfma_f32_32x32x16_bf16 v[128:143], a[24:27], v[120:123], v[128:143]
ds_read_b64_tr_b16 a[0:1], v236 offset:57344
ds_read_b64_tr_b16 a[2:3], v236 offset:58368
s_waitcnt vmcnt(12)
v_max3_u32 v230, v16, v17, v18
v_max3_u32 v231, v19, v20, v21
v_max3_u32 v230, v230, v22, v23
v_mfma_f32_32x32x16_bf16 v[144:159], a[24:27], v[124:127], v[144:159]
ds_read_b64_tr_b16 a[4:5], v237 offset:57344
ds_read_b64_tr_b16 a[6:7], v237 offset:58368
v_max3_u32 v231, v231, v24, v25
v_max3_u32 v230, v230, v26, v27
v_max3_u32 v231, v231, v28, v29
v_mfma_f32_32x32x16_bf16 v[176:191], a[28:31], v[124:127], v[176:191]
v_max3_u32 v230, v230, v30, v31
v_max_u32 v230, v230, v231
v_cmp_eq_u32 vcc, -1, v230
s_add_u32 s92, s5, 16384
v_mfma_f32_32x32x16_bf16 v[160:175], a[28:31], v[120:123], v[160:175]
s_cbranch_vccnz L_spin14
L_ok14:
buffer_load_dwordx4 v[72:75], v1, s[40:43], s92 offen offset:1024 sc1
buffer_load_dwordx4 v[76:79], v198, s[40:43], s92 offen offset:1024 sc1
s_waitcnt lgkmcnt(0)
v_mfma_f32_32x32x16_bf16 v[128:143], a[0:3], v[16:19], v[128:143]
ds_read_b64_tr_b16 a[8:9], v8 offset:0
ds_read_b64_tr_b16 a[10:11], v8 offset:1024
v_mfma_f32_32x32x16_bf16 v[144:159], a[0:3], v[20:23], v[144:159]
ds_read_b64_tr_b16 a[12:13], v9 offset:0
ds_read_b64_tr_b16 a[14:15], v9 offset:1024
v_mfma_f32_32x32x16_bf16 v[176:191], a[4:7], v[20:23], v[176:191]
v_mfma_f32_32x32x16_bf16 v[160:175], a[4:7], v[16:19], v[160:175]
s_waitcnt lgkmcnt(0)
v_mfma_f32_32x32x16_bf16 v[128:143], a[8:11], v[24:27], v[128:143]
ds_read_b64_tr_b16 a[16:17], v8 offset:8192
ds_read_b64_tr_b16 a[18:19], v8 offset:9216
s_waitcnt vmcnt(10)
v_max3_u32 v230, v32, v33, v34
v_max3_u32 v231, v35, v36, v37
v_max3_u32 v230, v230, v38, v39
v_mfma_f32_32x32x16_bf16 v[144:159], a[8:11], v[28:31], v[144:159]
ds_read_b64_tr_b16 a[20:21], v9 offset:8192
ds_read_b64_tr_b16 a[22:23], v9 offset:9216
v_max3_u32 v231, v231, v40, v41
v_max3_u32 v230, v230, v42, v43
v_max3_u32 v231, v231, v44, v45
v_mfma_f32_32x32x16_bf16 v[176:191], a[12:15], v[28:31], v[176:191]
v_max3_u32 v230, v230, v46, v47
v_max_u32 v230, v230, v231
v_cmp_eq_u32 vcc, -1, v230
v_mfma_f32_32x32x16_bf16 v[160:175], a[12:15], v[24:27], v[160:175]
s_cbranch_vccnz L_spin15
L_ok15:
s_waitcnt lgkmcnt(0)
v_mfma_f32_32x32x16_bf16 v[128:143], a[16:19], v[32:35], v[128:143]
ds_read_b64_tr_b16 a[24:25], v226 offset:0
ds_read_b64_tr_b16 a[26:27], v226 offset:1024
v_mfma_f32_32x32x16_bf16 v[144:159], a[16:19], v[36:39], v[144:159]
ds_read_b64_tr_b16 a[28:29], v228 offset:0
ds_read_b64_tr_b16 a[30:31], v228 offset:1024
v_mfma_f32_32x32x16_bf16 v[176:191], a[20:23], v[36:39], v[176:191]
v_mfma_f32_32x32x16_bf16 v[160:175], a[20:23], v[32:35], v[160:175]
s_waitcnt lgkmcnt(0)
v_mfma_f32_32x32x16_bf16 v[128:143], a[24:27], v[40:43], v[128:143]
ds_read_b64_tr_b16 a[0:1], v226 offset:12288
ds_read_b64_tr_b16 a[2:3], v226 offset:13312
s_waitcnt vmcnt(8)
v_max3_u32 v230, v48, v49, v50
v_mfma_f32_32x32x16_bf16 v[144:159], a[24:27], v[44:47], v[144:159]
ds_read_b64_tr_b16 a[4:5], v228 offset:12288
ds_read_b64_tr_b16 a[6:7], v228 offset:13312
v_max3_u32 v231, v51, v52, v53
v_max3_u32 v230, v230, v54, v55
v_mfma_f32_32x32x16_bf16 v[176:191], a[28:31], v[44:47], v[176:191]
v_max_u32 v230, v230, v231
v_cmp_eq_u32 vcc, -1, v230
v_mfma_f32_32x32x16_bf16 v[160:175], a[28:31], v[40:43], v[160:175]
s_cbranch_vccnz L_spin16
L_ok16:
s_waitcnt lgkmcnt(0)
v_mfma_f32_32x32x16_bf16 v[128:143], a[0:3], v[48:51], v[128:143]
ds_read_b64_tr_b16 a[8:9], v226 offset:20480
ds_read_b64_tr_b16 a[10:11], v226 offset:21504
s_waitcnt vmcnt(0)
v_max3_u32 v230, v56, v57, v58
v_max3_u32 v231, v59, v60, v61
v_max3_u32 v230, v230, v62, v63
v_max3_u32 v231, v231, v64, v65
v_mfma_f32_32x32x16_bf16 v[144:159], a[0:3], v[52:55], v[144:159]
ds_read_b64_tr_b16 a[12:13], v228 offset:20480
ds_read_b64_tr_b16 a[14:15], v228 offset:21504
v_max3_u32 v230, v230, v66, v67
v_max3_u32 v231, v231, v68, v69
v_max3_u32 v230, v230, v70, v71
v_max3_u32 v231, v231, v72, v73
v_max3_u32 v230, v230, v74, v75
v_mfma_f32_32x32x16_bf16 v[176:191], a[4:7], v[52:55], v[176:191]
ds_read_b64_tr_b16 a[16:17], v8 offset:16384
ds_read_b64_tr_b16 a[18:19], v8 offset:17408
ds_read_b64_tr_b16 a[20:21], v9 offset:16384
ds_read_b64_tr_b16 a[22:23], v9 offset:17408
v_max3_u32 v231, v231, v76, v77
v_max3_u32 v230, v230, v78, v79
v_max_u32 v230, v230, v231
v_cmp_eq_u32 vcc, -1, v230
v_mfma_f32_32x32x16_bf16 v[160:175], a[4:7], v[48:51], v[160:175]
s_cbranch_vccnz L_spin17
L_ok17:
ds_read_b64_tr_b16 a[24:25], v8 offset:24576
ds_read_b64_tr_b16 a[26:27], v8 offset:25600
ds_read_b64_tr_b16 a[28:29], v9 offset:24576
ds_read_b64_tr_b16 a[30:31], v9 offset:25600
s_waitcnt lgkmcnt(0)
v_mfma_f32_32x32x16_bf16 v[128:143], a[8:11], v[56:59], v[128:143]
v_lshlrev_b32 v80, 16, v204
v_lshlrev_b32 v82, 16, v205
v_lshlrev_b32 v84, 16, v206
v_mfma_f32_32x32x16_bf16 v[128:143], a[16:19], v[64:67], v[128:143]
v_lshlrev_b32 v86, 16, v207
v_lshlrev_b32 v88, 16, v208
v_lshlrev_b32 v90, 16, v209
v_mfma_f32_32x32x16_bf16 v[128:143], a[24:27], v[72:75], v[128:143]
v_lshlrev_b32 v92, 16, v210
v_lshlrev_b32 v94, 16, v211
v_and_b32 v81, 0xffff0000, v204
v_mfma_f32_32x32x16_bf16 v[144:159], a[8:11], v[60:63], v[144:159]
v_and_b32 v83, 0xffff0000, v205
v_and_b32 v85, 0xffff0000, v206
v_and_b32 v87, 0xffff0000, v207
v_mfma_f32_32x32x16_bf16 v[144:159], a[16:19], v[68:71], v[144:159]
v_and_b32 v89, 0xffff0000, v208
v_and_b32 v91, 0xffff0000, v209
v_and_b32 v93, 0xffff0000, v210
v_mfma_f32_32x32x16_bf16 v[144:159], a[24:27], v[76:79], v[144:159]
v_and_b32 v95, 0xffff0000, v211
v_mfma_f32_32x32x16_bf16 v[160:175], a[12:15], v[56:59], v[160:175]
ds_write_b128 v216, v[128:131] offset:0
ds_write_b128 v217, v[132:135] offset:0
v_mfma_f32_32x32x16_bf16 v[160:175], a[20:23], v[64:67], v[160:175]
ds_write_b128 v218, v[136:139] offset:0
ds_write_b128 v219, v[140:143] offset:0
v_mfma_f32_32x32x16_bf16 v[160:175], a[28:31], v[72:75], v[160:175]
v_mfma_f32_32x32x16_bf16 v[176:191], a[12:15], v[60:63], v[176:191]
s_nop 2
ds_write_b128 v216, v[144:147] offset:32768
ds_write_b128 v217, v[148:151] offset:32768
v_mfma_f32_32x32x16_bf16 v[176:191], a[20:23], v[68:71], v[176:191]
ds_write_b128 v218, v[152:155] offset:32768
ds_write_b128 v219, v[156:159] offset:32768
v_mfma_f32_32x32x16_bf16 v[176:191], a[28:31], v[76:79], v[176:191]
s_nop 1
ds_write_b128 v216, v[160:163] offset:128
ds_write_b128 v217, v[164:167] offset:128
ds_write_b128 v218, v[168:171] offset:128
ds_write_b128 v219, v[172:175] offset:128
s_nop 5
ds_write_b128 v216, v[176:179] offset:32896
ds_write_b128 v217, v[180:183] offset:32896
ds_write_b128 v218, v[184:187] offset:32896
ds_write_b128 v219, v[188:191] offset:32896
s_waitcnt lgkmcnt(0)
s_barrier
ds_read_b128 v[16:19], v220 offset:0
ds_read_b128 v[20:23], v221 offset:0
ds_read_b128 v[24:27], v220 offset:32768
ds_read_b128 v[28:31], v221 offset:32768
ds_read_b128 v[32:35], v220 offset:2048
ds_read_b128 v[36:39], v221 offset:2048
ds_read_b128 v[40:43], v220 offset:34816
ds_read_b128 v[44:47], v221 offset:34816
ds_read_b128 v[48:51], v220 offset:4096
ds_read_b128 v[52:55], v221 offset:4096
ds_read_b128 v[56:59], v220 offset:36864
ds_read_b128 v[60:63], v221 offset:36864
ds_read_b128 v[64:67], v220 offset:6144
ds_read_b128 v[68:71], v221 offset:6144
ds_read_b128 v[72:75], v220 offset:38912
ds_read_b128 v[76:79], v221 offset:38912
s_waitcnt lgkmcnt(8)
s_nop 0
v_pk_add_f32 v[16:17], v[16:17], v[32:33]
v_pk_add_f32 v[18:19], v[18:19], v[34:35]
v_pk_add_f32 v[20:21], v[20:21], v[36:37]
v_pk_add_f32 v[22:23], v[22:23], v[38:39]
v_pk_add_f32 v[24:25], v[24:25], v[40:41]
v_pk_add_f32 v[26:27], v[26:27], v[42:43]
v_pk_add_f32 v[28:29], v[28:29], v[44:45]
v_pk_add_f32 v[30:31], v[30:31], v[46:47]
v_pk_add_f32 v[16:17], v[16:17], v[80:81]
v_pk_add_f32 v[18:19], v[18:19], v[82:83]
v_pk_add_f32 v[20:21], v[20:21], v[84:85]
v_pk_add_f32 v[22:23], v[22:23], v[86:87]
v_pk_add_f32 v[24:25], v[24:25], v[88:89]
v_pk_add_f32 v[26:27], v[26:27], v[90:91]
v_pk_add_f32 v[28:29], v[28:29], v[92:93]
v_pk_add_f32 v[30:31], v[30:31], v[94:95]
s_waitcnt lgkmcnt(0)
s_nop 0
v_pk_add_f32 v[48:49], v[48:49], v[64:65]
v_pk_add_f32 v[50:51], v[50:51], v[66:67]
v_pk_add_f32 v[52:53], v[52:53], v[68:69]
v_pk_add_f32 v[54:55], v[54:55], v[70:71]
v_pk_add_f32 v[56:57], v[56:57], v[72:73]
v_pk_add_f32 v[58:59], v[58:59], v[74:75]
v_pk_add_f32 v[60:61], v[60:61], v[76:77]
v_pk_add_f32 v[62:63], v[62:63], v[78:79]
v_pk_add_f32 v[16:17], v[16:17], v[48:49]
v_pk_add_f32 v[18:19], v[18:19], v[50:51]
v_pk_add_f32 v[20:21], v[20:21], v[52:53]
v_pk_add_f32 v[22:23], v[22:23], v[54:55]
v_cvt_pk_bf16_f32 v96, v16, v17
v_cvt_pk_bf16_f32 v97, v18, v19
v_cvt_pk_bf16_f32 v98, v20, v21
v_cvt_pk_bf16_f32 v99, v22, v23
buffer_store_dwordx4 v[96:99], v222, s[36:39], s3 offen sc1
v_pk_add_f32 v[24:25], v[24:25], v[56:57]
v_pk_add_f32 v[26:27], v[26:27], v[58:59]
v_pk_add_f32 v[28:29], v[28:29], v[60:61]
v_pk_add_f32 v[30:31], v[30:31], v[62:63]
v_cvt_pk_bf16_f32 v100, v24, v25
v_cvt_pk_bf16_f32 v101, v26, v27
v_cvt_pk_bf16_f32 v102, v28, v29
v_cvt_pk_bf16_f32 v103, v30, v31
buffer_store_dwordx4 v[100:103], v223, s[36:39], s3 offen sc1
L_fin:
L_end:
s_endpgm
L_spin900:
s_mov_b32 s40, s22
s_and_b32 s41, s23, 0xffff
s_mov_b32 s42, 12582912
s_mov_b32 s43, 0x20000
v_mov_b32 v200, 0
v_mov_b32 v201, 0
v_mov_b32 v202, 0
v_mov_b32 v203, 0
v_lshrrev_b32 v204, 1, v193
v_and_b32 v205, 16, v1
v_lshl_add_u32 v204, v204, 7, v205
s_mov_b32 s4, 10567680
buffer_store_dwordx4 v[200:203], v1, s[40:43], s4 offen sc1
s_mov_b32 s4, 10551296
buffer_store_dwordx4 v[200:203], v204, s[40:43], s4 offen sc1
s_mov_b32 s4, 10555392
buffer_store_dwordx4 v[200:203], v204, s[40:43], s4 offen sc1
s_mov_b32 s4, 10559488
buffer_store_dwordx4 v[200:203], v204, s[40:43], s4 offen sc1
s_mov_b32 s4, 10563584
buffer_store_dwordx4 v[200:203], v204, s[40:43], s4 offen sc1
s_nop 1
s_branch L_ok900
L_spin901:
buffer_store_dword v225, v224, s[44:47], 0 offen offset:128 sc1
s_branch L_ok901
L_spin0:
s_mov_b32 s98, 0x8000
s_waitcnt vmcnt(0)
L_spinl0:
s_sleep 2
buffer_load_dword v227, off, s[44:47], 0 offset:128 sc1
s_waitcnt vmcnt(0)
v_cmp_eq_u32 vcc, 0, v227
s_cbranch_vccz L_ok0
s_sub_u32 s98, s98, 1
s_cmp_lg_u32 s98, 0
s_cbranch_scc1 L_spinl0
s_branch L_ok0
L_spin1:
s_mov_b32 s98, 0x8000
s_waitcnt vmcnt(0)
L_spinl1:
s_sleep 2
buffer_load_dwordx4 v[192:195], v239, s[40:43], s2 offen sc1
s_waitcnt vmcnt(0)
v_max3_u32 v230, v192, v193, v194
v_mov_b32 v231, v195
v_max_u32 v230, v230, v231
v_cmp_eq_u32 vcc, -1, v230
s_cbranch_vccz L_ok1
s_sub_u32 s98, s98, 1
s_cmp_lg_u32 s98, 0
s_cbranch_scc1 L_spinl1
s_branch L_ok1
L_spin2:
s_mov_b32 s98, 0x8000
s_waitcnt vmcnt(0)
L_spinl2:
s_sleep 2
buffer_load_dword v227, v229, s[40:43], s87 offen sc1
s_waitcnt vmcnt(0)
v_cmp_eq_u32 vcc, 0, v227
s_nop 0
s_and_b64 vcc, vcc, s[88:89]
s_cbranch_vccz L_ok2
s_sub_u32 s98, s98, 1
s_cmp_lg_u32 s98, 0
s_cbranch_scc1 L_spinl2
s_branch L_ok2
L_spin3:
s_mov_b32 s98, 0x8000
s_waitcnt vmcnt(0)
L_spinl3:
s_sleep 2
buffer_load_dword v227, v4, s[40:43], s85 offen sc1
s_waitcnt vmcnt(0)
v_cmp_gt_u32 vcc, 1, v227
s_cbranch_vccz L_ok3
s_sub_u32 s98, s98, 1
s_cmp_lg_u32 s98, 0
s_cbranch_scc1 L_spinl3
s_branch L_ok3
L_spin4:
s_mov_b32 s98, 0x8000
s_waitcnt vmcnt(0)
L_spinl4:
s_sleep 2
buffer_load_dwordx4 v[80:83], v1, s[40:43], s4 offen offset:2048 sc1
buffer_load_dwordx4 v[84:87], v198, s[40:43], s4 offen offset:2048 sc1
buffer_load_dwordx4 v[88:91], v1, s[40:43], s4 offen offset:3072 sc1
buffer_load_dwordx4 v[92:95], v198, s[40:43], s4 offen offset:3072 sc1
s_waitcnt vmcnt(0)
v_max3_u32 v230, v80, v81, v82
v_max3_u32 v231, v83, v84, v85
v_max3_u32 v230, v230, v86, v87
v_max3_u32 v231, v231, v88, v89
v_max3_u32 v230, v230, v90, v91
v_max3_u32 v231, v231, v92, v93
v_max3_u32 v230, v230, v94, v95
v_max_u32 v230, v230, v231
v_cmp_eq_u32 vcc, -1, v230
s_cbranch_vccz L_ok4
s_sub_u32 s98, s98, 1
s_cmp_lg_u32 s98, 0
s_cbranch_scc1 L_spinl4
s_branch L_ok4
L_spin5:
s_mov_b32 s98, 0x8000
s_waitcnt vmcnt(0)
L_spinl5:
s_sleep 2
s_add_u32 s101, s4, 8192
buffer_load_dwordx4 v[96:99], v1, s[40:43], s101 offen offset:2048 sc1
buffer_load_dwordx4 v[100:103], v198, s[40:43], s101 offen offset:2048 sc1
s_add_u32 s101, s4, 8192
buffer_load_dwordx4 v[104:107], v1, s[40:43], s101 offen offset:3072 sc1
buffer_load_dwordx4 v[108:111], v198, s[40:43], s101 offen offset:3072 sc1
s_waitcnt vmcnt(0)
v_max3_u32 v230, v96, v97, v98
v_max3_u32 v231, v99, v100, v101
v_max3_u32 v230, v230, v102, v103
v_max3_u32 v231, v231, v104, v105
v_max3_u32 v230, v230, v106, v107
v_max3_u32 v231, v231, v108, v109
v_max3_u32 v230, v230, v110, v111
v_max_u32 v230, v230, v231
v_cmp_eq_u32 vcc, -1, v230
s_cbranch_vccz L_ok5
s_sub_u32 s98, s98, 1
s_cmp_lg_u32 s98, 0
s_cbranch_scc1 L_spinl5
s_branch L_ok5
L_spin6:
s_mov_b32 s98, 0x8000
s_waitcnt vmcnt(0)
L_spinl6:
s_sleep 2
buffer_load_dwordx4 v[112:115], v1, s[40:43], s5 offen offset:2048 sc1
buffer_load_dwordx4 v[116:119], v198, s[40:43], s5 offen offset:2048 sc1
buffer_load_dwordx4 v[120:123], v1, s[40:43], s5 offen offset:3072 sc1
buffer_load_dwordx4 v[124:127], v198, s[40:43], s5 offen offset:3072 sc1
s_waitcnt vmcnt(0)
v_max3_u32 v230, v112, v113, v114
v_max3_u32 v231, v115, v116, v117
v_max3_u32 v230, v230, v118, v119
v_max3_u32 v231, v231, v120, v121
v_max3_u32 v230, v230, v122, v123
v_max3_u32 v231, v231, v124, v125
v_max3_u32 v230, v230, v126, v127
v_max_u32 v230, v230, v231
v_cmp_eq_u32 vcc, -1, v230
s_cbranch_vccz L_ok6
s_sub_u32 s98, s98, 1
s_cmp_lg_u32 s98, 0
s_cbranch_scc1 L_spinl6
s_branch L_ok6
L_spin7:
s_mov_b32 s98, 0x8000
s_waitcnt vmcnt(0)
L_spinl7:
s_sleep 2
s_add_u32 s101, s5, 8192
buffer_load_dwordx4 v[16:19], v1, s[40:43], s101 offen offset:2048 sc1
buffer_load_dwordx4 v[20:23], v198, s[40:43], s101 offen offset:2048 sc1
s_add_u32 s101, s5, 8192
buffer_load_dwordx4 v[24:27], v1, s[40:43], s101 offen offset:3072 sc1
buffer_load_dwordx4 v[28:31], v198, s[40:43], s101 offen offset:3072 sc1
s_waitcnt vmcnt(0)
v_max3_u32 v230, v16, v17, v18
v_max3_u32 v231, v19, v20, v21
v_max3_u32 v230, v230, v22, v23
v_max3_u32 v231, v231, v24, v25
v_max3_u32 v230, v230, v26, v27
v_max3_u32 v231, v231, v28, v29
v_max3_u32 v230, v230, v30, v31
v_max_u32 v230, v230, v231
v_cmp_eq_u32 vcc, -1, v230
s_cbranch_vccz L_ok7
s_sub_u32 s98, s98, 1
s_cmp_lg_u32 s98, 0
s_cbranch_scc1 L_spinl7
s_branch L_ok7
L_spin8:
s_mov_b32 s98, 0x8000
s_waitcnt vmcnt(0)
L_spinl8:
s_sleep 2
s_add_u32 s101, s4, 12288
buffer_load_dwordx4 v[32:35], v1, s[40:43], s101 offen offset:0 sc1
buffer_load_dwordx4 v[36:39], v198, s[40:43], s101 offen offset:0 sc1
s_add_u32 s101, s4, 12288
buffer_load_dwordx4 v[40:43], v1, s[40:43], s101 offen offset:1024 sc1
buffer_load_dwordx4 v[44:47], v198, s[40:43], s101 offen offset:1024 sc1
s_waitcnt vmcnt(0)
v_max3_u32 v230, v32, v33, v34
v_max3_u32 v231, v35, v36, v37
v_max3_u32 v230, v230, v38, v39
v_max3_u32 v231, v231, v40, v41
v_max3_u32 v230, v230, v42, v43
v_max3_u32 v231, v231, v44, v45
v_max3_u32 v230, v230, v46, v47
v_max_u32 v230, v230, v231
v_cmp_eq_u32 vcc, -1, v230
s_cbranch_vccz L_ok8
s_sub_u32 s98, s98, 1
s_cmp_lg_u32 s98, 0
s_cbranch_scc1 L_spinl8
s_branch L_ok8
L_spin9:
s_mov_b32 s98, 0x8000
s_waitcnt vmcnt(0)
L_spinl9:
s_sleep 2
s_add_u32 s101, s5, 12288
buffer_load_dwordx4 v[48:51], v1, s[40:43], s101 offen offset:0 sc1
buffer_load_dwordx4 v[52:55], v198, s[40:43], s101 offen offset:0 sc1
s_add_u32 s101, s5, 12288
buffer_load_dwordx4 v[56:59], v1, s[40:43], s101 offen offset:1024 sc1
buffer_load_dwordx4 v[60:63], v198, s[40:43], s101 offen offset:1024 sc1
s_waitcnt vmcnt(0)
v_max3_u32 v230, v48, v49, v50
v_max3_u32 v231, v51, v52, v53
v_max3_u32 v230, v230, v54, v55
v_max3_u32 v231, v231, v56, v57
v_max3_u32 v230, v230, v58, v59
v_max3_u32 v231, v231, v60, v61
v_max3_u32 v230, v230, v62, v63
v_max_u32 v230, v230, v231
v_cmp_eq_u32 vcc, -1, v230
s_cbranch_vccz L_ok9
s_sub_u32 s98, s98, 1
s_cmp_lg_u32 s98, 0
s_cbranch_scc1 L_spinl9
s_branch L_ok9
L_spin10:
s_mov_b32 s98, 0x8000
s_waitcnt vmcnt(0)
L_spinl10:
s_sleep 2
s_add_u32 s101, s4, 4096
buffer_load_dwordx4 v[64:67], v1, s[40:43], s101 offen offset:0 sc1
buffer_load_dwordx4 v[68:71], v198, s[40:43], s101 offen offset:0 sc1
s_add_u32 s101, s4, 4096
buffer_load_dwordx4 v[72:75], v1, s[40:43], s101 offen offset:1024 sc1
buffer_load_dwordx4 v[76:79], v198, s[40:43], s101 offen offset:1024 sc1
s_waitcnt vmcnt(0)
v_max3_u32 v230, v64, v65, v66
v_max3_u32 v231, v67, v68, v69
v_max3_u32 v230, v230, v70, v71
v_max3_u32 v231, v231, v72, v73
v_max3_u32 v230, v230, v74, v75
v_max3_u32 v231, v231, v76, v77
v_max3_u32 v230, v230, v78, v79
v_max_u32 v230, v230, v231
v_cmp_eq_u32 vcc, -1, v230
s_cbranch_vccz L_ok10
s_sub_u32 s98, s98, 1
s_cmp_lg_u32 s98, 0
s_cbranch_scc1 L_spinl10
s_branch L_ok10
L_spin11:
s_mov_b32 s98, 0x8000
s_waitcnt vmcnt(0)
L_spinl11:
s_sleep 2
s_add_u32 s101, s5, 4096
buffer_load_dwordx4 v[80:83], v1, s[40:43], s101 offen offset:0 sc1
buffer_load_dwordx4 v[84:87], v198, s[40:43], s101 offen offset:0 sc1
s_add_u32 s101, s5, 4096
buffer_load_dwordx4 v[88:91], v1, s[40:43], s101 offen offset:1024 sc1
buffer_load_dwordx4 v[92:95], v198, s[40:43], s101 offen offset:1024 sc1
s_waitcnt vmcnt(0)
v_max3_u32 v230, v80, v81, v82
v_max3_u32 v231, v83, v84, v85
v_max3_u32 v230, v230, v86, v87
v_max3_u32 v231, v231, v88, v89
v_max3_u32 v230, v230, v90, v91
v_max3_u32 v231, v231, v92, v93
v_max3_u32 v230, v230, v94, v95
v_max_u32 v230, v230, v231
v_cmp_eq_u32 vcc, -1, v230
s_cbranch_vccz L_ok11
s_sub_u32 s98, s98, 1
s_cmp_lg_u32 s98, 0
s_cbranch_scc1 L_spinl11
s_branch L_ok11
L_spin12:
s_mov_b32 s98, 0x8000
s_waitcnt vmcnt(0)
L_spinl12:
s_sleep 2
s_add_u32 s101, s4, 12288
buffer_load_dwordx4 v[96:99], v1, s[40:43], s101 offen offset:2048 sc1
buffer_load_dwordx4 v[100:103], v198, s[40:43], s101 offen offset:2048 sc1
s_add_u32 s101, s4, 12288
buffer_load_dwordx4 v[104:107], v1, s[40:43], s101 offen offset:3072 sc1
buffer_load_dwordx4 v[108:111], v198, s[40:43], s101 offen offset:3072 sc1
s_waitcnt vmcnt(0)
v_max3_u32 v230, v96, v97, v98
v_max3_u32 v231, v99, v100, v101
v_max3_u32 v230, v230, v102, v103
v_max3_u32 v231, v231, v104, v105
v_max3_u32 v230, v230, v106, v107
v_max3_u32 v231, v231, v108, v109
v_max3_u32 v230, v230, v110, v111
v_max_u32 v230, v230, v231
v_cmp_eq_u32 vcc, -1, v230
s_cbranch_vccz L_ok12
s_sub_u32 s98, s98, 1
s_cmp_lg_u32 s98, 0
s_cbranch_scc1 L_spinl12
s_branch L_ok12
L_spin13:
s_mov_b32 s98, 0x8000
s_waitcnt vmcnt(0)
L_spinl13:
s_sleep 2
s_add_u32 s101, s5, 12288
buffer_load_dwordx4 v[112:115], v1, s[40:43], s101 offen offset:2048 sc1
buffer_load_dwordx4 v[116:119], v198, s[40:43], s101 offen offset:2048 sc1
s_add_u32 s101, s5, 12288
buffer_load_dwordx4 v[120:123], v1, s[40:43], s101 offen offset:3072 sc1
buffer_load_dwordx4 v[124:127], v198, s[40:43], s101 offen offset:3072 sc1
s_waitcnt vmcnt(0)
v_max3_u32 v230, v112, v113, v114
v_max3_u32 v231, v115, v116, v117
v_max3_u32 v230, v230, v118, v119
v_max3_u32 v231, v231, v120, v121
v_max3_u32 v230, v230, v122, v123
v_max3_u32 v231, v231, v124, v125
v_max3_u32 v230, v230, v126, v127
v_max_u32 v230, v230, v231
v_cmp_eq_u32 vcc, -1, v230
s_cbranch_vccz L_ok13
s_sub_u32 s98, s98, 1
s_cmp_lg_u32 s98, 0
s_cbranch_scc1 L_spinl13
s_branch L_ok13
L_spin14:
s_mov_b32 s98, 0x8000
s_waitcnt vmcnt(0)
L_spinl14:
s_sleep 2
s_add_u32 s101, s4, 4096
buffer_load_dwordx4 v[16:19], v1, s[40:43], s101 offen offset:2048 sc1
buffer_load_dwordx4 v[20:23], v198, s[40:43], s101 offen offset:2048 sc1
s_add_u32 s101, s4, 4096
buffer_load_dwordx4 v[24:27], v1, s[40:43], s101 offen offset:3072 sc1
buffer_load_dwordx4 v[28:31], v198, s[40:43], s101 offen offset:3072 sc1
s_waitcnt vmcnt(0)
v_max3_u32 v230, v16, v17, v18
v_max3_u32 v231, v19, v20, v21
v_max3_u32 v230, v230, v22, v23
v_max3_u32 v231, v231, v24, v25
v_max3_u32 v230, v230, v26, v27
v_max3_u32 v231, v231, v28, v29
v_max3_u32 v230, v230, v30, v31
v_max_u32 v230, v230, v231
v_cmp_eq_u32 vcc, -1, v230
s_cbranch_vccz L_ok14
s_sub_u32 s98, s98, 1
s_cmp_lg_u32 s98, 0
s_cbranch_scc1 L_spinl14
s_branch L_ok14
L_spin15:
s_mov_b32 s98, 0x8000
s_waitcnt vmcnt(0)
L_spinl15:
s_sleep 2
s_add_u32 s101, s5, 4096
buffer_load_dwordx4 v[32:35], v1, s[40:43], s101 offen offset:2048 sc1
buffer_load_dwordx4 v[36:39], v198, s[40:43], s101 offen offset:2048 sc1
s_add_u32 s101, s5, 4096
buffer_load_dwordx4 v[40:43], v1, s[40:43], s101 offen offset:3072 sc1
buffer_load_dwordx4 v[44:47], v198, s[40:43], s101 offen offset:3072 sc1
s_waitcnt vmcnt(0)
v_max3_u32 v230, v32, v33, v34
v_max3_u32 v231, v35, v36, v37
v_max3_u32 v230, v230, v38, v39
v_max3_u32 v231, v231, v40, v41
v_max3_u32 v230, v230, v42, v43
v_max3_u32 v231, v231, v44, v45
v_max3_u32 v230, v230, v46, v47
v_max_u32 v230, v230, v231
v_cmp_eq_u32 vcc, -1, v230
s_cbranch_vccz L_ok15
s_sub_u32 s98, s98, 1
s_cmp_lg_u32 s98, 0
s_cbranch_scc1 L_spinl15
s_branch L_ok15
L_spin16:
s_mov_b32 s98, 0x8000
s_waitcnt vmcnt(0)
L_spinl16:
s_sleep 2
s_add_u32 s101, s4, 16384
buffer_load_dwordx4 v[48:51], v1, s[40:43], s101 offen offset:0 sc1
buffer_load_dwordx4 v[52:55], v198, s[40:43], s101 offen offset:0 sc1
s_waitcnt vmcnt(0)
v_max3_u32 v230, v48, v49, v50
v_max3_u32 v231, v51, v52, v53
v_max3_u32 v230, v230, v54, v55
v_max_u32 v230, v230, v231
v_cmp_eq_u32 vcc, -1, v230
s_cbranch_vccz L_ok16
s_sub_u32 s98, s98, 1
s_cmp_lg_u32 s98, 0
s_cbranch_scc1 L_spinl16
s_branch L_ok16
L_spin17:
s_mov_b32 s98, 0x8000
s_waitcnt vmcnt(0)
L_spinl17:
s_sleep 2
s_add_u32 s101, s4, 16384
buffer_load_dwordx4 v[56:59], v1, s[40:43], s101 offen offset:1024 sc1
buffer_load_dwordx4 v[60:63], v198, s[40:43], s101 offen offset:1024 sc1
s_add_u32 s101, s5, 16384
buffer_load_dwordx4 v[64:67], v1, s[40:43], s101 offen offset:0 sc1
buffer_load_dwordx4 v[68:71], v198, s[40:43], s101 offen offset:0 sc1
s_add_u32 s101, s5, 16384
buffer_load_dwordx4 v[72:75], v1, s[40:43], s101 offen offset:1024 sc1
buffer_load_dwordx4 v[76:79], v198, s[40:43], s101 offen offset:1024 sc1
s_waitcnt vmcnt(0)
v_max3_u32 v230, v56, v57, v58
v_max3_u32 v231, v59, v60, v61
v_max3_u32 v230, v230, v62, v63
v_max3_u32 v231, v231, v64, v65
v_max3_u32 v230, v230, v66, v67
v_max3_u32 v231, v231, v68, v69
v_max3_u32 v230, v230, v70, v71
v_max3_u32 v231, v231, v72, v73
v_max3_u32 v230, v230, v74, v75
v_max3_u32 v231, v231, v76, v77
v_max3_u32 v230, v230, v78, v79
v_max_u32 v230, v230, v231
v_cmp_eq_u32 vcc, -1, v230
s_cbranch_vccz L_ok17
s_sub_u32 s98, s98, 1
s_cmp_lg_u32 s98, 0
s_cbranch_scc1 L_spinl17
s_branch L_ok17
.p2align 6
L_typeB:
ds_read_b64_tr_b16 a[0:1], v9 offset:28672
ds_read_b64_tr_b16 a[2:3], v9 offset:28928
v_mfma_f32_32x32x16_bf16 a[48:63], a[12:15], v[120:123], a[48:63]
ds_read_b64_tr_b16 a[4:5], v9 offset:35840
ds_read_b64_tr_b16 a[6:7], v9 offset:36096
v_mfma_f32_32x32x16_bf16 v[128:143], a[16:19], v[124:127], v[128:143]
ds_read_b64_tr_b16 a[8:9], v9 offset:29696
ds_read_b64_tr_b16 a[10:11], v9 offset:29952
v_mfma_f32_32x32x16_bf16 a[32:47], a[20:23], v[124:127], a[32:47]
ds_read_b64_tr_b16 a[12:13], v9 offset:36864
ds_read_b64_tr_b16 a[14:15], v9 offset:37120
v_add_u32 v2, s70, v5
s_add_u32 m0, s72, 57344
v_mfma_f32_32x32x16_bf16 v[144:159], a[24:27], v[124:127], v[144:159]
ds_read_b64_tr_b16 a[16:17], v9 offset:30720
ds_read_b64_tr_b16 a[18:19], v9 offset:30976
buffer_load_dwordx4 v2, s[36:39], s48 offen offset:0 lds
v_add_u32 v232, 0x10000, v236
v_mfma_f32_32x32x16_bf16 a[48:63], a[28:31], v[124:127], a[48:63]
ds_read_b64_tr_b16 a[20:21], v9 offset:37888
ds_read_b64_tr_b16 a[22:23], v9 offset:38144
buffer_load_dwordx4 v2, s[36:39], s49 offen offset:1024 lds
v_add_u32 v233, 0x10000, v237
s_waitcnt lgkmcnt(4)
v_mfma_f32_32x32x16_bf16 v[160:175], a[0:3], v[16:19], 0
ds_read_b64_tr_b16 a[24:25], v9 offset:31744
ds_read_b64_tr_b16 a[26:27], v9 offset:32000
buffer_load_dwordx4 v2, s[36:39], s50 offen offset:2048 lds
v_mfma_f32_32x32x16_bf16 v[176:191], a[4:7], v[16:19], 0
ds_read_b64_tr_b16 a[28:29], v9 offset:38912
ds_read_b64_tr_b16 a[30:31], v9 offset:39168
v_mfma_f32_32x32x16_bf16 v[160:175], a[8:11], v[20:23], v[160:175]
ds_read_b64_tr_b16 a[0:1], v9 offset:32768
ds_read_b64_tr_b16 a[2:3], v9 offset:33024
buffer_load_dwordx4 v2, s[36:39], s51 offen offset:3072 lds
s_add_u32 m0, s72, 61440
v_mfma_f32_32x32x16_bf16 v[176:191], a[12:15], v[20:23], v[176:191]
ds_read_b64_tr_b16 a[4:5], v9 offset:39936
ds_read_b64_tr_b16 a[6:7], v9 offset:40192
buffer_load_dwordx4 v2, s[36:39], s52 offen offset:0 lds
v_mul_f32 v244, v128, v128
v_mul_f32 v245, v129, v129
v_mul_f32 v246, v130, v130
v_mul_f32 v247, v131, v131
v_fma_f32 v244, v244, v12, v11
v_fma_f32 v245, v245, v12, v11
v_fma_f32 v246, v246, v12, v11
v_fma_f32 v247, v247, v12, v11
v_mul_f32 v244, v244, v128
v_mul_f32 v245, v245, v129
v_mul_f32 v246, v246, v130
s_waitcnt lgkmcnt(4)
v_mfma_f32_32x32x16_bf16 v[160:175], a[16:19], v[24:27], v[160:175]
ds_read_b64_tr_b16 a[8:9], v9 offset:33792
ds_read_b64_tr_b16 a[10:11], v9 offset:34048
v_mul_f32 v247, v247, v131
v_accvgpr_read_b32 v240, a32
v_accvgpr_read_b32 v241, a33
v_accvgpr_read_b32 v242, a34
v_accvgpr_read_b32 v243, a35
v_exp_f32 v244, v244
v_exp_f32 v245, v245
v_exp_f32 v246, v246
v_mfma_f32_32x32x16_bf16 v[176:191], a[20:23], v[24:27], v[176:191]
ds_read_b64_tr_b16 a[12:13], v9 offset:40960
ds_read_b64_tr_b16 a[14:15], v9 offset:41216
buffer_load_dwordx4 v2, s[36:39], s53 offen offset:1024 lds
v_exp_f32 v247, v247
v_mul_f32 v128, v128, v240
v_mul_f32 v129, v129, v241
v_mul_f32 v130, v130, v242
v_mul_f32 v131, v131, v243
v_fma_f32 v244, v244, v13, v13
v_fma_f32 v245, v245, v13, v13
v_fma_f32 v246, v246, v13, v13
v_fma_f32 v247, v247, v13, v13
v_rcp_f32 v244, v244
v_mfma_f32_32x32x16_bf16 v[160:175], a[24:27], v[28:31], v[160:175]
ds_read_b64_tr_b16 a[16:17], v9 offset:34816
ds_read_b64_tr_b16 a[18:19], v9 offset:35072
buffer_load_dwordx4 v2, s[36:39], s54 offen offset:2048 lds
v_rcp_f32 v245, v245
v_rcp_f32 v246, v246
v_rcp_f32 v247, v247
v_mul_f32 v128, v128, v244
v_mul_f32 v129, v129, v245
v_mul_f32 v130, v130, v246
v_mul_f32 v131, v131, v247
v_mfma_f32_32x32x16_bf16 v[176:191], a[28:31], v[28:31], v[176:191]
ds_read_b64_tr_b16 a[20:21], v9 offset:41984
ds_read_b64_tr_b16 a[22:23], v9 offset:42240
v_cvt_pk_bf16_f32 v248, v128, v129
v_cvt_pk_bf16_f32 v249, v130, v131
v_mul_f32 v244, v132, v132
v_mul_f32 v245, v133, v133
v_mul_f32 v246, v134, v134
v_mul_f32 v247, v135, v135
v_fma_f32 v244, v244, v12, v11
v_fma_f32 v245, v245, v12, v11
v_fma_f32 v246, v246, v12, v11
v_fma_f32 v247, v247, v12, v11
v_mul_f32 v244, v244, v132
s_waitcnt lgkmcnt(4)
v_mfma_f32_32x32x16_bf16 v[160:175], a[0:3], v[32:35], v[160:175]
ds_read_b64_tr_b16 a[24:25], v9 offset:43008
ds_read_b64_tr_b16 a[26:27], v9 offset:43264
v_mul_f32 v245, v245, v133
v_mul_f32 v246, v246, v134
v_mul_f32 v247, v247, v135
v_accvgpr_read_b32 v240, a36
v_accvgpr_read_b32 v241, a37
v_accvgpr_read_b32 v242, a38
v_accvgpr_read_b32 v243, a39
v_exp_f32 v244, v244
v_exp_f32 v245, v245
v_mfma_f32_32x32x16_bf16 v[176:191], a[4:7], v[32:35], v[176:191]
ds_read_b64_tr_b16 a[28:29], v9 offset:50176
ds_read_b64_tr_b16 a[30:31], v9 offset:50432
v_exp_f32 v246, v246
v_exp_f32 v247, v247
v_mul_f32 v132, v132, v240
v_mul_f32 v133, v133, v241
v_mul_f32 v134, v134, v242
v_mul_f32 v135, v135, v243
v_fma_f32 v244, v244, v13, v13
v_fma_f32 v245, v245, v13, v13
v_fma_f32 v246, v246, v13, v13
s_add_u32 m0, s73, 24576
s_add_u32 s11, s15, 28672
v_mfma_f32_32x32x16_bf16 v[160:175], a[8:11], v[36:39], v[160:175]
ds_read_b64_tr_b16 a[0:1], v9 offset:44032
ds_read_b64_tr_b16 a[2:3], v9 offset:44288
buffer_load_dwordx4 v6, s[28:31], s11 offen lds
buffer_load_dwordx4 v7, s[28:31], s11 offen offset:1024 lds
v_fma_f32 v247, v247, v13, v13
v_rcp_f32 v244, v244
v_rcp_f32 v245, v245
v_rcp_f32 v246, v246
v_rcp_f32 v247, v247
v_mul_f32 v132, v132, v244
v_mul_f32 v133, v133, v245
v_mfma_f32_32x32x16_bf16 v[176:191], a[12:15], v[36:39], v[176:191]
ds_read_b64_tr_b16 a[4:5], v9 offset:51200
ds_read_b64_tr_b16 a[6:7], v9 offset:51456
v_mul_f32 v134, v134, v246
v_mul_f32 v135, v135, v247
v_cvt_pk_bf16_f32 v250, v132, v133
v_cvt_pk_bf16_f32 v251, v134, v135
s_waitcnt vmcnt(13) lgkmcnt(4)
v_mfma_f32_32x32x16_bf16 v[160:175], a[16:19], v[40:43], v[160:175]
ds_read_b64_tr_b16 a[8:9], v9 offset:45056
ds_read_b64_tr_b16 a[10:11], v9 offset:45312
ds_read_b64_tr_b16 a[184:185], v236 offset:0
ds_read_b64_tr_b16 a[186:187], v236 offset:1024
ds_read_b64_tr_b16 a[188:189], v237 offset:0
ds_read_b64_tr_b16 a[190:191], v237 offset:1024
buffer_store_dwordx4 v[248:251], v1, s[40:43], s74 offen offset:0 sc1
v_mul_f32 v244, v136, v136
v_mul_f32 v245, v137, v137
v_mul_f32 v246, v138, v138
v_mul_f32 v247, v139, v139
v_fma_f32 v244, v244, v12, v11
v_fma_f32 v245, v245, v12, v11
v_fma_f32 v246, v246, v12, v11
v_fma_f32 v247, v247, v12, v11
v_mul_f32 v244, v244, v136
v_mul_f32 v245, v245, v137
v_mul_f32 v246, v246, v138
v_mul_f32 v247, v247, v139
v_accvgpr_read_b32 v240, a40
v_accvgpr_read_b32 v241, a41
v_accvgpr_read_b32 v242, a42
v_accvgpr_read_b32 v243, a43
v_exp_f32 v244, v244
v_max3_u32 v230, v192, v193, v194
v_mov_b32 v231, v195
v_max_u32 v230, v230, v231
v_cmp_eq_u32 vcc, -1, v230
v_mfma_f32_32x32x16_bf16 v[176:191], a[20:23], v[40:43], v[176:191]
ds_read_b64_tr_b16 a[12:13], v9 offset:52224
ds_read_b64_tr_b16 a[14:15], v9 offset:52480
v_exp_f32 v245, v245
v_exp_f32 v246, v246
v_exp_f32 v247, v247
v_mul_f32 v136, v136, v240
v_mul_f32 v137, v137, v241
v_mul_f32 v138, v138, v242
v_mul_f32 v139, v139, v243
s_cbranch_vccnz L_spin1_B
L_ok1_B:
v_add_f32_dpp v192, v192, v192 row_ror:4 row_mask:0xf bank_mask:0xf
v_add_f32_dpp v193, v193, v193 row_ror:4 row_mask:0xf bank_mask:0xf
v_add_f32_dpp v194, v194, v194 row_ror:4 row_mask:0xf bank_mask:0xf
s_add_u32 m0, s73, 32768
s_add_u32 s11, s15, 43008
v_mfma_f32_32x32x16_bf16 v[160:175], a[24:27], v[44:47], v[160:175]
ds_read_b64_tr_b16 a[16:17], v9 offset:46080
ds_read_b64_tr_b16 a[18:19], v9 offset:46336
buffer_load_dwordx4 v6, s[28:31], s11 offen lds
buffer_load_dwordx4 v7, s[28:31], s11 offen offset:1024 lds
v_fma_f32 v244, v244, v13, v13
v_fma_f32 v245, v245, v13, v13
v_fma_f32 v246, v246, v13, v13
v_fma_f32 v247, v247, v13, v13
v_rcp_f32 v244, v244
v_rcp_f32 v245, v245
v_rcp_f32 v246, v246
v_rcp_f32 v247, v247
v_add_f32_dpp v195, v195, v195 row_ror:4 row_mask:0xf bank_mask:0xf
v_add_f32_dpp v192, v192, v192 row_ror:8 row_mask:0xf bank_mask:0xf
v_add_f32_dpp v193, v193, v193 row_ror:8 row_mask:0xf bank_mask:0xf
v_add_f32_dpp v194, v194, v194 row_ror:8 row_mask:0xf bank_mask:0xf
v_mfma_f32_32x32x16_bf16 v[176:191], a[28:31], v[44:47], v[176:191]
ds_read_b64_tr_b16 a[20:21], v9 offset:53248
ds_read_b64_tr_b16 a[22:23], v9 offset:53504
v_mul_f32 v136, v136, v244
v_mul_f32 v137, v137, v245
v_mul_f32 v138, v138, v246
v_mul_f32 v139, v139, v247
v_cvt_pk_bf16_f32 v252, v136, v137
v_cvt_pk_bf16_f32 v253, v138, v139
v_mul_f32 v244, v140, v140
v_mul_f32 v245, v141, v141
v_mul_f32 v246, v142, v142
v_mul_f32 v247, v143, v143
v_add_f32_dpp v195, v195, v195 row_ror:8 row_mask:0xf bank_mask:0xf
v_mov_b32 v196, v192
v_mov_b32 v197, v193
v_mov_b32 v198, v194
s_waitcnt vmcnt(14) lgkmcnt(4)
v_mfma_f32_32x32x16_bf16 v[160:175], a[0:3], v[48:51], v[160:175]
ds_read_b64_tr_b16 a[24:25], v9 offset:47104
ds_read_b64_tr_b16 a[26:27], v9 offset:47360
ds_read_b64_tr_b16 a[192:193], v236 offset:8192
ds_read_b64_tr_b16 a[194:195], v236 offset:9216
ds_read_b64_tr_b16 a[196:197], v237 offset:8192
ds_read_b64_tr_b16 a[198:199], v237 offset:9216
v_fma_f32 v244, v244, v12, v11
v_fma_f32 v245, v245, v12, v11
v_fma_f32 v246, v246, v12, v11
v_fma_f32 v247, v247, v12, v11
v_mul_f32 v244, v244, v140
v_mul_f32 v245, v245, v141
v_mul_f32 v246, v246, v142
v_mul_f32 v247, v247, v143
v_accvgpr_read_b32 v240, a44
v_accvgpr_read_b32 v241, a45
v_accvgpr_read_b32 v242, a46
v_mov_b32 v199, v195
v_permlane16_swap_b32 v192, v196
v_permlane16_swap_b32 v193, v197
v_permlane16_swap_b32 v194, v198
v_mfma_f32_32x32x16_bf16 v[176:191], a[4:7], v[48:51], v[176:191]
ds_read_b64_tr_b16 a[28:29], v9 offset:54272
ds_read_b64_tr_b16 a[30:31], v9 offset:54528
v_accvgpr_read_b32 v243, a47
v_exp_f32 v244, v244
v_exp_f32 v245, v245
v_exp_f32 v246, v246
v_exp_f32 v247, v247
v_mul_f32 v140, v140, v240
v_mul_f32 v141, v141, v241
v_permlane16_swap_b32 v195, v199
v_add_f32 v192, v192, v196
v_add_f32 v193, v193, v197
v_add_f32 v194, v194, v198
s_add_u32 m0, s73, 0
s_add_u32 s11, s20, 0
v_mfma_f32_32x32x16_bf16 v[160:175], a[8:11], v[52:55], v[160:175]
ds_read_b64_tr_b16 a[0:1], v9 offset:48128
ds_read_b64_tr_b16 a[2:3], v9 offset:48384
buffer_load_dwordx4 v6, s[28:31], s11 offen lds
buffer_load_dwordx4 v7, s[28:31], s11 offen offset:1024 lds
v_mul_f32 v142, v142, v242
v_mul_f32 v143, v143, v243
v_fma_f32 v244, v244, v13, v13
v_fma_f32 v245, v245, v13, v13
v_fma_f32 v246, v246, v13, v13
v_fma_f32 v247, v247, v13, v13
v_rcp_f32 v244, v244
v_rcp_f32 v245, v245
v_rcp_f32 v246, v246
v_add_f32 v195, v195, v199
v_mov_b32 v196, v192
v_mov_b32 v197, v193
v_mov_b32 v198, v194
v_mfma_f32_32x32x16_bf16 v[176:191], a[12:15], v[52:55], v[176:191]
ds_read_b64_tr_b16 a[4:5], v9 offset:55296
ds_read_b64_tr_b16 a[6:7], v9 offset:55552
v_rcp_f32 v247, v247
v_mul_f32 v140, v140, v244
v_mul_f32 v141, v141, v245
v_mul_f32 v142, v142, v246
v_mul_f32 v143, v143, v247
v_cvt_pk_bf16_f32 v254, v140, v141
v_cvt_pk_bf16_f32 v255, v142, v143
v_mov_b32 v199, v195
v_permlane32_swap_b32 v192, v196
v_permlane32_swap_b32 v193, v197
v_permlane32_swap_b32 v194, v198
s_waitcnt vmcnt(14) lgkmcnt(4)
v_mfma_f32_32x32x16_bf16 v[160:175], a[16:19], v[56:59], v[160:175]
ds_read_b64_tr_b16 a[8:9], v9 offset:49152
ds_read_b64_tr_b16 a[10:11], v9 offset:49408
ds_read_b64_tr_b16 a[200:201], v236 offset:16384
ds_read_b64_tr_b16 a[202:203], v236 offset:17408
ds_read_b64_tr_b16 a[204:205], v237 offset:16384
ds_read_b64_tr_b16 a[206:207], v237 offset:17408
buffer_store_dwordx4 v[252:255], v1, s[40:43], s74 offen offset:1024 sc1
v_mul_f32 v244, v144, v144
v_mul_f32 v245, v145, v145
v_mul_f32 v246, v146, v146
v_mul_f32 v247, v147, v147
v_fma_f32 v244, v244, v12, v11
v_fma_f32 v245, v245, v12, v11
v_permlane32_swap_b32 v195, v199
v_add_f32 v192, v192, v196
v_add_f32 v193, v193, v197
v_add_f32 v194, v194, v198
v_mfma_f32_32x32x16_bf16 v[176:191], a[20:23], v[56:59], v[176:191]
ds_read_b64_tr_b16 a[12:13], v9 offset:56320
ds_read_b64_tr_b16 a[14:15], v9 offset:56576
v_fma_f32 v246, v246, v12, v11
v_fma_f32 v247, v247, v12, v11
v_mul_f32 v244, v244, v144
v_mul_f32 v245, v245, v145
v_mul_f32 v246, v246, v146
v_add_f32 v195, v195, v199
v_cvt_pk_bf16_f32 v196, v192, v193
v_cvt_pk_bf16_f32 v197, v194, v195
v_mfma_f32_32x32x16_bf16 v[160:175], a[24:27], v[60:63], v[160:175]
s_waitcnt lgkmcnt(0)
s_barrier
ds_read_b64_tr_b16 a[16:17], v10 offset:0
ds_read_b64_tr_b16 a[18:19], v10 offset:256
buffer_store_dwordx2 v[196:197], v238, s[40:43], s7 offen sc1
v_mul_f32 v247, v247, v147
v_accvgpr_read_b32 v240, a48
v_accvgpr_read_b32 v241, a49
v_accvgpr_read_b32 v242, a50
v_accvgpr_read_b32 v243, a51
v_mfma_f32_32x32x16_bf16 v[176:191], a[28:31], v[60:63], v[176:191]
ds_read_b64_tr_b16 a[20:21], v10 offset:7168
ds_read_b64_tr_b16 a[22:23], v10 offset:7424
v_exp_f32 v244, v244
v_exp_f32 v245, v245
v_exp_f32 v246, v246
v_mfma_f32_32x32x16_bf16 v[160:175], a[0:3], v[64:67], v[160:175]
ds_read_b64_tr_b16 a[24:25], v10 offset:1024
ds_read_b64_tr_b16 a[26:27], v10 offset:1280
v_exp_f32 v247, v247
v_mul_f32 v144, v144, v240
v_mul_f32 v145, v145, v241
v_mul_f32 v146, v146, v242
v_mfma_f32_32x32x16_bf16 v[176:191], a[4:7], v[64:67], v[176:191]
ds_read_b64_tr_b16 a[28:29], v10 offset:8192
ds_read_b64_tr_b16 a[30:31], v10 offset:8448
v_mul_f32 v147, v147, v243
v_fma_f32 v244, v244, v13, v13
v_fma_f32 v245, v245, v13, v13
v_fma_f32 v246, v246, v13, v13
v_fma_f32 v247, v247, v13, v13
v_add_u32 v2, s71, v5
s_add_u32 m0, s72, 86016
v_mfma_f32_32x32x16_bf16 v[160:175], a[8:11], v[68:71], v[160:175]
ds_read_b64_tr_b16 a[0:1], v10 offset:2048
ds_read_b64_tr_b16 a[2:3], v10 offset:2304
buffer_load_dwordx4 v2, s[36:39], s48 offen offset:0 lds
v_rcp_f32 v244, v244
v_rcp_f32 v245, v245
v_rcp_f32 v246, v246
v_mfma_f32_32x32x16_bf16 v[176:191], a[12:15], v[68:71], v[176:191]
ds_read_b64_tr_b16 a[4:5], v10 offset:9216
ds_read_b64_tr_b16 a[6:7], v10 offset:9472
buffer_load_dwordx4 v2, s[36:39], s49 offen offset:1024 lds
v_rcp_f32 v247, v247
v_mul_f32 v144, v144, v244
v_mul_f32 v145, v145, v245
v_mul_f32 v146, v146, v246
s_waitcnt lgkmcnt(4)
v_mfma_f32_32x32x16_bf16 v[160:175], a[16:19], v[72:75], v[160:175]
ds_read_b64_tr_b16 a[8:9], v10 offset:3072
ds_read_b64_tr_b16 a[10:11], v10 offset:3328
buffer_load_dwordx4 v2, s[36:39], s50 offen offset:2048 lds
v_mul_f32 v147, v147, v247
v_cvt_pk_bf16_f32 v248, v144, v145
v_cvt_pk_bf16_f32 v249, v146, v147
v_mul_f32 v244, v148, v148
v_mul_f32 v245, v149, v149
v_mfma_f32_32x32x16_bf16 v[176:191], a[20:23], v[72:75], v[176:191]
ds_read_b64_tr_b16 a[12:13], v10 offset:10240
ds_read_b64_tr_b16 a[14:15], v10 offset:10496
v_mul_f32 v246, v150, v150
v_mul_f32 v247, v151, v151
v_fma_f32 v244, v244, v12, v11
v_fma_f32 v245, v245, v12, v11
v_fma_f32 v246, v246, v12, v11
v_fma_f32 v247, v247, v12, v11
v_mfma_f32_32x32x16_bf16 v[160:175], a[24:27], v[76:79], v[160:175]
ds_read_b64_tr_b16 a[16:17], v10 offset:4096
ds_read_b64_tr_b16 a[18:19], v10 offset:4352
buffer_load_dwordx4 v2, s[36:39], s51 offen offset:3072 lds
v_mul_f32 v244, v244, v148
v_mul_f32 v245, v245, v149
v_mul_f32 v246, v246, v150
v_mul_f32 v247, v247, v151
v_accvgpr_read_b32 v240, a52
s_add_u32 m0, s72, 90112
v_mfma_f32_32x32x16_bf16 v[176:191], a[28:31], v[76:79], v[176:191]
ds_read_b64_tr_b16 a[20:21], v10 offset:11264
ds_read_b64_tr_b16 a[22:23], v10 offset:11520
buffer_load_dwordx4 v2, s[36:39], s52 offen offset:0 lds
v_accvgpr_read_b32 v241, a53
v_accvgpr_read_b32 v242, a54
v_accvgpr_read_b32 v243, a55
v_exp_f32 v244, v244
s_waitcnt lgkmcnt(4)
v_mfma_f32_32x32x16_bf16 v[160:175], a[0:3], v[80:83], v[160:175]
ds_read_b64_tr_b16 a[24:25], v10 offset:5120
ds_read_b64_tr_b16 a[26:27], v10 offset:5376
v_exp_f32 v245, v245
v_exp_f32 v246, v246
v_exp_f32 v247, v247
v_bfe_u32 v230, v1, 6, 2
v_lshrrev_b32 v231, 9, v1
v_mul_u32_u24 v231, 7168, v231
v_mfma_f32_32x32x16_bf16 v[176:191], a[4:7], v[80:83], v[176:191]
ds_read_b64_tr_b16 a[28:29], v10 offset:12288
ds_read_b64_tr_b16 a[30:31], v10 offset:12544
buffer_load_dwordx4 v2, s[36:39], s53 offen offset:1024 lds
v_mul_f32 v148, v148, v240
v_mul_f32 v149, v149, v241
v_mul_f32 v150, v150, v242
v_mul_f32 v151, v151, v243
v_fma_f32 v244, v244, v13, v13
v_lshl_add_u32 v231, v230, 7, v231
v_add_u32 v231, 57344, v231
v_and_b32 v230, 0x7f, v236
v_mfma_f32_32x32x16_bf16 v[160:175], a[8:11], v[84:87], v[160:175]
ds_read_b64_tr_b16 a[0:1], v10 offset:6144
ds_read_b64_tr_b16 a[2:3], v10 offset:6400
buffer_load_dwordx4 v2, s[36:39], s54 offen offset:2048 lds
v_fma_f32 v245, v245, v13, v13
v_fma_f32 v246, v246, v13, v13
v_fma_f32 v247, v247, v13, v13
v_rcp_f32 v244, v244
v_add_u32 v234, v230, v231
v_and_b32 v235, 64, v230
v_and_b32 v230, 63, v230
v_mfma_f32_32x32x16_bf16 v[176:191], a[12:15], v[84:87], v[176:191]
ds_read_b64_tr_b16 a[4:5], v10 offset:13312
ds_read_b64_tr_b16 a[6:7], v10 offset:13568
v_rcp_f32 v245, v245
v_rcp_f32 v246, v246
v_rcp_f32 v247, v247
v_add_u32 v230, 56, v230
v_xor_b32 v230, v230, v235
v_add_u32 v235, v230, v231
s_waitcnt lgkmcnt(4)
v_mfma_f32_32x32x16_bf16 v[160:175], a[16:19], v[88:91], v[160:175]
ds_read_b64_tr_b16 a[8:9], v10 offset:14336
ds_read_b64_tr_b16 a[10:11], v10 offset:14592
v_mul_f32 v148, v148, v244
v_mul_f32 v149, v149, v245
v_mul_f32 v150, v150, v246
v_mul_f32 v151, v151, v247
v_cvt_pk_bf16_f32 v250, v148, v149
v_mfma_f32_32x32x16_bf16 v[176:191], a[20:23], v[88:91], v[176:191]
ds_read_b64_tr_b16 a[12:13], v10 offset:21504
ds_read_b64_tr_b16 a[14:15], v10 offset:21760
v_cvt_pk_bf16_f32 v251, v150, v151
s_add_u32 m0, s73, 8192
s_add_u32 s11, s20, 14336
v_mfma_f32_32x32x16_bf16 v[160:175], a[24:27], v[92:95], v[160:175]
ds_read_b64_tr_b16 a[16:17], v10 offset:15360
ds_read_b64_tr_b16 a[18:19], v10 offset:15616
buffer_store_dwordx4 v[248:251], v1, s[40:43], s74 offen offset:2048 sc1
buffer_load_dwordx4 v6, s[28:31], s11 offen lds
buffer_load_dwordx4 v7, s[28:31], s11 offen offset:1024 lds
v_mul_f32 v244, v152, v152
v_mul_f32 v245, v153, v153
v_mul_f32 v246, v154, v154
v_mul_f32 v247, v155, v155
v_fma_f32 v244, v244, v12, v11
v_fma_f32 v245, v245, v12, v11
v_fma_f32 v246, v246, v12, v11
v_fma_f32 v247, v247, v12, v11
v_mfma_f32_32x32x16_bf16 v[176:191], a[28:31], v[92:95], v[176:191]
ds_read_b64_tr_b16 a[20:21], v10 offset:22528
ds_read_b64_tr_b16 a[22:23], v10 offset:22784
v_mul_f32 v244, v244, v152
v_mul_f32 v245, v245, v153
v_mul_f32 v246, v246, v154
v_mul_f32 v247, v247, v155
v_accvgpr_read_b32 v240, a56
v_accvgpr_read_b32 v241, a57
s_waitcnt vmcnt(17) lgkmcnt(4)
v_mfma_f32_32x32x16_bf16 v[160:175], a[0:3], v[96:99], v[160:175]
ds_read_b64_tr_b16 a[24:25], v10 offset:16384
ds_read_b64_tr_b16 a[26:27], v10 offset:16640
ds_read_b64_tr_b16 a[208:209], v236 offset:24576
ds_read_b64_tr_b16 a[210:211], v236 offset:25600
ds_read_b64_tr_b16 a[212:213], v237 offset:24576
ds_read_b64_tr_b16 a[214:215], v237 offset:25600
v_accvgpr_read_b32 v242, a58
v_accvgpr_read_b32 v243, a59
v_exp_f32 v244, v244
v_exp_f32 v245, v245
v_mfma_f32_32x32x16_bf16 v[176:191], a[4:7], v[96:99], v[176:191]
ds_read_b64_tr_b16 a[28:29], v10 offset:23552
ds_read_b64_tr_b16 a[30:31], v10 offset:23808
v_exp_f32 v246, v246
v_exp_f32 v247, v247
s_add_u32 m0, s73, 16384
s_add_u32 s11, s21, 0
v_mfma_f32_32x32x16_bf16 v[160:175], a[8:11], v[100:103], v[160:175]
ds_read_b64_tr_b16 a[0:1], v10 offset:17408
ds_read_b64_tr_b16 a[2:3], v10 offset:17664
buffer_load_dwordx4 v6, s[28:31], s11 offen lds
buffer_load_dwordx4 v7, s[28:31], s11 offen offset:1024 lds
v_mul_f32 v152, v152, v240
v_mul_f32 v153, v153, v241
v_mul_f32 v154, v154, v242
v_mul_f32 v155, v155, v243
v_fma_f32 v244, v244, v13, v13
v_fma_f32 v245, v245, v13, v13
v_mfma_f32_32x32x16_bf16 v[176:191], a[12:15], v[100:103], v[176:191]
ds_read_b64_tr_b16 a[4:5], v10 offset:24576
ds_read_b64_tr_b16 a[6:7], v10 offset:24832
v_fma_f32 v246, v246, v13, v13
v_fma_f32 v247, v247, v13, v13
v_rcp_f32 v244, v244
v_rcp_f32 v245, v245
s_waitcnt vmcnt(16) lgkmcnt(4)
v_mfma_f32_32x32x16_bf16 v[160:175], a[16:19], v[104:107], v[160:175]
ds_read_b64_tr_b16 a[8:9], v10 offset:18432
ds_read_b64_tr_b16 a[10:11], v10 offset:18688
ds_read_b64_tr_b16 a[216:217], v236 offset:32768
ds_read_b64_tr_b16 a[218:219], v236 offset:33792
ds_read_b64_tr_b16 a[220:221], v237 offset:32768
ds_read_b64_tr_b16 a[222:223], v237 offset:33792
v_rcp_f32 v246, v246
v_rcp_f32 v247, v247
v_mfma_f32_32x32x16_bf16 v[176:191], a[20:23], v[104:107], v[176:191]
ds_read_b64_tr_b16 a[12:13], v10 offset:25600
ds_read_b64_tr_b16 a[14:15], v10 offset:25856
v_mul_f32 v152, v152, v244
v_mul_f32 v153, v153, v245
v_mul_f32 v154, v154, v246
v_mul_f32 v155, v155, v247
v_cvt_pk_bf16_f32 v252, v152, v153
v_cvt_pk_bf16_f32 v253, v154, v155
s_add_u32 m0, s73, 24576
s_add_u32 s11, s21, 14336
v_mfma_f32_32x32x16_bf16 v[160:175], a[24:27], v[108:111], v[160:175]
ds_read_b64_tr_b16 a[16:17], v10 offset:19456
ds_read_b64_tr_b16 a[18:19], v10 offset:19712
buffer_load_dwordx4 v6, s[28:31], s11 offen lds
buffer_load_dwordx4 v7, s[28:31], s11 offen offset:1024 lds
v_mul_f32 v244, v156, v156
v_mul_f32 v245, v157, v157
v_mul_f32 v246, v158, v158
v_mul_f32 v247, v159, v159
v_fma_f32 v244, v244, v12, v11
v_mfma_f32_32x32x16_bf16 v[176:191], a[28:31], v[108:111], v[176:191]
ds_read_b64_tr_b16 a[20:21], v10 offset:26624
ds_read_b64_tr_b16 a[22:23], v10 offset:26880
v_fma_f32 v245, v245, v12, v11
v_fma_f32 v246, v246, v12, v11
v_fma_f32 v247, v247, v12, v11
v_mul_f32 v244, v244, v156
v_mul_f32 v245, v245, v157
s_waitcnt vmcnt(16) lgkmcnt(4)
v_mfma_f32_32x32x16_bf16 v[160:175], a[0:3], v[112:115], v[160:175]
ds_read_b64_tr_b16 a[24:25], v10 offset:20480
ds_read_b64_tr_b16 a[26:27], v10 offset:20736
ds_read_b64_tr_b16 a[224:225], v236 offset:0
ds_read_b64_tr_b16 a[226:227], v236 offset:1024
ds_read_b64_tr_b16 a[228:229], v237 offset:0
ds_read_b64_tr_b16 a[230:231], v237 offset:1024
buffer_load_dword v227, v229, s[40:43], s87 offen sc1
v_mul_f32 v246, v246, v158
v_mul_f32 v247, v247, v159
v_accvgpr_read_b32 v240, a60
v_accvgpr_read_b32 v241, a61
v_accvgpr_read_b32 v242, a62
v_accvgpr_read_b32 v243, a63
s_waitcnt vmcnt(16)
v_mov_b32 v225, 1
v_mfma_f32_32x32x16_bf16 v[176:191], a[4:7], v[112:115], v[176:191]
ds_read_b64_tr_b16 a[28:29], v10 offset:27648
ds_read_b64_tr_b16 a[30:31], v10 offset:27904
buffer_store_dword v225, v224, s[40:43], s84 offen sc1
v_exp_f32 v244, v244
v_exp_f32 v245, v245
v_exp_f32 v246, v246
s_add_u32 m0, s73, 32768
s_add_u32 s11, s12, 57344
v_mfma_f32_32x32x16_bf16 v[160:175], a[8:11], v[116:119], v[160:175]
s_waitcnt lgkmcnt(0)
s_barrier
ds_read_b64_tr_b16 a[0:1], v234 offset:0
ds_read_b64_tr_b16 a[2:3], v234 offset:512
buffer_load_dwordx4 v6, s[28:31], s11 offen lds
buffer_load_dwordx4 v7, s[28:31], s11 offen offset:1024 lds
v_exp_f32 v247, v247
v_mul_f32 v156, v156, v240
v_mul_f32 v157, v157, v241
v_mfma_f32_32x32x16_bf16 v[176:191], a[12:15], v[116:119], v[176:191]
ds_read_b64_tr_b16 a[4:5], v235 offset:0
ds_read_b64_tr_b16 a[6:7], v235 offset:512
v_mul_f32 v158, v158, v242
v_mul_f32 v159, v159, v243
v_fma_f32 v244, v244, v13, v13
v_fma_f32 v245, v245, v13, v13
v_fma_f32 v246, v246, v13, v13
v_fma_f32 v247, v247, v13, v13
v_mfma_f32_32x32x16_bf16 v[160:175], a[16:19], v[120:123], v[160:175]
ds_read_b64_tr_b16 a[8:9], v234 offset:1024
ds_read_b64_tr_b16 a[10:11], v234 offset:1536
v_rcp_f32 v244, v244
v_rcp_f32 v245, v245
v_rcp_f32 v246, v246
v_mfma_f32_32x32x16_bf16 v[176:191], a[20:23], v[120:123], v[176:191]
ds_read_b64_tr_b16 a[12:13], v235 offset:1024
ds_read_b64_tr_b16 a[14:15], v235 offset:1536
v_rcp_f32 v247, v247
v_mul_f32 v156, v156, v244
v_mul_f32 v157, v157, v245
s_add_u32 m0, s73, 0
s_add_u32 s11, s12, 71680
v_mfma_f32_32x32x16_bf16 v[160:175], a[24:27], v[124:127], v[160:175]
ds_read_b64_tr_b16 a[16:17], v234 offset:2048
ds_read_b64_tr_b16 a[18:19], v234 offset:2560
buffer_load_dwordx4 v6, s[28:31], s11 offen lds
buffer_load_dwordx4 v7, s[28:31], s11 offen offset:1024 lds
v_mul_f32 v158, v158, v246
v_mul_f32 v159, v159, v247
v_cvt_pk_bf16_f32 v254, v156, v157
v_cvt_pk_bf16_f32 v255, v158, v159
s_mov_b32 s32, s8
s_and_b32 s33, s9, 0xffff
s_mul_i32 s34, s77, 401408
v_mfma_f32_32x32x16_bf16 v[176:191], a[28:31], v[124:127], v[176:191]
ds_read_b64_tr_b16 a[20:21], v235 offset:2048
ds_read_b64_tr_b16 a[22:23], v235 offset:2560
buffer_store_dwordx4 v[252:255], v1, s[40:43], s74 offen offset:3072 sc1
s_mov_b32 s36, s18
s_and_b32 s37, s19, 0xffff
s_mov_b32 s38, 1835008
s_waitcnt lgkmcnt(4)
v_mfma_f32_32x32x16_bf16 v[128:143], a[0:3], v[16:19], 0
ds_read_b64_tr_b16 a[24:25], v234 offset:3072
ds_read_b64_tr_b16 a[26:27], v234 offset:3584
v_mfma_f32_32x32x16_bf16 v[144:159], a[4:7], v[16:19], 0
ds_read_b64_tr_b16 a[28:29], v235 offset:3072
ds_read_b64_tr_b16 a[30:31], v235 offset:3584
s_add_u32 m0, s73, 40960
s_add_u32 s11, s13, 57344
v_mfma_f32_32x32x16_bf16 v[128:143], a[8:11], v[20:23], v[128:143]
ds_read_b64_tr_b16 a[0:1], v234 offset:4096
ds_read_b64_tr_b16 a[2:3], v234 offset:4608
buffer_load_dwordx4 v6, s[28:31], s11 offen lds
buffer_load_dwordx4 v7, s[28:31], s11 offen offset:1024 lds
v_mfma_f32_32x32x16_bf16 v[144:159], a[12:15], v[20:23], v[144:159]
ds_read_b64_tr_b16 a[4:5], v235 offset:4096
ds_read_b64_tr_b16 a[6:7], v235 offset:4608
s_waitcnt lgkmcnt(4)
v_mfma_f32_32x32x16_bf16 v[128:143], a[16:19], v[24:27], v[128:143]
ds_read_b64_tr_b16 a[8:9], v234 offset:5120
ds_read_b64_tr_b16 a[10:11], v234 offset:5632
v_mul_f32 v244, v160, v160
v_mul_f32 v245, v161, v161
v_mul_f32 v246, v162, v162
v_mul_f32 v247, v163, v163
v_mfma_f32_32x32x16_bf16 v[144:159], a[20:23], v[24:27], v[144:159]
ds_read_b64_tr_b16 a[12:13], v235 offset:5120
ds_read_b64_tr_b16 a[14:15], v235 offset:5632
v_fma_f32 v244, v244, v12, v11
v_fma_f32 v245, v245, v12, v11
v_fma_f32 v246, v246, v12, v11
v_fma_f32 v247, v247, v12, v11
s_add_u32 m0, s73, 49152
s_add_u32 s11, s13, 71680
v_mfma_f32_32x32x16_bf16 v[128:143], a[24:27], v[28:31], v[128:143]
ds_read_b64_tr_b16 a[16:17], v234 offset:6144
ds_read_b64_tr_b16 a[18:19], v234 offset:6656
buffer_load_dwordx4 v6, s[28:31], s11 offen lds
buffer_load_dwordx4 v7, s[28:31], s11 offen offset:1024 lds
v_mul_f32 v244, v244, v160
v_mul_f32 v245, v245, v161
v_mul_f32 v246, v246, v162
v_mul_f32 v247, v247, v163
v_mfma_f32_32x32x16_bf16 v[144:159], a[28:31], v[28:31], v[144:159]
ds_read_b64_tr_b16 a[20:21], v235 offset:6144
ds_read_b64_tr_b16 a[22:23], v235 offset:6656
v_exp_f32 v244, v244
v_exp_f32 v245, v245
s_waitcnt lgkmcnt(4)
v_mfma_f32_32x32x16_bf16 v[128:143], a[0:3], v[32:35], v[128:143]
ds_read_b64_tr_b16 a[24:25], v234 offset:14336
ds_read_b64_tr_b16 a[26:27], v234 offset:14848
v_exp_f32 v246, v246
v_exp_f32 v247, v247
v_mfma_f32_32x32x16_bf16 v[144:159], a[4:7], v[32:35], v[144:159]
ds_read_b64_tr_b16 a[28:29], v235 offset:14336
ds_read_b64_tr_b16 a[30:31], v235 offset:14848
v_mul_f32 v160, v160, v176
v_mul_f32 v161, v161, v177
v_mul_f32 v162, v162, v178
s_add_u32 m0, s73, 114688
s_add_u32 s11, s22, 0
v_mfma_f32_32x32x16_bf16 v[128:143], a[8:11], v[36:39], v[128:143]
ds_read_b64_tr_b16 a[0:1], v234 offset:15360
ds_read_b64_tr_b16 a[2:3], v234 offset:15872
buffer_load_dwordx4 v6, s[32:35], s11 offen lds
buffer_load_dwordx4 v7, s[32:35], s11 offen offset:1024 lds
v_mul_f32 v163, v163, v179
v_fma_f32 v244, v244, v13, v13
v_fma_f32 v245, v245, v13, v13
v_mfma_f32_32x32x16_bf16 v[144:159], a[12:15], v[36:39], v[144:159]
ds_read_b64_tr_b16 a[4:5], v235 offset:15360
ds_read_b64_tr_b16 a[6:7], v235 offset:15872
v_fma_f32 v246, v246, v13, v13
v_fma_f32 v247, v247, v13, v13
v_rcp_f32 v244, v244
s_waitcnt vmcnt(17) lgkmcnt(4)
v_mfma_f32_32x32x16_bf16 v[128:143], a[16:19], v[40:43], v[128:143]
ds_read_b64_tr_b16 a[8:9], v234 offset:16384
ds_read_b64_tr_b16 a[10:11], v234 offset:16896
ds_read_b64_tr_b16 a[232:233], v236 offset:8192
ds_read_b64_tr_b16 a[234:235], v236 offset:9216
ds_read_b64_tr_b16 a[236:237], v237 offset:8192
ds_read_b64_tr_b16 a[238:239], v237 offset:9216
v_rcp_f32 v245, v245
v_rcp_f32 v246, v246
v_mfma_f32_32x32x16_bf16 v[144:159], a[20:23], v[40:43], v[144:159]
ds_read_b64_tr_b16 a[12:13], v235 offset:16384
ds_read_b64_tr_b16 a[14:15], v235 offset:16896
v_rcp_f32 v247, v247
v_mul_f32 v160, v160, v244
s_add_u32 m0, s73, 122880
s_add_u32 s11, s22, 14336
v_mfma_f32_32x32x16_bf16 v[128:143], a[24:27], v[44:47], v[128:143]
ds_read_b64_tr_b16 a[16:17], v234 offset:17408
ds_read_b64_tr_b16 a[18:19], v234 offset:17920
buffer_load_dwordx4 v6, s[32:35], s11 offen lds
buffer_load_dwordx4 v7, s[32:35], s11 offen offset:1024 lds
v_mul_f32 v161, v161, v245
v_mul_f32 v162, v162, v246
v_mul_f32 v163, v163, v247
v_cvt_pk_bf16_f32 v248, v160, v161
v_mfma_f32_32x32x16_bf16 v[144:159], a[28:31], v[44:47], v[144:159]
ds_read_b64_tr_b16 a[20:21], v235 offset:17408
ds_read_b64_tr_b16 a[22:23], v235 offset:17920
v_cvt_pk_bf16_f32 v249, v162, v163
v_mul_f32 v244, v164, v164
v_mul_f32 v245, v165, v165
v_mul_f32 v246, v166, v166
s_waitcnt vmcnt(17) lgkmcnt(4)
v_mfma_f32_32x32x16_bf16 v[128:143], a[0:3], v[48:51], v[128:143]
ds_read_b64_tr_b16 a[24:25], v234 offset:18432
ds_read_b64_tr_b16 a[26:27], v234 offset:18944
ds_read_b64_tr_b16 a[240:241], v236 offset:16384
ds_read_b64_tr_b16 a[242:243], v236 offset:17408
ds_read_b64_tr_b16 a[244:245], v237 offset:16384
ds_read_b64_tr_b16 a[246:247], v237 offset:17408
v_mul_f32 v247, v167, v167
v_fma_f32 v244, v244, v12, v11
v_fma_f32 v245, v245, v12, v11
v_fma_f32 v246, v246, v12, v11
v_mfma_f32_32x32x16_bf16 v[144:159], a[4:7], v[48:51], v[144:159]
ds_read_b64_tr_b16 a[28:29], v235 offset:18432
ds_read_b64_tr_b16 a[30:31], v235 offset:18944
v_fma_f32 v247, v247, v12, v11
v_mul_f32 v244, v244, v164
v_mul_f32 v245, v245, v165
s_add_u32 m0, s73, 8192
s_add_u32 s11, s23, 0
v_mfma_f32_32x32x16_bf16 v[128:143], a[8:11], v[52:55], v[128:143]
ds_read_b64_tr_b16 a[0:1], v234 offset:19456
ds_read_b64_tr_b16 a[2:3], v234 offset:19968
buffer_load_dwordx4 v6, s[32:35], s11 offen lds
buffer_load_dwordx4 v7, s[32:35], s11 offen offset:1024 lds
v_mul_f32 v246, v246, v166
v_mul_f32 v247, v247, v167
v_exp_f32 v244, v244
v_mfma_f32_32x32x16_bf16 v[144:159], a[12:15], v[52:55], v[144:159]
ds_read_b64_tr_b16 a[4:5], v235 offset:19456
ds_read_b64_tr_b16 a[6:7], v235 offset:19968
v_exp_f32 v245, v245
v_exp_f32 v246, v246
s_waitcnt lgkmcnt(4)
v_mfma_f32_32x32x16_bf16 v[128:143], a[16:19], v[56:59], v[128:143]
ds_read_b64_tr_b16 a[8:9], v234 offset:20480
ds_read_b64_tr_b16 a[10:11], v234 offset:20992
v_exp_f32 v247, v247
v_mul_f32 v164, v164, v180
s_waitcnt vmcnt(16)
v_cmp_eq_u32 vcc, 0, v227
s_cbranch_vccnz L_spin3_B
L_ok3_B:
v_mfma_f32_32x32x16_bf16 v[144:159], a[20:23], v[56:59], v[144:159]
ds_read_b64_tr_b16 a[12:13], v235 offset:20480
ds_read_b64_tr_b16 a[14:15], v235 offset:20992
v_mul_f32 v165, v165, v181
v_mul_f32 v166, v166, v182
v_mul_f32 v167, v167, v183
v_fma_f32 v244, v244, v13, v13
s_add_u32 m0, s73, 16384
s_add_u32 s11, s23, 14336
v_mfma_f32_32x32x16_bf16 v[128:143], a[24:27], v[60:63], v[128:143]
s_waitcnt lgkmcnt(0)
s_barrier
ds_read_b64_tr_b16 a[16:17], v234 offset:28672
ds_read_b64_tr_b16 a[18:19], v234 offset:29184
buffer_load_dwordx4 v6, s[32:35], s11 offen lds
buffer_load_dwordx4 v7, s[32:35], s11 offen offset:1024 lds
v_fma_f32 v245, v245, v13, v13
v_fma_f32 v246, v246, v13, v13
v_fma_f32 v247, v247, v13, v13
v_rcp_f32 v244, v244
v_mfma_f32_32x32x16_bf16 v[144:159], a[28:31], v[60:63], v[144:159]
ds_read_b64_tr_b16 a[20:21], v235 offset:28672
ds_read_b64_tr_b16 a[22:23], v235 offset:29184
v_rcp_f32 v245, v245
v_mfma_f32_32x32x16_bf16 v[128:143], a[0:3], v[64:67], v[128:143]
ds_read_b64_tr_b16 a[24:25], v234 offset:29696
ds_read_b64_tr_b16 a[26:27], v234 offset:30208
v_rcp_f32 v246, v246
v_rcp_f32 v247, v247
v_mfma_f32_32x32x16_bf16 v[144:159], a[4:7], v[64:67], v[144:159]
ds_read_b64_tr_b16 a[28:29], v235 offset:29696
ds_read_b64_tr_b16 a[30:31], v235 offset:30208
v_mul_f32 v164, v164, v244
v_mul_f32 v165, v165, v245
v_mul_f32 v166, v166, v246
v_mul_f32 v167, v167, v247
s_add_u32 m0, s73, 57344
s_add_u32 s11, s12, 86016
v_mfma_f32_32x32x16_bf16 v[128:143], a[8:11], v[68:71], v[128:143]
ds_read_b64_tr_b16 a[0:1], v234 offset:30720
ds_read_b64_tr_b16 a[2:3], v234 offset:31232
buffer_load_dwordx4 v6, s[28:31], s11 offen lds
buffer_load_dwordx4 v7, s[28:31], s11 offen offset:1024 lds
v_cvt_pk_bf16_f32 v250, v164, v165
v_cvt_pk_bf16_f32 v251, v166, v167
v_mfma_f32_32x32x16_bf16 v[144:159], a[12:15], v[68:71], v[144:159]
ds_read_b64_tr_b16 a[4:5], v235 offset:30720
ds_read_b64_tr_b16 a[6:7], v235 offset:31232
buffer_store_dwordx4 v[248:251], v1, s[40:43], s75 offen offset:0 sc1
v_mul_f32 v244, v168, v168
v_mul_f32 v245, v169, v169
v_mul_f32 v246, v170, v170
v_mul_f32 v247, v171, v171
s_waitcnt lgkmcnt(4)
v_mfma_f32_32x32x16_bf16 v[128:143], a[16:19], v[72:75], v[128:143]
ds_read_b64_tr_b16 a[8:9], v234 offset:31744
ds_read_b64_tr_b16 a[10:11], v234 offset:32256
v_fma_f32 v244, v244, v12, v11
v_fma_f32 v245, v245, v12, v11
v_fma_f32 v246, v246, v12, v11
v_fma_f32 v247, v247, v12, v11
v_mfma_f32_32x32x16_bf16 v[144:159], a[20:23], v[72:75], v[144:159]
ds_read_b64_tr_b16 a[12:13], v235 offset:31744
ds_read_b64_tr_b16 a[14:15], v235 offset:32256
v_mul_f32 v244, v244, v168
v_mul_f32 v245, v245, v169
v_mul_f32 v246, v246, v170
v_mul_f32 v247, v247, v171
s_add_u32 m0, s73, 65536
s_add_u32 s11, s12, 100352
v_mfma_f32_32x32x16_bf16 v[128:143], a[24:27], v[76:79], v[128:143]
ds_read_b64_tr_b16 a[16:17], v234 offset:32768
ds_read_b64_tr_b16 a[18:19], v234 offset:33280
buffer_load_dwordx4 v6, s[28:31], s11 offen lds
buffer_load_dwordx4 v7, s[28:31], s11 offen offset:1024 lds
v_exp_f32 v244, v244
v_exp_f32 v245, v245
v_mfma_f32_32x32x16_bf16 v[144:159], a[28:31], v[76:79], v[144:159]
ds_read_b64_tr_b16 a[20:21], v235 offset:32768
ds_read_b64_tr_b16 a[22:23], v235 offset:33280
v_exp_f32 v246, v246
v_exp_f32 v247, v247
s_waitcnt lgkmcnt(4)
v_mfma_f32_32x32x16_bf16 v[128:143], a[0:3], v[80:83], v[128:143]
ds_read_b64_tr_b16 a[24:25], v234 offset:33792
ds_read_b64_tr_b16 a[26:27], v234 offset:34304
v_mul_f32 v168, v168, v184
v_mul_f32 v169, v169, v185
v_mul_f32 v170, v170, v186
v_mfma_f32_32x32x16_bf16 v[144:159], a[4:7], v[80:83], v[144:159]
ds_read_b64_tr_b16 a[28:29], v235 offset:33792
ds_read_b64_tr_b16 a[30:31], v235 offset:34304
v_mul_f32 v171, v171, v187
v_fma_f32 v244, v244, v13, v13
v_fma_f32 v245, v245, v13, v13
s_add_u32 m0, s73, 73728
s_add_u32 s11, s13, 86016
v_mfma_f32_32x32x16_bf16 v[128:143], a[8:11], v[84:87], v[128:143]
ds_read_b64_tr_b16 a[0:1], v234 offset:34816
ds_read_b64_tr_b16 a[2:3], v234 offset:35328
buffer_load_dwordx4 v6, s[28:31], s11 offen lds
buffer_load_dwordx4 v7, s[28:31], s11 offen offset:1024 lds
v_fma_f32 v246, v246, v13, v13
v_fma_f32 v247, v247, v13, v13
v_rcp_f32 v244, v244
v_mfma_f32_32x32x16_bf16 v[144:159], a[12:15], v[84:87], v[144:159]
ds_read_b64_tr_b16 a[4:5], v235 offset:34816
ds_read_b64_tr_b16 a[6:7], v235 offset:35328
v_rcp_f32 v245, v245
v_rcp_f32 v246, v246
s_waitcnt lgkmcnt(4)
v_mfma_f32_32x32x16_bf16 v[128:143], a[16:19], v[88:91], v[128:143]
ds_read_b64_tr_b16 a[8:9], v234 offset:43008
ds_read_b64_tr_b16 a[10:11], v234 offset:43520
v_rcp_f32 v247, v247
v_mul_f32 v168, v168, v244
v_mfma_f32_32x32x16_bf16 v[144:159], a[20:23], v[88:91], v[144:159]
ds_read_b64_tr_b16 a[12:13], v235 offset:43008
ds_read_b64_tr_b16 a[14:15], v235 offset:43520
v_mul_f32 v169, v169, v245
v_mul_f32 v170, v170, v246
v_mul_f32 v171, v171, v247
v_cvt_pk_bf16_f32 v252, v168, v169
s_add_u32 m0, s73, 131072
s_add_u32 s11, s13, 100352
v_mfma_f32_32x32x16_bf16 v[128:143], a[24:27], v[92:95], v[128:143]
ds_read_b64_tr_b16 a[16:17], v234 offset:44032
ds_read_b64_tr_b16 a[18:19], v234 offset:44544
buffer_load_dwordx4 v[200:203], v1, s[40:43], s1 offen offset:0 sc1
buffer_load_dwordx4 v6, s[28:31], s11 offen lds
buffer_load_dwordx4 v7, s[28:31], s11 offen offset:1024 lds
v_cvt_pk_bf16_f32 v253, v170, v171
v_mul_f32 v244, v172, v172
v_mul_f32 v245, v173, v173
v_mul_f32 v246, v174, v174
v_mfma_f32_32x32x16_bf16 v[144:159], a[28:31], v[92:95], v[144:159]
ds_read_b64_tr_b16 a[20:21], v235 offset:44032
ds_read_b64_tr_b16 a[22:23], v235 offset:44544
buffer_load_dwordx4 v[204:207], v1, s[40:43], s1 offen offset:1024 sc1
v_mul_f32 v247, v175, v175
v_fma_f32 v244, v244, v12, v11
v_fma_f32 v245, v245, v12, v11
v_fma_f32 v246, v246, v12, v11
s_waitcnt lgkmcnt(4)
v_mfma_f32_32x32x16_bf16 v[128:143], a[0:3], v[96:99], v[128:143]
ds_read_b64_tr_b16 a[24:25], v234 offset:45056
ds_read_b64_tr_b16 a[26:27], v234 offset:45568
buffer_load_dwordx4 v[208:211], v1, s[40:43], s1 offen offset:2048 sc1
v_fma_f32 v247, v247, v12, v11
v_mul_f32 v244, v244, v172
v_mul_f32 v245, v245, v173
v_mfma_f32_32x32x16_bf16 v[144:159], a[4:7], v[96:99], v[144:159]
ds_read_b64_tr_b16 a[28:29], v235 offset:45056
ds_read_b64_tr_b16 a[30:31], v235 offset:45568
buffer_load_dwordx4 v[212:215], v1, s[40:43], s1 offen offset:3072 sc1
v_mul_f32 v246, v246, v174
v_mul_f32 v247, v247, v175
v_exp_f32 v244, v244
s_add_u32 m0, s73, 143360
s_add_u32 s11, s22, 25088
v_mfma_f32_32x32x16_bf16 v[128:143], a[8:11], v[100:103], v[128:143]
ds_read_b64_tr_b16 a[0:1], v234 offset:46080
ds_read_b64_tr_b16 a[2:3], v234 offset:46592
buffer_load_dwordx4 v6, s[32:35], s11 offen lds
buffer_load_dwordx4 v7, s[32:35], s11 offen offset:1024 lds
v_exp_f32 v245, v245
v_exp_f32 v246, v246
v_mfma_f32_32x32x16_bf16 v[144:159], a[12:15], v[100:103], v[144:159]
ds_read_b64_tr_b16 a[4:5], v235 offset:46080
ds_read_b64_tr_b16 a[6:7], v235 offset:46592
v_exp_f32 v247, v247
v_mul_f32 v172, v172, v188
s_waitcnt lgkmcnt(4)
v_mfma_f32_32x32x16_bf16 v[128:143], a[16:19], v[104:107], v[128:143]
ds_read_b64_tr_b16 a[8:9], v234 offset:47104
ds_read_b64_tr_b16 a[10:11], v234 offset:47616
v_mul_f32 v173, v173, v189
v_mul_f32 v174, v174, v190
v_mul_f32 v175, v175, v191
v_fma_f32 v244, v244, v13, v13
v_mfma_f32_32x32x16_bf16 v[144:159], a[20:23], v[104:107], v[144:159]
ds_read_b64_tr_b16 a[12:13], v235 offset:47104
ds_read_b64_tr_b16 a[14:15], v235 offset:47616
v_fma_f32 v245, v245, v13, v13
v_fma_f32 v246, v246, v13, v13
v_fma_f32 v247, v247, v13, v13
v_rcp_f32 v244, v244
s_add_u32 m0, s73, 151552
s_add_u32 s11, s22, 39424
v_mfma_f32_32x32x16_bf16 v[128:143], a[24:27], v[108:111], v[128:143]
ds_read_b64_tr_b16 a[16:17], v234 offset:48128
ds_read_b64_tr_b16 a[18:19], v234 offset:48640
buffer_load_dwordx4 v6, s[32:35], s11 offen lds
buffer_load_dwordx4 v7, s[32:35], s11 offen offset:1024 lds
v_rcp_f32 v245, v245
v_mfma_f32_32x32x16_bf16 v[144:159], a[28:31], v[108:111], v[144:159]
ds_read_b64_tr_b16 a[20:21], v235 offset:48128
ds_read_b64_tr_b16 a[22:23], v235 offset:48640
v_rcp_f32 v246, v246
v_rcp_f32 v247, v247
s_waitcnt lgkmcnt(4)
v_mfma_f32_32x32x16_bf16 v[128:143], a[0:3], v[112:115], v[128:143]
ds_read_b64_tr_b16 a[24:25], v234 offset:49152
ds_read_b64_tr_b16 a[26:27], v234 offset:49664
v_mul_f32 v172, v172, v244
v_mul_f32 v173, v173, v245
v_mul_f32 v174, v174, v246
v_mul_f32 v175, v175, v247
v_mfma_f32_32x32x16_bf16 v[144:159], a[4:7], v[112:115], v[144:159]
ds_read_b64_tr_b16 a[28:29], v235 offset:49152
ds_read_b64_tr_b16 a[30:31], v235 offset:49664
v_cvt_pk_bf16_f32 v254, v172, v173
v_cvt_pk_bf16_f32 v255, v174, v175
v_mfma_f32_32x32x16_bf16 v[128:143], a[8:11], v[116:119], v[128:143]
s_waitcnt lgkmcnt(0)
s_barrier
buffer_store_dwordx4 v[252:255], v1, s[40:43], s75 offen offset:1024 sc1
v_and_b32 v4, 28, v229
v_mfma_f32_32x32x16_bf16 v[144:159], a[12:15], v[116:119], v[144:159]
buffer_load_dword v227, v4, s[40:43], s85 offen sc1
s_add_u32 m0, s73, 81920
s_add_u32 s11, s23, 25088
v_mfma_f32_32x32x16_bf16 v[128:143], a[16:19], v[120:123], v[128:143]
buffer_load_dwordx4 v6, s[32:35], s11 offen lds
buffer_load_dwordx4 v7, s[32:35], s11 offen offset:1024 lds
v_mfma_f32_32x32x16_bf16 v[144:159], a[20:23], v[120:123], v[144:159]
v_mfma_f32_32x32x16_bf16 v[128:143], a[24:27], v[124:127], v[128:143]
v_mfma_f32_32x32x16_bf16 v[144:159], a[28:31], v[124:127], v[144:159]
v_add_u32 v198, 147456, v1
s_cmp_eq_u32 s77, 0
s_cselect_b32 s92, 0x40000000, 0
s_add_u32 s4, s4, s92
s_add_u32 s5, s5, s92
s_mov_b32 s88, 0x358637bd
s_mov_b32 s89, 0x358637bd
s_nop 3
v_pk_mul_f32 v[244:245], v[128:129], v[14:15] op_sel:[0,1] op_sel_hi:[1,1]
v_pk_mul_f32 v[246:247], v[130:131], v[14:15] op_sel:[0,1] op_sel_hi:[1,1]
v_exp_f32_e64 v244, v244 clamp
v_exp_f32_e64 v245, v245 clamp
v_exp_f32_e64 v246, v246 clamp
v_exp_f32_e64 v247, v247 clamp
v_max_f32 v128, 0, v128
v_max_f32 v129, 0, v129
v_max_f32 v130, 0, v130
v_max_f32 v131, 0, v131
v_pk_fma_f32 v[128:129], v[128:129], v[14:15], v[244:245] op_sel_hi:[1,0,1]
v_pk_fma_f32 v[130:131], v[130:131], v[14:15], v[246:247] op_sel_hi:[1,0,1]
v_pk_add_f32 v[128:129], v[128:129], s[88:89]
v_pk_add_f32 v[130:131], v[130:131], s[88:89]
v_cvt_pk_bf16_f32 v216, v128, v129
v_cvt_pk_bf16_f32 v217, v130, v131
v_pk_mul_f32 v[244:245], v[132:133], v[14:15] op_sel:[0,1] op_sel_hi:[1,1]
v_pk_mul_f32 v[246:247], v[134:135], v[14:15] op_sel:[0,1] op_sel_hi:[1,1]
v_exp_f32_e64 v244, v244 clamp
v_exp_f32_e64 v245, v245 clamp
v_exp_f32_e64 v246, v246 clamp
v_exp_f32_e64 v247, v247 clamp
s_waitcnt vmcnt(2)
v_cmp_gt_u32 vcc, 1, v227
s_cbranch_vccnz L_spin4_B
L_ok4_B:
v_max_f32 v132, 0, v132
v_max_f32 v133, 0, v133
v_max_f32 v134, 0, v134
v_max_f32 v135, 0, v135
v_pk_fma_f32 v[132:133], v[132:133], v[14:15], v[244:245] op_sel_hi:[1,0,1]
v_pk_fma_f32 v[134:135], v[134:135], v[14:15], v[246:247] op_sel_hi:[1,0,1]
v_pk_add_f32 v[132:133], v[132:133], s[88:89]
v_pk_add_f32 v[134:135], v[134:135], s[88:89]
v_cvt_pk_bf16_f32 v218, v132, v133
v_cvt_pk_bf16_f32 v219, v134, v135
v_pk_mul_f32 v[244:245], v[136:137], v[14:15] op_sel:[0,1] op_sel_hi:[1,1]
v_pk_mul_f32 v[246:247], v[138:139], v[14:15] op_sel:[0,1] op_sel_hi:[1,1]
v_exp_f32_e64 v244, v244 clamp
v_exp_f32_e64 v245, v245 clamp
v_exp_f32_e64 v246, v246 clamp
v_exp_f32_e64 v247, v247 clamp
v_max_f32 v136, 0, v136
v_max_f32 v137, 0, v137
buffer_load_dwordx4 v[16:19], v1, s[40:43], s4 offen offset:0 sc1
buffer_load_dwordx4 v[20:23], v198, s[40:43], s4 offen offset:0 sc1
v_max_f32 v138, 0, v138
v_max_f32 v139, 0, v139
v_pk_fma_f32 v[136:137], v[136:137], v[14:15], v[244:245] op_sel_hi:[1,0,1]
v_pk_fma_f32 v[138:139], v[138:139], v[14:15], v[246:247] op_sel_hi:[1,0,1]
v_pk_add_f32 v[136:137], v[136:137], s[88:89]
v_pk_add_f32 v[138:139], v[138:139], s[88:89]
v_cvt_pk_bf16_f32 v220, v136, v137
v_cvt_pk_bf16_f32 v221, v138, v139
v_pk_mul_f32 v[244:245], v[140:141], v[14:15] op_sel:[0,1] op_sel_hi:[1,1]
v_pk_mul_f32 v[246:247], v[142:143], v[14:15] op_sel:[0,1] op_sel_hi:[1,1]
v_exp_f32_e64 v244, v244 clamp
v_exp_f32_e64 v245, v245 clamp
v_exp_f32_e64 v246, v246 clamp
v_exp_f32_e64 v247, v247 clamp
v_max_f32 v140, 0, v140
v_max_f32 v141, 0, v141
v_max_f32 v142, 0, v142
v_max_f32 v143, 0, v143
buffer_load_dwordx4 v[24:27], v1, s[40:43], s4 offen offset:1024 sc1
buffer_load_dwordx4 v[28:31], v198, s[40:43], s4 offen offset:1024 sc1
v_pk_fma_f32 v[140:141], v[140:141], v[14:15], v[244:245] op_sel_hi:[1,0,1]
v_pk_fma_f32 v[142:143], v[142:143], v[14:15], v[246:247] op_sel_hi:[1,0,1]
v_pk_add_f32 v[140:141], v[140:141], s[88:89]
v_pk_add_f32 v[142:143], v[142:143], s[88:89]
v_cvt_pk_bf16_f32 v222, v140, v141
v_cvt_pk_bf16_f32 v223, v142, v143
v_cndmask_b32 v222, v222, 0, s[90:91]
v_cndmask_b32 v223, v223, 0, s[90:91]
v_pk_mul_f32 v[244:245], v[144:145], v[14:15] op_sel:[0,1] op_sel_hi:[1,1]
v_pk_mul_f32 v[246:247], v[146:147], v[14:15] op_sel:[0,1] op_sel_hi:[1,1]
v_exp_f32_e64 v244, v244 clamp
v_exp_f32_e64 v245, v245 clamp
v_exp_f32_e64 v246, v246 clamp
v_exp_f32_e64 v247, v247 clamp
v_max_f32 v144, 0, v144
v_max_f32 v145, 0, v145
v_max_f32 v146, 0, v146
v_max_f32 v147, 0, v147
s_add_u32 s92, s4, 8192
buffer_load_dwordx4 v[32:35], v1, s[40:43], s92 offen offset:0 sc1
buffer_load_dwordx4 v[36:39], v198, s[40:43], s92 offen offset:0 sc1
v_pk_fma_f32 v[144:145], v[144:145], v[14:15], v[244:245] op_sel_hi:[1,0,1]
v_pk_fma_f32 v[146:147], v[146:147], v[14:15], v[246:247] op_sel_hi:[1,0,1]
v_pk_add_f32 v[144:145], v[144:145], s[88:89]
v_pk_add_f32 v[146:147], v[146:147], s[88:89]
v_cvt_pk_bf16_f32 v248, v144, v145
v_cvt_pk_bf16_f32 v249, v146, v147
v_pk_mul_f32 v[244:245], v[148:149], v[14:15] op_sel:[0,1] op_sel_hi:[1,1]
v_pk_mul_f32 v[246:247], v[150:151], v[14:15] op_sel:[0,1] op_sel_hi:[1,1]
v_exp_f32_e64 v244, v244 clamp
v_exp_f32_e64 v245, v245 clamp
v_exp_f32_e64 v246, v246 clamp
v_exp_f32_e64 v247, v247 clamp
v_max_f32 v148, 0, v148
v_max_f32 v149, 0, v149
v_max_f32 v150, 0, v150
v_max_f32 v151, 0, v151
v_pk_fma_f32 v[148:149], v[148:149], v[14:15], v[244:245] op_sel_hi:[1,0,1]
v_pk_fma_f32 v[150:151], v[150:151], v[14:15], v[246:247] op_sel_hi:[1,0,1]
s_add_u32 s92, s4, 8192
buffer_load_dwordx4 v[40:43], v1, s[40:43], s92 offen offset:1024 sc1
buffer_load_dwordx4 v[44:47], v198, s[40:43], s92 offen offset:1024 sc1
v_pk_add_f32 v[148:149], v[148:149], s[88:89]
v_pk_add_f32 v[150:151], v[150:151], s[88:89]
v_cvt_pk_bf16_f32 v250, v148, v149
v_cvt_pk_bf16_f32 v251, v150, v151
v_pk_mul_f32 v[244:245], v[152:153], v[14:15] op_sel:[0,1] op_sel_hi:[1,1]
v_pk_mul_f32 v[246:247], v[154:155], v[14:15] op_sel:[0,1] op_sel_hi:[1,1]
v_exp_f32_e64 v244, v244 clamp
v_exp_f32_e64 v245, v245 clamp
v_exp_f32_e64 v246, v246 clamp
v_exp_f32_e64 v247, v247 clamp
v_max_f32 v152, 0, v152
v_max_f32 v153, 0, v153
v_max_f32 v154, 0, v154
v_max_f32 v155, 0, v155
v_pk_fma_f32 v[152:153], v[152:153], v[14:15], v[244:245] op_sel_hi:[1,0,1]
v_pk_fma_f32 v[154:155], v[154:155], v[14:15], v[246:247] op_sel_hi:[1,0,1]
v_pk_add_f32 v[152:153], v[152:153], s[88:89]
v_pk_add_f32 v[154:155], v[154:155], s[88:89]
buffer_load_dwordx4 v[48:51], v1, s[40:43], s5 offen offset:0 sc1
buffer_load_dwordx4 v[52:55], v198, s[40:43], s5 offen offset:0 sc1
v_cvt_pk_bf16_f32 v252, v152, v153
v_cvt_pk_bf16_f32 v253, v154, v155
v_pk_mul_f32 v[244:245], v[156:157], v[14:15] op_sel:[0,1] op_sel_hi:[1,1]
v_pk_mul_f32 v[246:247], v[158:159], v[14:15] op_sel:[0,1] op_sel_hi:[1,1]
v_exp_f32_e64 v244, v244 clamp
v_exp_f32_e64 v245, v245 clamp
v_exp_f32_e64 v246, v246 clamp
v_exp_f32_e64 v247, v247 clamp
v_max_f32 v156, 0, v156
v_max_f32 v157, 0, v157
v_max_f32 v158, 0, v158
v_max_f32 v159, 0, v159
v_pk_fma_f32 v[156:157], v[156:157], v[14:15], v[244:245] op_sel_hi:[1,0,1]
v_pk_fma_f32 v[158:159], v[158:159], v[14:15], v[246:247] op_sel_hi:[1,0,1]
v_pk_add_f32 v[156:157], v[156:157], s[88:89]
v_pk_add_f32 v[158:159], v[158:159], s[88:89]
v_cvt_pk_bf16_f32 v254, v156, v157
v_cvt_pk_bf16_f32 v255, v158, v159
buffer_load_dwordx4 v[56:59], v1, s[40:43], s5 offen offset:1024 sc1
buffer_load_dwordx4 v[60:63], v198, s[40:43], s5 offen offset:1024 sc1
v_cndmask_b32 v254, v254, 0, s[90:91]
v_cndmask_b32 v255, v255, 0, s[90:91]
v_max3_u32 v230, v200, v201, v202
v_max3_u32 v231, v203, v204, v205
v_max3_u32 v230, v230, v206, v207
v_max3_u32 v231, v231, v208, v209
v_max3_u32 v230, v230, v210, v211
v_max3_u32 v231, v231, v212, v213
v_max3_u32 v230, v230, v214, v215
v_max_u32 v230, v230, v231
v_cmp_eq_u32 vcc, -1, v230
s_cbranch_vccnz L_spin5_B
L_ok5_B:
v_mfma_f32_32x32x16_bf16 v[160:175], v[200:203], v[216:219], 0
v_mfma_f32_32x32x16_bf16 v[160:175], v[204:207], v[220:223], v[160:175]
v_mfma_f32_32x32x16_bf16 v[176:191], v[208:211], v[248:251], 0
v_mfma_f32_32x32x16_bf16 v[176:191], v[212:215], v[252:255], v[176:191]
s_add_u32 s92, s5, 8192
buffer_load_dwordx4 v[64:67], v1, s[40:43], s92 offen offset:0 sc1
buffer_load_dwordx4 v[68:71], v198, s[40:43], s92 offen offset:0 sc1
s_add_u32 s92, s5, 8192
buffer_load_dwordx4 v[72:75], v1, s[40:43], s92 offen offset:1024 sc1
buffer_load_dwordx4 v[76:79], v198, s[40:43], s92 offen offset:1024 sc1
s_nop 3
v_mov_b32 v230, v172
v_mov_b32 v231, v172
s_nop 1
v_permlane32_swap_b32 v230, v231
v_add_f32 v230, 0x358637bd, v231
v_rcp_f32 v230, v230
s_nop 0
v_mul_f32 v230, 0x3f317218, v230
v_pk_mul_f32 v[160:161], v[160:161], v[230:231] op_sel_hi:[1,0]
v_pk_mul_f32 v[162:163], v[162:163], v[230:231] op_sel_hi:[1,0]
v_pk_mul_f32 v[164:165], v[164:165], v[230:231] op_sel_hi:[1,0]
v_pk_mul_f32 v[166:167], v[166:167], v[230:231] op_sel_hi:[1,0]
v_pk_mul_f32 v[168:169], v[168:169], v[230:231] op_sel_hi:[1,0]
v_pk_mul_f32 v[170:171], v[170:171], v[230:231] op_sel_hi:[1,0]
v_pk_mul_f32 v[172:173], v[172:173], v[230:231] op_sel_hi:[1,0]
v_pk_mul_f32 v[174:175], v[174:175], v[230:231] op_sel_hi:[1,0]
v_cvt_pk_bf16_f32 v128, v160, v161
v_cvt_pk_bf16_f32 v129, v162, v163
v_cvt_pk_bf16_f32 v130, v164, v165
v_cvt_pk_bf16_f32 v131, v166, v167
v_cvt_pk_bf16_f32 v132, v168, v169
v_cvt_pk_bf16_f32 v133, v170, v171
v_cvt_pk_bf16_f32 v134, v172, v173
v_cvt_pk_bf16_f32 v135, v174, v175
v_cndmask_b32 v134, v134, 0, s[90:91]
v_cndmask_b32 v135, v135, 0, s[90:91]
buffer_store_dwordx4 v[128:131], v1, s[40:43], s75 offen offset:2048 sc1
buffer_store_dwordx4 v[132:135], v1, s[40:43], s75 offen offset:3072 sc1
v_mov_b32 v230, v188
v_mov_b32 v231, v188
s_nop 1
v_permlane32_swap_b32 v230, v231
v_add_f32 v230, 0x358637bd, v231
v_rcp_f32 v230, v230
s_nop 0
v_mul_f32 v230, 0x3f317218, v230
v_pk_mul_f32 v[176:177], v[176:177], v[230:231] op_sel_hi:[1,0]
v_pk_mul_f32 v[178:179], v[178:179], v[230:231] op_sel_hi:[1,0]
v_pk_mul_f32 v[180:181], v[180:181], v[230:231] op_sel_hi:[1,0]
v_pk_mul_f32 v[182:183], v[182:183], v[230:231] op_sel_hi:[1,0]
v_pk_mul_f32 v[184:185], v[184:185], v[230:231] op_sel_hi:[1,0]
v_pk_mul_f32 v[186:187], v[186:187], v[230:231] op_sel_hi:[1,0]
v_pk_mul_f32 v[188:189], v[188:189], v[230:231] op_sel_hi:[1,0]
v_pk_mul_f32 v[190:191], v[190:191], v[230:231] op_sel_hi:[1,0]
v_cvt_pk_bf16_f32 v136, v176, v177
s_add_u32 m0, s73, 90112
s_add_u32 s11, s23, 39424
buffer_load_dwordx4 v6, s[32:35], s11 offen lds
buffer_load_dwordx4 v7, s[32:35], s11 offen offset:1024 lds
v_cvt_pk_bf16_f32 v137, v178, v179
v_cvt_pk_bf16_f32 v138, v180, v181
v_cvt_pk_bf16_f32 v139, v182, v183
v_cvt_pk_bf16_f32 v140, v184, v185
v_cvt_pk_bf16_f32 v141, v186, v187
v_cvt_pk_bf16_f32 v142, v188, v189
v_cvt_pk_bf16_f32 v143, v190, v191
v_cndmask_b32 v142, v142, 0, s[90:91]
v_cndmask_b32 v143, v143, 0, s[90:91]
buffer_store_dwordx4 v[136:139], v1, s[40:43], s76 offen offset:0 sc1
buffer_store_dwordx4 v[140:143], v1, s[40:43], s76 offen offset:1024 sc1
s_cmp_eq_u32 s77, 0
s_cbranch_scc1 L_fin_B
s_waitcnt vmcnt(20)
v_mfma_f32_32x32x16_bf16 v[128:143], a[96:99], v[16:19], 0
v_lshrrev_b32 v244, 7, v1
s_lshl_b32 s99, s10, 3
v_add_u32 v245, s99, v244
v_mfma_f32_32x32x16_bf16 v[144:159], a[96:99], v[20:23], 0
v_mul_u32_u24 v245, 896, v245
v_and_b32 v222, 0x70, v1
v_add_u32 v222, v222, v245
v_mfma_f32_32x32x16_bf16 v[176:191], a[100:103], v[20:23], 0
v_add_u32 v223, 28672, v222
v_bfe_u32 v245, v1, 4, 2
v_lshlrev_b32 v245, 1, v245
v_mfma_f32_32x32x16_bf16 v[160:175], a[100:103], v[16:19], 0
buffer_load_dwordx4 v[80:83], v1, s[40:43], s4 offen offset:2048 sc1
buffer_load_dwordx4 v[84:87], v198, s[40:43], s4 offen offset:2048 sc1
v_xor_b32 v245, v245, v244
v_lshlrev_b32 v245, 4, v245
v_lshl_add_u32 v245, v244, 8, v245
s_waitcnt vmcnt(20)
v_mfma_f32_32x32x16_bf16 v[128:143], a[104:107], v[24:27], v[128:143]
v_bfe_u32 v244, v1, 6, 1
v_lshl_add_u32 v245, v244, 7, v245
s_lshl_b32 s99, s10, 13
v_mfma_f32_32x32x16_bf16 v[144:159], a[104:107], v[28:31], v[144:159]
v_add_u32 v220, s99, v245
v_xor_b32 v221, 16, v220
v_bfe_u32 v244, v1, 4, 3
v_mfma_f32_32x32x16_bf16 v[176:191], a[108:111], v[28:31], v[176:191]
v_lshrrev_b32 v245, 9, v1
v_xor_b32 v245, v245, v244
v_lshlrev_b32 v245, 4, v245
v_mfma_f32_32x32x16_bf16 v[160:175], a[108:111], v[24:27], v[160:175]
buffer_load_dwordx4 v[88:91], v1, s[40:43], s4 offen offset:3072 sc1
buffer_load_dwordx4 v[92:95], v198, s[40:43], s4 offen offset:3072 sc1
v_lshl_add_u32 v245, v244, 8, v245
v_bfe_u32 v244, v1, 7, 2
v_lshl_add_u32 v245, v244, 13, v245
s_waitcnt vmcnt(20)
v_mfma_f32_32x32x16_bf16 v[128:143], a[112:115], v[32:35], v[128:143]
v_add_u32 v216, s73, v245
v_xor_b32 v217, 32, v216
v_xor_b32 v218, 64, v216
v_mfma_f32_32x32x16_bf16 v[144:159], a[112:115], v[36:39], v[144:159]
v_xor_b32 v219, 0x60, v216
v_mfma_f32_32x32x16_bf16 v[176:191], a[116:119], v[36:39], v[176:191]
s_add_u32 s92, s4, 8192
v_mfma_f32_32x32x16_bf16 v[160:175], a[116:119], v[32:35], v[160:175]
buffer_load_dwordx4 v[96:99], v1, s[40:43], s92 offen offset:2048 sc1
buffer_load_dwordx4 v[100:103], v198, s[40:43], s92 offen offset:2048 sc1
s_waitcnt vmcnt(20)
v_mfma_f32_32x32x16_bf16 v[128:143], a[120:123], v[40:43], v[128:143]
v_mfma_f32_32x32x16_bf16 v[144:159], a[120:123], v[44:47], v[144:159]
v_mfma_f32_32x32x16_bf16 v[176:191], a[124:127], v[44:47], v[176:191]
s_add_u32 s92, s4, 8192
v_mfma_f32_32x32x16_bf16 v[160:175], a[124:127], v[40:43], v[160:175]
buffer_load_dwordx4 v[104:107], v1, s[40:43], s92 offen offset:3072 sc1
buffer_load_dwordx4 v[108:111], v198, s[40:43], s92 offen offset:3072 sc1
s_waitcnt vmcnt(20)
v_mfma_f32_32x32x16_bf16 v[128:143], a[128:131], v[48:51], v[128:143]
v_mfma_f32_32x32x16_bf16 v[144:159], a[128:131], v[52:55], v[144:159]
v_mfma_f32_32x32x16_bf16 v[176:191], a[132:135], v[52:55], v[176:191]
v_mfma_f32_32x32x16_bf16 v[160:175], a[132:135], v[48:51], v[160:175]
buffer_load_dwordx4 v[112:115], v1, s[40:43], s5 offen offset:2048 sc1
buffer_load_dwordx4 v[116:119], v198, s[40:43], s5 offen offset:2048 sc1
s_waitcnt vmcnt(20)
v_mfma_f32_32x32x16_bf16 v[128:143], a[136:139], v[56:59], v[128:143]
v_mfma_f32_32x32x16_bf16 v[144:159], a[136:139], v[60:63], v[144:159]
v_mfma_f32_32x32x16_bf16 v[176:191], a[140:143], v[60:63], v[176:191]
v_mfma_f32_32x32x16_bf16 v[160:175], a[140:143], v[56:59], v[160:175]
buffer_load_dwordx4 v[120:123], v1, s[40:43], s5 offen offset:3072 sc1
buffer_load_dwordx4 v[124:127], v198, s[40:43], s5 offen offset:3072 sc1
s_waitcnt vmcnt(20)
v_mfma_f32_32x32x16_bf16 v[128:143], a[144:147], v[64:67], v[128:143]
v_mfma_f32_32x32x16_bf16 v[144:159], a[144:147], v[68:71], v[144:159]
v_mfma_f32_32x32x16_bf16 v[176:191], a[148:151], v[68:71], v[176:191]
s_add_u32 s92, s5, 8192
v_mfma_f32_32x32x16_bf16 v[160:175], a[148:151], v[64:67], v[160:175]
buffer_load_dwordx4 v[16:19], v1, s[40:43], s92 offen offset:2048 sc1
buffer_load_dwordx4 v[20:23], v198, s[40:43], s92 offen offset:2048 sc1
s_waitcnt vmcnt(20)
v_mfma_f32_32x32x16_bf16 v[128:143], a[152:155], v[72:75], v[128:143]
s_waitcnt vmcnt(10)
v_max3_u32 v230, v80, v81, v82
v_max3_u32 v231, v83, v84, v85
v_max3_u32 v230, v230, v86, v87
v_mfma_f32_32x32x16_bf16 v[144:159], a[152:155], v[76:79], v[144:159]
v_max3_u32 v231, v231, v88, v89
v_max3_u32 v230, v230, v90, v91
v_max3_u32 v231, v231, v92, v93
v_mfma_f32_32x32x16_bf16 v[176:191], a[156:159], v[76:79], v[176:191]
v_max3_u32 v230, v230, v94, v95
v_max_u32 v230, v230, v231
v_cmp_eq_u32 vcc, -1, v230
s_add_u32 s92, s5, 8192
v_mfma_f32_32x32x16_bf16 v[160:175], a[156:159], v[72:75], v[160:175]
s_cbranch_vccnz L_spin6_B
L_ok6_B:
buffer_load_dwordx4 v[24:27], v1, s[40:43], s92 offen offset:3072 sc1
buffer_load_dwordx4 v[28:31], v198, s[40:43], s92 offen offset:3072 sc1
v_mfma_f32_32x32x16_bf16 v[128:143], a[160:163], v[80:83], v[128:143]
v_mfma_f32_32x32x16_bf16 v[144:159], a[160:163], v[84:87], v[144:159]
v_mfma_f32_32x32x16_bf16 v[176:191], a[164:167], v[84:87], v[176:191]
s_add_u32 s92, s4, 12288
v_mfma_f32_32x32x16_bf16 v[160:175], a[164:167], v[80:83], v[160:175]
buffer_load_dwordx4 v[32:35], v1, s[40:43], s92 offen offset:0 sc1
buffer_load_dwordx4 v[36:39], v198, s[40:43], s92 offen offset:0 sc1
v_mfma_f32_32x32x16_bf16 v[128:143], a[168:171], v[88:91], v[128:143]
s_waitcnt vmcnt(10)
v_max3_u32 v230, v96, v97, v98
v_max3_u32 v231, v99, v100, v101
v_max3_u32 v230, v230, v102, v103
v_mfma_f32_32x32x16_bf16 v[144:159], a[168:171], v[92:95], v[144:159]
v_max3_u32 v231, v231, v104, v105
v_max3_u32 v230, v230, v106, v107
v_max3_u32 v231, v231, v108, v109
v_mfma_f32_32x32x16_bf16 v[176:191], a[172:175], v[92:95], v[176:191]
v_max3_u32 v230, v230, v110, v111
v_max_u32 v230, v230, v231
v_cmp_eq_u32 vcc, -1, v230
s_add_u32 s92, s4, 12288
v_mfma_f32_32x32x16_bf16 v[160:175], a[172:175], v[88:91], v[160:175]
s_cbranch_vccnz L_spin7_B
L_ok7_B:
buffer_load_dwordx4 v[40:43], v1, s[40:43], s92 offen offset:1024 sc1
buffer_load_dwordx4 v[44:47], v198, s[40:43], s92 offen offset:1024 sc1
v_mfma_f32_32x32x16_bf16 v[128:143], a[176:179], v[96:99], v[128:143]
v_mfma_f32_32x32x16_bf16 v[144:159], a[176:179], v[100:103], v[144:159]
v_mfma_f32_32x32x16_bf16 v[176:191], a[180:183], v[100:103], v[176:191]
s_add_u32 s92, s5, 12288
v_mfma_f32_32x32x16_bf16 v[160:175], a[180:183], v[96:99], v[160:175]
buffer_load_dwordx4 v[48:51], v1, s[40:43], s92 offen offset:0 sc1
buffer_load_dwordx4 v[52:55], v198, s[40:43], s92 offen offset:0 sc1
v_mfma_f32_32x32x16_bf16 v[128:143], a[184:187], v[104:107], v[128:143]
s_waitcnt vmcnt(10)
v_max3_u32 v230, v112, v113, v114
v_max3_u32 v231, v115, v116, v117
v_max3_u32 v230, v230, v118, v119
v_mfma_f32_32x32x16_bf16 v[144:159], a[184:187], v[108:111], v[144:159]
v_max3_u32 v231, v231, v120, v121
v_max3_u32 v230, v230, v122, v123
v_max3_u32 v231, v231, v124, v125
v_mfma_f32_32x32x16_bf16 v[176:191], a[188:191], v[108:111], v[176:191]
v_max3_u32 v230, v230, v126, v127
v_max_u32 v230, v230, v231
v_cmp_eq_u32 vcc, -1, v230
s_add_u32 s92, s5, 12288
v_mfma_f32_32x32x16_bf16 v[160:175], a[188:191], v[104:107], v[160:175]
s_cbranch_vccnz L_spin8_B
L_ok8_B:
buffer_load_dwordx4 v[56:59], v1, s[40:43], s92 offen offset:1024 sc1
buffer_load_dwordx4 v[60:63], v198, s[40:43], s92 offen offset:1024 sc1
v_mfma_f32_32x32x16_bf16 v[128:143], a[192:195], v[112:115], v[128:143]
v_mfma_f32_32x32x16_bf16 v[144:159], a[192:195], v[116:119], v[144:159]
v_mfma_f32_32x32x16_bf16 v[176:191], a[196:199], v[116:119], v[176:191]
s_add_u32 s92, s4, 4096
v_mfma_f32_32x32x16_bf16 v[160:175], a[196:199], v[112:115], v[160:175]
buffer_load_dwordx4 v[64:67], v1, s[40:43], s92 offen offset:0 sc1
buffer_load_dwordx4 v[68:71], v198, s[40:43], s92 offen offset:0 sc1
v_mfma_f32_32x32x16_bf16 v[128:143], a[200:203], v[120:123], v[128:143]
s_waitcnt vmcnt(10)
v_max3_u32 v230, v16, v17, v18
v_max3_u32 v231, v19, v20, v21
v_max3_u32 v230, v230, v22, v23
v_mfma_f32_32x32x16_bf16 v[144:159], a[200:203], v[124:127], v[144:159]
v_max3_u32 v231, v231, v24, v25
v_max3_u32 v230, v230, v26, v27
v_max3_u32 v231, v231, v28, v29
v_mfma_f32_32x32x16_bf16 v[176:191], a[204:207], v[124:127], v[176:191]
v_max3_u32 v230, v230, v30, v31
v_max_u32 v230, v230, v231
v_cmp_eq_u32 vcc, -1, v230
s_add_u32 s92, s4, 4096
v_mfma_f32_32x32x16_bf16 v[160:175], a[204:207], v[120:123], v[160:175]
s_cbranch_vccnz L_spin9_B
L_ok9_B:
buffer_load_dwordx4 v[72:75], v1, s[40:43], s92 offen offset:1024 sc1
buffer_load_dwordx4 v[76:79], v198, s[40:43], s92 offen offset:1024 sc1
v_mfma_f32_32x32x16_bf16 v[128:143], a[208:211], v[16:19], v[128:143]
v_mfma_f32_32x32x16_bf16 v[144:159], a[208:211], v[20:23], v[144:159]
v_mfma_f32_32x32x16_bf16 v[176:191], a[212:215], v[20:23], v[176:191]
s_add_u32 s92, s5, 4096
v_mfma_f32_32x32x16_bf16 v[160:175], a[212:215], v[16:19], v[160:175]
buffer_load_dwordx4 v[80:83], v1, s[40:43], s92 offen offset:0 sc1
buffer_load_dwordx4 v[84:87], v198, s[40:43], s92 offen offset:0 sc1
v_mfma_f32_32x32x16_bf16 v[128:143], a[216:219], v[24:27], v[128:143]
s_waitcnt vmcnt(10)
v_max3_u32 v230, v32, v33, v34
v_max3_u32 v231, v35, v36, v37
v_max3_u32 v230, v230, v38, v39
v_mfma_f32_32x32x16_bf16 v[144:159], a[216:219], v[28:31], v[144:159]
v_max3_u32 v231, v231, v40, v41
v_max3_u32 v230, v230, v42, v43
v_max3_u32 v231, v231, v44, v45
v_mfma_f32_32x32x16_bf16 v[176:191], a[220:223], v[28:31], v[176:191]
v_max3_u32 v230, v230, v46, v47
v_max_u32 v230, v230, v231
v_cmp_eq_u32 vcc, -1, v230
s_add_u32 s92, s5, 4096
v_mfma_f32_32x32x16_bf16 v[160:175], a[220:223], v[24:27], v[160:175]
s_cbranch_vccnz L_spin10_B
L_ok10_B:
buffer_load_dwordx4 v[88:91], v1, s[40:43], s92 offen offset:1024 sc1
buffer_load_dwordx4 v[92:95], v198, s[40:43], s92 offen offset:1024 sc1
v_mfma_f32_32x32x16_bf16 v[128:143], a[224:227], v[32:35], v[128:143]
v_mfma_f32_32x32x16_bf16 v[144:159], a[224:227], v[36:39], v[144:159]
v_mfma_f32_32x32x16_bf16 v[176:191], a[228:231], v[36:39], v[176:191]
s_add_u32 s92, s4, 12288
v_mfma_f32_32x32x16_bf16 v[160:175], a[228:231], v[32:35], v[160:175]
buffer_load_dwordx4 v[96:99], v1, s[40:43], s92 offen offset:2048 sc1
buffer_load_dwordx4 v[100:103], v198, s[40:43], s92 offen offset:2048 sc1
v_mfma_f32_32x32x16_bf16 v[128:143], a[232:235], v[40:43], v[128:143]
s_waitcnt vmcnt(10)
v_max3_u32 v230, v48, v49, v50
v_max3_u32 v231, v51, v52, v53
v_max3_u32 v230, v230, v54, v55
v_mfma_f32_32x32x16_bf16 v[144:159], a[232:235], v[44:47], v[144:159]
v_max3_u32 v231, v231, v56, v57
v_max3_u32 v230, v230, v58, v59
v_max3_u32 v231, v231, v60, v61
v_mfma_f32_32x32x16_bf16 v[176:191], a[236:239], v[44:47], v[176:191]
v_max3_u32 v230, v230, v62, v63
v_max_u32 v230, v230, v231
v_cmp_eq_u32 vcc, -1, v230
s_add_u32 s92, s4, 12288
v_mfma_f32_32x32x16_bf16 v[160:175], a[236:239], v[40:43], v[160:175]
s_cbranch_vccnz L_spin11_B
L_ok11_B:
buffer_load_dwordx4 v[104:107], v1, s[40:43], s92 offen offset:3072 sc1
buffer_load_dwordx4 v[108:111], v198, s[40:43], s92 offen offset:3072 sc1
v_mfma_f32_32x32x16_bf16 v[128:143], a[240:243], v[48:51], v[128:143]
ds_read_b64_tr_b16 a[24:25], v236 offset:24576
ds_read_b64_tr_b16 a[26:27], v236 offset:25600
v_mfma_f32_32x32x16_bf16 v[144:159], a[240:243], v[52:55], v[144:159]
ds_read_b64_tr_b16 a[28:29], v237 offset:24576
ds_read_b64_tr_b16 a[30:31], v237 offset:25600
v_mfma_f32_32x32x16_bf16 v[176:191], a[244:247], v[52:55], v[176:191]
s_add_u32 s92, s5, 12288
v_mfma_f32_32x32x16_bf16 v[160:175], a[244:247], v[48:51], v[160:175]
buffer_load_dwordx4 v[112:115], v1, s[40:43], s92 offen offset:2048 sc1
buffer_load_dwordx4 v[116:119], v198, s[40:43], s92 offen offset:2048 sc1
s_waitcnt lgkmcnt(0)
v_mfma_f32_32x32x16_bf16 v[128:143], a[24:27], v[56:59], v[128:143]
ds_read_b64_tr_b16 a[0:1], v236 offset:32768
ds_read_b64_tr_b16 a[2:3], v236 offset:33792
s_waitcnt vmcnt(10)
v_max3_u32 v230, v64, v65, v66
v_max3_u32 v231, v67, v68, v69
v_max3_u32 v230, v230, v70, v71
v_mfma_f32_32x32x16_bf16 v[144:159], a[24:27], v[60:63], v[144:159]
ds_read_b64_tr_b16 a[4:5], v237 offset:32768
ds_read_b64_tr_b16 a[6:7], v237 offset:33792
v_max3_u32 v231, v231, v72, v73
v_max3_u32 v230, v230, v74, v75
v_max3_u32 v231, v231, v76, v77
v_mfma_f32_32x32x16_bf16 v[176:191], a[28:31], v[60:63], v[176:191]
v_max3_u32 v230, v230, v78, v79
v_max_u32 v230, v230, v231
v_cmp_eq_u32 vcc, -1, v230
s_add_u32 s92, s5, 12288
v_mfma_f32_32x32x16_bf16 v[160:175], a[28:31], v[56:59], v[160:175]
s_cbranch_vccnz L_spin12_B
L_ok12_B:
buffer_load_dwordx4 v[120:123], v1, s[40:43], s92 offen offset:3072 sc1
buffer_load_dwordx4 v[124:127], v198, s[40:43], s92 offen offset:3072 sc1
s_waitcnt lgkmcnt(0)
v_mfma_f32_32x32x16_bf16 v[128:143], a[0:3], v[64:67], v[128:143]
ds_read_b64_tr_b16 a[8:9], v236 offset:0
ds_read_b64_tr_b16 a[10:11], v236 offset:1024
v_mfma_f32_32x32x16_bf16 v[144:159], a[0:3], v[68:71], v[144:159]
ds_read_b64_tr_b16 a[12:13], v237 offset:0
ds_read_b64_tr_b16 a[14:15], v237 offset:1024
v_mfma_f32_32x32x16_bf16 v[176:191], a[4:7], v[68:71], v[176:191]
s_add_u32 s92, s4, 4096
v_mfma_f32_32x32x16_bf16 v[160:175], a[4:7], v[64:67], v[160:175]
buffer_load_dwordx4 v[16:19], v1, s[40:43], s92 offen offset:2048 sc1
buffer_load_dwordx4 v[20:23], v198, s[40:43], s92 offen offset:2048 sc1
s_waitcnt lgkmcnt(0)
v_mfma_f32_32x32x16_bf16 v[128:143], a[8:11], v[72:75], v[128:143]
ds_read_b64_tr_b16 a[16:17], v236 offset:40960
ds_read_b64_tr_b16 a[18:19], v236 offset:41984
s_waitcnt vmcnt(10)
v_max3_u32 v230, v80, v81, v82
v_max3_u32 v231, v83, v84, v85
v_max3_u32 v230, v230, v86, v87
v_mfma_f32_32x32x16_bf16 v[144:159], a[8:11], v[76:79], v[144:159]
ds_read_b64_tr_b16 a[20:21], v237 offset:40960
ds_read_b64_tr_b16 a[22:23], v237 offset:41984
v_max3_u32 v231, v231, v88, v89
v_max3_u32 v230, v230, v90, v91
v_max3_u32 v231, v231, v92, v93
v_mfma_f32_32x32x16_bf16 v[176:191], a[12:15], v[76:79], v[176:191]
v_max3_u32 v230, v230, v94, v95
v_max_u32 v230, v230, v231
v_cmp_eq_u32 vcc, -1, v230
s_add_u32 s92, s4, 4096
v_mfma_f32_32x32x16_bf16 v[160:175], a[12:15], v[72:75], v[160:175]
s_cbranch_vccnz L_spin13_B
L_ok13_B:
buffer_load_dwordx4 v[24:27], v1, s[40:43], s92 offen offset:3072 sc1
buffer_load_dwordx4 v[28:31], v198, s[40:43], s92 offen offset:3072 sc1
s_waitcnt lgkmcnt(0)
v_mfma_f32_32x32x16_bf16 v[128:143], a[16:19], v[80:83], v[128:143]
ds_read_b64_tr_b16 a[24:25], v236 offset:49152
ds_read_b64_tr_b16 a[26:27], v236 offset:50176
v_mfma_f32_32x32x16_bf16 v[144:159], a[16:19], v[84:87], v[144:159]
ds_read_b64_tr_b16 a[28:29], v237 offset:49152
ds_read_b64_tr_b16 a[30:31], v237 offset:50176
v_mfma_f32_32x32x16_bf16 v[176:191], a[20:23], v[84:87], v[176:191]
s_add_u32 s92, s5, 4096
v_mfma_f32_32x32x16_bf16 v[160:175], a[20:23], v[80:83], v[160:175]
buffer_load_dwordx4 v[32:35], v1, s[40:43], s92 offen offset:2048 sc1
buffer_load_dwordx4 v[36:39], v198, s[40:43], s92 offen offset:2048 sc1
s_waitcnt lgkmcnt(0)
v_mfma_f32_32x32x16_bf16 v[128:143], a[24:27], v[88:91], v[128:143]
ds_read_b64_tr_b16 a[0:1], v232 offset:49152
ds_read_b64_tr_b16 a[2:3], v232 offset:50176
s_waitcnt vmcnt(10)
v_max3_u32 v230, v96, v97, v98
v_max3_u32 v231, v99, v100, v101
v_max3_u32 v230, v230, v102, v103
v_mfma_f32_32x32x16_bf16 v[144:159], a[24:27], v[92:95], v[144:159]
ds_read_b64_tr_b16 a[4:5], v233 offset:49152
ds_read_b64_tr_b16 a[6:7], v233 offset:50176
v_max3_u32 v231, v231, v104, v105
v_max3_u32 v230, v230, v106, v107
v_max3_u32 v231, v231, v108, v109
v_mfma_f32_32x32x16_bf16 v[176:191], a[28:31], v[92:95], v[176:191]
v_max3_u32 v230, v230, v110, v111
v_max_u32 v230, v230, v231
v_cmp_eq_u32 vcc, -1, v230
s_add_u32 s92, s5, 4096
v_mfma_f32_32x32x16_bf16 v[160:175], a[28:31], v[88:91], v[160:175]
s_cbranch_vccnz L_spin14_B
L_ok14_B:
buffer_load_dwordx4 v[40:43], v1, s[40:43], s92 offen offset:3072 sc1
buffer_load_dwordx4 v[44:47], v198, s[40:43], s92 offen offset:3072 sc1
s_waitcnt lgkmcnt(0)
v_mfma_f32_32x32x16_bf16 v[128:143], a[0:3], v[96:99], v[128:143]
ds_read_b64_tr_b16 a[8:9], v232 offset:57344
ds_read_b64_tr_b16 a[10:11], v232 offset:58368
v_mfma_f32_32x32x16_bf16 v[144:159], a[0:3], v[100:103], v[144:159]
ds_read_b64_tr_b16 a[12:13], v233 offset:57344
ds_read_b64_tr_b16 a[14:15], v233 offset:58368
v_mfma_f32_32x32x16_bf16 v[176:191], a[4:7], v[100:103], v[176:191]
s_add_u32 s92, s4, 16384
v_mfma_f32_32x32x16_bf16 v[160:175], a[4:7], v[96:99], v[160:175]
buffer_load_dwordx4 v[48:51], v1, s[40:43], s92 offen offset:0 sc1
buffer_load_dwordx4 v[52:55], v198, s[40:43], s92 offen offset:0 sc1
buffer_load_dwordx4 v[204:207], v222, s[24:27], s3 offen
buffer_load_dwordx4 v[208:211], v223, s[24:27], s3 offen
s_waitcnt lgkmcnt(0)
v_mfma_f32_32x32x16_bf16 v[128:143], a[8:11], v[104:107], v[128:143]
ds_read_b64_tr_b16 a[16:17], v236 offset:8192
ds_read_b64_tr_b16 a[18:19], v236 offset:9216
s_waitcnt vmcnt(12)
v_max3_u32 v230, v112, v113, v114
v_max3_u32 v231, v115, v116, v117
v_max3_u32 v230, v230, v118, v119
v_mfma_f32_32x32x16_bf16 v[144:159], a[8:11], v[108:111], v[144:159]
ds_read_b64_tr_b16 a[20:21], v237 offset:8192
ds_read_b64_tr_b16 a[22:23], v237 offset:9216
v_max3_u32 v231, v231, v120, v121
v_max3_u32 v230, v230, v122, v123
v_max3_u32 v231, v231, v124, v125
v_mfma_f32_32x32x16_bf16 v[176:191], a[12:15], v[108:111], v[176:191]
v_max3_u32 v230, v230, v126, v127
v_max_u32 v230, v230, v231
v_cmp_eq_u32 vcc, -1, v230
s_add_u32 s92, s4, 16384
v_mfma_f32_32x32x16_bf16 v[160:175], a[12:15], v[104:107], v[160:175]
s_cbranch_vccnz L_spin15_B
L_ok15_B:
buffer_load_dwordx4 v[56:59], v1, s[40:43], s92 offen offset:1024 sc1
buffer_load_dwordx4 v[60:63], v198, s[40:43], s92 offen offset:1024 sc1
s_waitcnt lgkmcnt(0)
v_mfma_f32_32x32x16_bf16 v[128:143], a[16:19], v[112:115], v[128:143]
ds_read_b64_tr_b16 a[24:25], v236 offset:16384
ds_read_b64_tr_b16 a[26:27], v236 offset:17408
v_mfma_f32_32x32x16_bf16 v[144:159], a[16:19], v[116:119], v[144:159]
ds_read_b64_tr_b16 a[28:29], v237 offset:16384
ds_read_b64_tr_b16 a[30:31], v237 offset:17408
v_mfma_f32_32x32x16_bf16 v[176:191], a[20:23], v[116:119], v[176:191]
s_add_u32 s92, s5, 16384
v_mfma_f32_32x32x16_bf16 v[160:175], a[20:23], v[112:115], v[160:175]
buffer_load_dwordx4 v[64:67], v1, s[40:43], s92 offen offset:0 sc1
buffer_load_dwordx4 v[68:71], v198, s[40:43], s92 offen offset:0 sc1
s_waitcnt lgkmcnt(0)
v_mfma_f32_32x32x16_bf16 v[128:143], a[24:27], v[120:123], v[128:143]
ds_read_b64_tr_b16 a[0:1], v236 offset:57344
ds_read_b64_tr_b16 a[2:3], v236 offset:58368
s_waitcnt vmcnt(12)
v_max3_u32 v230, v16, v17, v18
v_max3_u32 v231, v19, v20, v21
v_max3_u32 v230, v230, v22, v23
v_mfma_f32_32x32x16_bf16 v[144:159], a[24:27], v[124:127], v[144:159]
ds_read_b64_tr_b16 a[4:5], v237 offset:57344
ds_read_b64_tr_b16 a[6:7], v237 offset:58368
v_max3_u32 v231, v231, v24, v25
v_max3_u32 v230, v230, v26, v27
v_max3_u32 v231, v231, v28, v29
v_mfma_f32_32x32x16_bf16 v[176:191], a[28:31], v[124:127], v[176:191]
v_max3_u32 v230, v230, v30, v31
v_max_u32 v230, v230, v231
v_cmp_eq_u32 vcc, -1, v230
s_add_u32 s92, s5, 16384
v_mfma_f32_32x32x16_bf16 v[160:175], a[28:31], v[120:123], v[160:175]
s_cbranch_vccnz L_spin16_B
L_ok16_B:
buffer_load_dwordx4 v[72:75], v1, s[40:43], s92 offen offset:1024 sc1
buffer_load_dwordx4 v[76:79], v198, s[40:43], s92 offen offset:1024 sc1
s_waitcnt lgkmcnt(0)
v_mfma_f32_32x32x16_bf16 v[128:143], a[0:3], v[16:19], v[128:143]
ds_read_b64_tr_b16 a[8:9], v232 offset:0
ds_read_b64_tr_b16 a[10:11], v232 offset:1024
v_mfma_f32_32x32x16_bf16 v[144:159], a[0:3], v[20:23], v[144:159]
ds_read_b64_tr_b16 a[12:13], v233 offset:0
ds_read_b64_tr_b16 a[14:15], v233 offset:1024
v_mfma_f32_32x32x16_bf16 v[176:191], a[4:7], v[20:23], v[176:191]
v_mfma_f32_32x32x16_bf16 v[160:175], a[4:7], v[16:19], v[160:175]
s_waitcnt lgkmcnt(0)
v_mfma_f32_32x32x16_bf16 v[128:143], a[8:11], v[24:27], v[128:143]
ds_read_b64_tr_b16 a[16:17], v232 offset:8192
ds_read_b64_tr_b16 a[18:19], v232 offset:9216
s_waitcnt vmcnt(10)
v_max3_u32 v230, v32, v33, v34
v_max3_u32 v231, v35, v36, v37
v_max3_u32 v230, v230, v38, v39
v_mfma_f32_32x32x16_bf16 v[144:159], a[8:11], v[28:31], v[144:159]
ds_read_b64_tr_b16 a[20:21], v233 offset:8192
ds_read_b64_tr_b16 a[22:23], v233 offset:9216
v_max3_u32 v231, v231, v40, v41
v_max3_u32 v230, v230, v42, v43
v_max3_u32 v231, v231, v44, v45
v_mfma_f32_32x32x16_bf16 v[176:191], a[12:15], v[28:31], v[176:191]
v_max3_u32 v230, v230, v46, v47
v_max_u32 v230, v230, v231
v_cmp_eq_u32 vcc, -1, v230
v_mfma_f32_32x32x16_bf16 v[160:175], a[12:15], v[24:27], v[160:175]
s_cbranch_vccnz L_spin17_B
L_ok17_B:
s_waitcnt lgkmcnt(0)
v_mfma_f32_32x32x16_bf16 v[128:143], a[16:19], v[32:35], v[128:143]
ds_read_b64_tr_b16 a[24:25], v226 offset:0
ds_read_b64_tr_b16 a[26:27], v226 offset:1024
v_mfma_f32_32x32x16_bf16 v[144:159], a[16:19], v[36:39], v[144:159]
ds_read_b64_tr_b16 a[28:29], v228 offset:0
ds_read_b64_tr_b16 a[30:31], v228 offset:1024
v_mfma_f32_32x32x16_bf16 v[176:191], a[20:23], v[36:39], v[176:191]
v_mfma_f32_32x32x16_bf16 v[160:175], a[20:23], v[32:35], v[160:175]
s_waitcnt lgkmcnt(0)
v_mfma_f32_32x32x16_bf16 v[128:143], a[24:27], v[40:43], v[128:143]
ds_read_b64_tr_b16 a[0:1], v226 offset:12288
ds_read_b64_tr_b16 a[2:3], v226 offset:13312
s_waitcnt vmcnt(8)
v_max3_u32 v230, v48, v49, v50
v_mfma_f32_32x32x16_bf16 v[144:159], a[24:27], v[44:47], v[144:159]
ds_read_b64_tr_b16 a[4:5], v228 offset:12288
ds_read_b64_tr_b16 a[6:7], v228 offset:13312
v_max3_u32 v231, v51, v52, v53
v_max3_u32 v230, v230, v54, v55
v_mfma_f32_32x32x16_bf16 v[176:191], a[28:31], v[44:47], v[176:191]
v_max_u32 v230, v230, v231
v_cmp_eq_u32 vcc, -1, v230
v_mfma_f32_32x32x16_bf16 v[160:175], a[28:31], v[40:43], v[160:175]
s_cbranch_vccnz L_spin18_B
L_ok18_B:
s_waitcnt lgkmcnt(0)
v_mfma_f32_32x32x16_bf16 v[128:143], a[0:3], v[48:51], v[128:143]
ds_read_b64_tr_b16 a[8:9], v226 offset:20480
ds_read_b64_tr_b16 a[10:11], v226 offset:21504
s_waitcnt vmcnt(0)
v_max3_u32 v230, v56, v57, v58
v_max3_u32 v231, v59, v60, v61
v_max3_u32 v230, v230, v62, v63
v_max3_u32 v231, v231, v64, v65
v_mfma_f32_32x32x16_bf16 v[144:159], a[0:3], v[52:55], v[144:159]
ds_read_b64_tr_b16 a[12:13], v228 offset:20480
ds_read_b64_tr_b16 a[14:15], v228 offset:21504
v_max3_u32 v230, v230, v66, v67
v_max3_u32 v231, v231, v68, v69
v_max3_u32 v230, v230, v70, v71
v_max3_u32 v231, v231, v72, v73
v_max3_u32 v230, v230, v74, v75
v_mfma_f32_32x32x16_bf16 v[176:191], a[4:7], v[52:55], v[176:191]
ds_read_b64_tr_b16 a[16:17], v232 offset:16384
ds_read_b64_tr_b16 a[18:19], v232 offset:17408
ds_read_b64_tr_b16 a[20:21], v233 offset:16384
ds_read_b64_tr_b16 a[22:23], v233 offset:17408
v_max3_u32 v231, v231, v76, v77
v_max3_u32 v230, v230, v78, v79
v_max_u32 v230, v230, v231
v_cmp_eq_u32 vcc, -1, v230
v_mfma_f32_32x32x16_bf16 v[160:175], a[4:7], v[48:51], v[160:175]
s_cbranch_vccnz L_spin19_B
L_ok19_B:
ds_read_b64_tr_b16 a[24:25], v232 offset:24576
ds_read_b64_tr_b16 a[26:27], v232 offset:25600
ds_read_b64_tr_b16 a[28:29], v233 offset:24576
ds_read_b64_tr_b16 a[30:31], v233 offset:25600
s_waitcnt lgkmcnt(0)
v_mfma_f32_32x32x16_bf16 v[128:143], a[8:11], v[56:59], v[128:143]
v_lshlrev_b32 v80, 16, v204
v_lshlrev_b32 v82, 16, v205
v_lshlrev_b32 v84, 16, v206
v_mfma_f32_32x32x16_bf16 v[128:143], a[16:19], v[64:67], v[128:143]
v_lshlrev_b32 v86, 16, v207
v_lshlrev_b32 v88, 16, v208
v_lshlrev_b32 v90, 16, v209
v_mfma_f32_32x32x16_bf16 v[128:143], a[24:27], v[72:75], v[128:143]
v_lshlrev_b32 v92, 16, v210
v_lshlrev_b32 v94, 16, v211
v_and_b32 v81, 0xffff0000, v204
v_mfma_f32_32x32x16_bf16 v[144:159], a[8:11], v[60:63], v[144:159]
v_and_b32 v83, 0xffff0000, v205
v_and_b32 v85, 0xffff0000, v206
v_and_b32 v87, 0xffff0000, v207
v_mfma_f32_32x32x16_bf16 v[144:159], a[16:19], v[68:71], v[144:159]
v_and_b32 v89, 0xffff0000, v208
v_and_b32 v91, 0xffff0000, v209
v_and_b32 v93, 0xffff0000, v210
v_mfma_f32_32x32x16_bf16 v[144:159], a[24:27], v[76:79], v[144:159]
v_and_b32 v95, 0xffff0000, v211
v_mfma_f32_32x32x16_bf16 v[160:175], a[12:15], v[56:59], v[160:175]
ds_write_b128 v216, v[128:131] offset:0
ds_write_b128 v217, v[132:135] offset:0
v_mfma_f32_32x32x16_bf16 v[160:175], a[20:23], v[64:67], v[160:175]
ds_write_b128 v218, v[136:139] offset:0
ds_write_b128 v219, v[140:143] offset:0
v_mfma_f32_32x32x16_bf16 v[160:175], a[28:31], v[72:75], v[160:175]
v_mfma_f32_32x32x16_bf16 v[176:191], a[12:15], v[60:63], v[176:191]
s_nop 2
ds_write_b128 v216, v[144:147] offset:32768
ds_write_b128 v217, v[148:151] offset:32768
v_mfma_f32_32x32x16_bf16 v[176:191], a[20:23], v[68:71], v[176:191]
ds_write_b128 v218, v[152:155] offset:32768
ds_write_b128 v219, v[156:159] offset:32768
v_mfma_f32_32x32x16_bf16 v[176:191], a[28:31], v[76:79], v[176:191]
s_nop 1
ds_write_b128 v216, v[160:163] offset:128
ds_write_b128 v217, v[164:167] offset:128
ds_write_b128 v218, v[168:171] offset:128
ds_write_b128 v219, v[172:175] offset:128
s_nop 5
ds_write_b128 v216, v[176:179] offset:32896
ds_write_b128 v217, v[180:183] offset:32896
ds_write_b128 v218, v[184:187] offset:32896
ds_write_b128 v219, v[188:191] offset:32896
s_waitcnt lgkmcnt(0)
s_barrier
ds_read_b128 v[16:19], v220 offset:0
ds_read_b128 v[20:23], v221 offset:0
ds_read_b128 v[24:27], v220 offset:32768
ds_read_b128 v[28:31], v221 offset:32768
ds_read_b128 v[32:35], v220 offset:2048
ds_read_b128 v[36:39], v221 offset:2048
ds_read_b128 v[40:43], v220 offset:34816
ds_read_b128 v[44:47], v221 offset:34816
ds_read_b128 v[48:51], v220 offset:4096
ds_read_b128 v[52:55], v221 offset:4096
ds_read_b128 v[56:59], v220 offset:36864
ds_read_b128 v[60:63], v221 offset:36864
ds_read_b128 v[64:67], v220 offset:6144
ds_read_b128 v[68:71], v221 offset:6144
ds_read_b128 v[72:75], v220 offset:38912
ds_read_b128 v[76:79], v221 offset:38912
s_waitcnt lgkmcnt(8)
v_pk_add_f32 v[16:17], v[16:17], v[32:33]
v_pk_add_f32 v[18:19], v[18:19], v[34:35]
v_pk_add_f32 v[20:21], v[20:21], v[36:37]
v_pk_add_f32 v[22:23], v[22:23], v[38:39]
v_pk_add_f32 v[24:25], v[24:25], v[40:41]
v_pk_add_f32 v[26:27], v[26:27], v[42:43]
v_pk_add_f32 v[28:29], v[28:29], v[44:45]
v_pk_add_f32 v[30:31], v[30:31], v[46:47]
v_pk_add_f32 v[16:17], v[16:17], v[80:81]
v_pk_add_f32 v[18:19], v[18:19], v[82:83]
v_pk_add_f32 v[20:21], v[20:21], v[84:85]
v_pk_add_f32 v[22:23], v[22:23], v[86:87]
v_pk_add_f32 v[24:25], v[24:25], v[88:89]
v_pk_add_f32 v[26:27], v[26:27], v[90:91]
v_pk_add_f32 v[28:29], v[28:29], v[92:93]
v_pk_add_f32 v[30:31], v[30:31], v[94:95]
s_waitcnt lgkmcnt(0)
v_pk_add_f32 v[48:49], v[48:49], v[64:65]
v_pk_add_f32 v[50:51], v[50:51], v[66:67]
v_pk_add_f32 v[52:53], v[52:53], v[68:69]
v_pk_add_f32 v[54:55], v[54:55], v[70:71]
v_pk_add_f32 v[56:57], v[56:57], v[72:73]
v_pk_add_f32 v[58:59], v[58:59], v[74:75]
v_pk_add_f32 v[60:61], v[60:61], v[76:77]
v_pk_add_f32 v[62:63], v[62:63], v[78:79]
v_pk_add_f32 v[16:17], v[16:17], v[48:49]
v_pk_add_f32 v[18:19], v[18:19], v[50:51]
v_pk_add_f32 v[20:21], v[20:21], v[52:53]
v_pk_add_f32 v[22:23], v[22:23], v[54:55]
v_cvt_pk_bf16_f32 v96, v16, v17
v_cvt_pk_bf16_f32 v97, v18, v19
v_cvt_pk_bf16_f32 v98, v20, v21
v_cvt_pk_bf16_f32 v99, v22, v23
buffer_store_dwordx4 v[96:99], v222, s[36:39], s3 offen sc1
v_pk_add_f32 v[24:25], v[24:25], v[56:57]
v_pk_add_f32 v[26:27], v[26:27], v[58:59]
v_pk_add_f32 v[28:29], v[28:29], v[60:61]
v_pk_add_f32 v[30:31], v[30:31], v[62:63]
v_cvt_pk_bf16_f32 v100, v24, v25
v_cvt_pk_bf16_f32 v101, v26, v27
v_cvt_pk_bf16_f32 v102, v28, v29
v_cvt_pk_bf16_f32 v103, v30, v31
buffer_store_dwordx4 v[100:103], v223, s[36:39], s3 offen sc1
L_fin_B:
L_end_B:
s_endpgm
L_spin1_B:
s_mov_b32 s98, 0x8000
s_waitcnt vmcnt(0)
L_spinl1_B:
s_sleep 2
buffer_load_dwordx4 v[192:195], v239, s[40:43], s2 offen sc1
s_waitcnt vmcnt(0)
v_max3_u32 v230, v192, v193, v194
v_mov_b32 v231, v195
v_max_u32 v230, v230, v231
v_cmp_eq_u32 vcc, -1, v230
s_cbranch_vccz L_ok1_B
s_sub_u32 s98, s98, 1
s_cmp_lg_u32 s98, 0
s_cbranch_scc1 L_spinl1_B
s_branch L_ok1_B
L_spin3_B:
s_mov_b32 s98, 0x8000
s_waitcnt vmcnt(0)
L_spinl3_B:
s_sleep 2
buffer_load_dword v227, v229, s[40:43], s87 offen sc1
s_waitcnt vmcnt(0)
v_cmp_eq_u32 vcc, 0, v227
s_cbranch_vccz L_ok3_B
s_sub_u32 s98, s98, 1
s_cmp_lg_u32 s98, 0
s_cbranch_scc1 L_spinl3_B
s_branch L_ok3_B
L_spin4_B:
s_mov_b32 s98, 0x8000
s_waitcnt vmcnt(0)
L_spinl4_B:
s_sleep 2
buffer_load_dword v227, v4, s[40:43], s85 offen sc1
s_waitcnt vmcnt(0)
v_cmp_gt_u32 vcc, 1, v227
s_cbranch_vccz L_ok4_B
s_sub_u32 s98, s98, 1
s_cmp_lg_u32 s98, 0
s_cbranch_scc1 L_spinl4_B
s_branch L_ok4_B
L_spin5_B:
s_mov_b32 s98, 0x8000
s_waitcnt vmcnt(0)
L_spinl5_B:
s_sleep 2
buffer_load_dwordx4 v[200:203], v1, s[40:43], s1 offen offset:0 sc1
buffer_load_dwordx4 v[204:207], v1, s[40:43], s1 offen offset:1024 sc1
buffer_load_dwordx4 v[208:211], v1, s[40:43], s1 offen offset:2048 sc1
buffer_load_dwordx4 v[212:215], v1, s[40:43], s1 offen offset:3072 sc1
s_waitcnt vmcnt(0)
v_max3_u32 v230, v200, v201, v202
v_max3_u32 v231, v203, v204, v205
v_max3_u32 v230, v230, v206, v207
v_max3_u32 v231, v231, v208, v209
v_max3_u32 v230, v230, v210, v211
v_max3_u32 v231, v231, v212, v213
v_max3_u32 v230, v230, v214, v215
v_max_u32 v230, v230, v231
v_cmp_eq_u32 vcc, -1, v230
s_cbranch_vccz L_ok5_B
s_sub_u32 s98, s98, 1
s_cmp_lg_u32 s98, 0
s_cbranch_scc1 L_spinl5_B
s_branch L_ok5_B
L_spin6_B:
s_mov_b32 s98, 0x8000
s_waitcnt vmcnt(0)
L_spinl6_B:
s_sleep 2
buffer_load_dwordx4 v[80:83], v1, s[40:43], s4 offen offset:2048 sc1
buffer_load_dwordx4 v[84:87], v198, s[40:43], s4 offen offset:2048 sc1
buffer_load_dwordx4 v[88:91], v1, s[40:43], s4 offen offset:3072 sc1
buffer_load_dwordx4 v[92:95], v198, s[40:43], s4 offen offset:3072 sc1
s_waitcnt vmcnt(0)
v_max3_u32 v230, v80, v81, v82
v_max3_u32 v231, v83, v84, v85
v_max3_u32 v230, v230, v86, v87
v_max3_u32 v231, v231, v88, v89
v_max3_u32 v230, v230, v90, v91
v_max3_u32 v231, v231, v92, v93
v_max3_u32 v230, v230, v94, v95
v_max_u32 v230, v230, v231
v_cmp_eq_u32 vcc, -1, v230
s_cbranch_vccz L_ok6_B
s_sub_u32 s98, s98, 1
s_cmp_lg_u32 s98, 0
s_cbranch_scc1 L_spinl6_B
s_branch L_ok6_B
L_spin7_B:
s_mov_b32 s98, 0x8000
s_waitcnt vmcnt(0)
L_spinl7_B:
s_sleep 2
s_add_u32 s101, s4, 8192
buffer_load_dwordx4 v[96:99], v1, s[40:43], s101 offen offset:2048 sc1
buffer_load_dwordx4 v[100:103], v198, s[40:43], s101 offen offset:2048 sc1
s_add_u32 s101, s4, 8192
buffer_load_dwordx4 v[104:107], v1, s[40:43], s101 offen offset:3072 sc1
buffer_load_dwordx4 v[108:111], v198, s[40:43], s101 offen offset:3072 sc1
s_waitcnt vmcnt(0)
v_max3_u32 v230, v96, v97, v98
v_max3_u32 v231, v99, v100, v101
v_max3_u32 v230, v230, v102, v103
v_max3_u32 v231, v231, v104, v105
v_max3_u32 v230, v230, v106, v107
v_max3_u32 v231, v231, v108, v109
v_max3_u32 v230, v230, v110, v111
v_max_u32 v230, v230, v231
v_cmp_eq_u32 vcc, -1, v230
s_cbranch_vccz L_ok7_B
s_sub_u32 s98, s98, 1
s_cmp_lg_u32 s98, 0
s_cbranch_scc1 L_spinl7_B
s_branch L_ok7_B
L_spin8_B:
s_mov_b32 s98, 0x8000
s_waitcnt vmcnt(0)
L_spinl8_B:
s_sleep 2
buffer_load_dwordx4 v[112:115], v1, s[40:43], s5 offen offset:2048 sc1
buffer_load_dwordx4 v[116:119], v198, s[40:43], s5 offen offset:2048 sc1
buffer_load_dwordx4 v[120:123], v1, s[40:43], s5 offen offset:3072 sc1
buffer_load_dwordx4 v[124:127], v198, s[40:43], s5 offen offset:3072 sc1
s_waitcnt vmcnt(0)
v_max3_u32 v230, v112, v113, v114
v_max3_u32 v231, v115, v116, v117
v_max3_u32 v230, v230, v118, v119
v_max3_u32 v231, v231, v120, v121
v_max3_u32 v230, v230, v122, v123
v_max3_u32 v231, v231, v124, v125
v_max3_u32 v230, v230, v126, v127
v_max_u32 v230, v230, v231
v_cmp_eq_u32 vcc, -1, v230
s_cbranch_vccz L_ok8_B
s_sub_u32 s98, s98, 1
s_cmp_lg_u32 s98, 0
s_cbranch_scc1 L_spinl8_B
s_branch L_ok8_B
L_spin9_B:
s_mov_b32 s98, 0x8000
s_waitcnt vmcnt(0)
L_spinl9_B:
s_sleep 2
s_add_u32 s101, s5, 8192
buffer_load_dwordx4 v[16:19], v1, s[40:43], s101 offen offset:2048 sc1
buffer_load_dwordx4 v[20:23], v198, s[40:43], s101 offen offset:2048 sc1
s_add_u32 s101, s5, 8192
buffer_load_dwordx4 v[24:27], v1, s[40:43], s101 offen offset:3072 sc1
buffer_load_dwordx4 v[28:31], v198, s[40:43], s101 offen offset:3072 sc1
s_waitcnt vmcnt(0)
v_max3_u32 v230, v16, v17, v18
v_max3_u32 v231, v19, v20, v21
v_max3_u32 v230, v230, v22, v23
v_max3_u32 v231, v231, v24, v25
v_max3_u32 v230, v230, v26, v27
v_max3_u32 v231, v231, v28, v29
v_max3_u32 v230, v230, v30, v31
v_max_u32 v230, v230, v231
v_cmp_eq_u32 vcc, -1, v230
s_cbranch_vccz L_ok9_B
s_sub_u32 s98, s98, 1
s_cmp_lg_u32 s98, 0
s_cbranch_scc1 L_spinl9_B
s_branch L_ok9_B
L_spin10_B:
s_mov_b32 s98, 0x8000
s_waitcnt vmcnt(0)
L_spinl10_B:
s_sleep 2
s_add_u32 s101, s4, 12288
buffer_load_dwordx4 v[32:35], v1, s[40:43], s101 offen offset:0 sc1
buffer_load_dwordx4 v[36:39], v198, s[40:43], s101 offen offset:0 sc1
s_add_u32 s101, s4, 12288
buffer_load_dwordx4 v[40:43], v1, s[40:43], s101 offen offset:1024 sc1
buffer_load_dwordx4 v[44:47], v198, s[40:43], s101 offen offset:1024 sc1
s_waitcnt vmcnt(0)
v_max3_u32 v230, v32, v33, v34
v_max3_u32 v231, v35, v36, v37
v_max3_u32 v230, v230, v38, v39
v_max3_u32 v231, v231, v40, v41
v_max3_u32 v230, v230, v42, v43
v_max3_u32 v231, v231, v44, v45
v_max3_u32 v230, v230, v46, v47
v_max_u32 v230, v230, v231
v_cmp_eq_u32 vcc, -1, v230
s_cbranch_vccz L_ok10_B
s_sub_u32 s98, s98, 1
s_cmp_lg_u32 s98, 0
s_cbranch_scc1 L_spinl10_B
s_branch L_ok10_B
L_spin11_B:
s_mov_b32 s98, 0x8000
s_waitcnt vmcnt(0)
L_spinl11_B:
s_sleep 2
s_add_u32 s101, s5, 12288
buffer_load_dwordx4 v[48:51], v1, s[40:43], s101 offen offset:0 sc1
buffer_load_dwordx4 v[52:55], v198, s[40:43], s101 offen offset:0 sc1
s_add_u32 s101, s5, 12288
buffer_load_dwordx4 v[56:59], v1, s[40:43], s101 offen offset:1024 sc1
buffer_load_dwordx4 v[60:63], v198, s[40:43], s101 offen offset:1024 sc1
s_waitcnt vmcnt(0)
v_max3_u32 v230, v48, v49, v50
v_max3_u32 v231, v51, v52, v53
v_max3_u32 v230, v230, v54, v55
v_max3_u32 v231, v231, v56, v57
v_max3_u32 v230, v230, v58, v59
v_max3_u32 v231, v231, v60, v61
v_max3_u32 v230, v230, v62, v63
v_max_u32 v230, v230, v231
v_cmp_eq_u32 vcc, -1, v230
s_cbranch_vccz L_ok11_B
s_sub_u32 s98, s98, 1
s_cmp_lg_u32 s98, 0
s_cbranch_scc1 L_spinl11_B
s_branch L_ok11_B
L_spin12_B:
s_mov_b32 s98, 0x8000
s_waitcnt vmcnt(0)
L_spinl12_B:
s_sleep 2
s_add_u32 s101, s4, 4096
buffer_load_dwordx4 v[64:67], v1, s[40:43], s101 offen offset:0 sc1
buffer_load_dwordx4 v[68:71], v198, s[40:43], s101 offen offset:0 sc1
s_add_u32 s101, s4, 4096
buffer_load_dwordx4 v[72:75], v1, s[40:43], s101 offen offset:1024 sc1
buffer_load_dwordx4 v[76:79], v198, s[40:43], s101 offen offset:1024 sc1
s_waitcnt vmcnt(0)
v_max3_u32 v230, v64, v65, v66
v_max3_u32 v231, v67, v68, v69
v_max3_u32 v230, v230, v70, v71
v_max3_u32 v231, v231, v72, v73
v_max3_u32 v230, v230, v74, v75
v_max3_u32 v231, v231, v76, v77
v_max3_u32 v230, v230, v78, v79
v_max_u32 v230, v230, v231
v_cmp_eq_u32 vcc, -1, v230
s_cbranch_vccz L_ok12_B
s_sub_u32 s98, s98, 1
s_cmp_lg_u32 s98, 0
s_cbranch_scc1 L_spinl12_B
s_branch L_ok12_B
L_spin13_B:
s_mov_b32 s98, 0x8000
s_waitcnt vmcnt(0)
L_spinl13_B:
s_sleep 2
s_add_u32 s101, s5, 4096
buffer_load_dwordx4 v[80:83], v1, s[40:43], s101 offen offset:0 sc1
buffer_load_dwordx4 v[84:87], v198, s[40:43], s101 offen offset:0 sc1
s_add_u32 s101, s5, 4096
buffer_load_dwordx4 v[88:91], v1, s[40:43], s101 offen offset:1024 sc1
buffer_load_dwordx4 v[92:95], v198, s[40:43], s101 offen offset:1024 sc1
s_waitcnt vmcnt(0)
v_max3_u32 v230, v80, v81, v82
v_max3_u32 v231, v83, v84, v85
v_max3_u32 v230, v230, v86, v87
v_max3_u32 v231, v231, v88, v89
v_max3_u32 v230, v230, v90, v91
v_max3_u32 v231, v231, v92, v93
v_max3_u32 v230, v230, v94, v95
v_max_u32 v230, v230, v231
v_cmp_eq_u32 vcc, -1, v230
s_cbranch_vccz L_ok13_B
s_sub_u32 s98, s98, 1
s_cmp_lg_u32 s98, 0
s_cbranch_scc1 L_spinl13_B
s_branch L_ok13_B
L_spin14_B:
s_mov_b32 s98, 0x8000
s_waitcnt vmcnt(0)
L_spinl14_B:
s_sleep 2
s_add_u32 s101, s4, 12288
buffer_load_dwordx4 v[96:99], v1, s[40:43], s101 offen offset:2048 sc1
buffer_load_dwordx4 v[100:103], v198, s[40:43], s101 offen offset:2048 sc1
s_add_u32 s101, s4, 12288
buffer_load_dwordx4 v[104:107], v1, s[40:43], s101 offen offset:3072 sc1
buffer_load_dwordx4 v[108:111], v198, s[40:43], s101 offen offset:3072 sc1
s_waitcnt vmcnt(0)
v_max3_u32 v230, v96, v97, v98
v_max3_u32 v231, v99, v100, v101
v_max3_u32 v230, v230, v102, v103
v_max3_u32 v231, v231, v104, v105
v_max3_u32 v230, v230, v106, v107
v_max3_u32 v231, v231, v108, v109
v_max3_u32 v230, v230, v110, v111
v_max_u32 v230, v230, v231
v_cmp_eq_u32 vcc, -1, v230
s_cbranch_vccz L_ok14_B
s_sub_u32 s98, s98, 1
s_cmp_lg_u32 s98, 0
s_cbranch_scc1 L_spinl14_B
s_branch L_ok14_B
L_spin15_B:
s_mov_b32 s98, 0x8000
s_waitcnt vmcnt(0)
L_spinl15_B:
s_sleep 2
s_add_u32 s101, s5, 12288
buffer_load_dwordx4 v[112:115], v1, s[40:43], s101 offen offset:2048 sc1
buffer_load_dwordx4 v[116:119], v198, s[40:43], s101 offen offset:2048 sc1
s_add_u32 s101, s5, 12288
buffer_load_dwordx4 v[120:123], v1, s[40:43], s101 offen offset:3072 sc1
buffer_load_dwordx4 v[124:127], v198, s[40:43], s101 offen offset:3072 sc1
s_waitcnt vmcnt(0)
v_max3_u32 v230, v112, v113, v114
v_max3_u32 v231, v115, v116, v117
v_max3_u32 v230, v230, v118, v119
v_max3_u32 v231, v231, v120, v121
v_max3_u32 v230, v230, v122, v123
v_max3_u32 v231, v231, v124, v125
v_max3_u32 v230, v230, v126, v127
v_max_u32 v230, v230, v231
v_cmp_eq_u32 vcc, -1, v230
s_cbranch_vccz L_ok15_B
s_sub_u32 s98, s98, 1
s_cmp_lg_u32 s98, 0
s_cbranch_scc1 L_spinl15_B
s_branch L_ok15_B
L_spin16_B:
s_mov_b32 s98, 0x8000
s_waitcnt vmcnt(0)
L_spinl16_B:
s_sleep 2
s_add_u32 s101, s4, 4096
buffer_load_dwordx4 v[16:19], v1, s[40:43], s101 offen offset:2048 sc1
buffer_load_dwordx4 v[20:23], v198, s[40:43], s101 offen offset:2048 sc1
s_add_u32 s101, s4, 4096
buffer_load_dwordx4 v[24:27], v1, s[40:43], s101 offen offset:3072 sc1
buffer_load_dwordx4 v[28:31], v198, s[40:43], s101 offen offset:3072 sc1
s_waitcnt vmcnt(0)
v_max3_u32 v230, v16, v17, v18
v_max3_u32 v231, v19, v20, v21
v_max3_u32 v230, v230, v22, v23
v_max3_u32 v231, v231, v24, v25
v_max3_u32 v230, v230, v26, v27
v_max3_u32 v231, v231, v28, v29
v_max3_u32 v230, v230, v30, v31
v_max_u32 v230, v230, v231
v_cmp_eq_u32 vcc, -1, v230
s_cbranch_vccz L_ok16_B
s_sub_u32 s98, s98, 1
s_cmp_lg_u32 s98, 0
s_cbranch_scc1 L_spinl16_B
s_branch L_ok16_B
L_spin17_B:
s_mov_b32 s98, 0x8000
s_waitcnt vmcnt(0)
L_spinl17_B:
s_sleep 2
s_add_u32 s101, s5, 4096
buffer_load_dwordx4 v[32:35], v1, s[40:43], s101 offen offset:2048 sc1
buffer_load_dwordx4 v[36:39], v198, s[40:43], s101 offen offset:2048 sc1
s_add_u32 s101, s5, 4096
buffer_load_dwordx4 v[40:43], v1, s[40:43], s101 offen offset:3072 sc1
buffer_load_dwordx4 v[44:47], v198, s[40:43], s101 offen offset:3072 sc1
s_waitcnt vmcnt(0)
v_max3_u32 v230, v32, v33, v34
v_max3_u32 v231, v35, v36, v37
v_max3_u32 v230, v230, v38, v39
v_max3_u32 v231, v231, v40, v41
v_max3_u32 v230, v230, v42, v43
v_max3_u32 v231, v231, v44, v45
v_max3_u32 v230, v230, v46, v47
v_max_u32 v230, v230, v231
v_cmp_eq_u32 vcc, -1, v230
s_cbranch_vccz L_ok17_B
s_sub_u32 s98, s98, 1
s_cmp_lg_u32 s98, 0
s_cbranch_scc1 L_spinl17_B
s_branch L_ok17_B
L_spin18_B:
s_mov_b32 s98, 0x8000
s_waitcnt vmcnt(0)
L_spinl18_B:
s_sleep 2
s_add_u32 s101, s4, 16384
buffer_load_dwordx4 v[48:51], v1, s[40:43], s101 offen offset:0 sc1
buffer_load_dwordx4 v[52:55], v198, s[40:43], s101 offen offset:0 sc1
s_waitcnt vmcnt(0)
v_max3_u32 v230, v48, v49, v50
v_max3_u32 v231, v51, v52, v53
v_max3_u32 v230, v230, v54, v55
v_max_u32 v230, v230, v231
v_cmp_eq_u32 vcc, -1, v230
s_cbranch_vccz L_ok18_B
s_sub_u32 s98, s98, 1
s_cmp_lg_u32 s98, 0
s_cbranch_scc1 L_spinl18_B
s_branch L_ok18_B
L_spin19_B:
s_mov_b32 s98, 0x8000
s_waitcnt vmcnt(0)
L_spinl19_B:
s_sleep 2
s_add_u32 s101, s4, 16384
buffer_load_dwordx4 v[56:59], v1, s[40:43], s101 offen offset:1024 sc1
buffer_load_dwordx4 v[60:63], v198, s[40:43], s101 offen offset:1024 sc1
s_add_u32 s101, s5, 16384
buffer_load_dwordx4 v[64:67], v1, s[40:43], s101 offen offset:0 sc1
buffer_load_dwordx4 v[68:71], v198, s[40:43], s101 offen offset:0 sc1
s_add_u32 s101, s5, 16384
buffer_load_dwordx4 v[72:75], v1, s[40:43], s101 offen offset:1024 sc1
buffer_load_dwordx4 v[76:79], v198, s[40:43], s101 offen offset:1024 sc1
s_waitcnt vmcnt(0)
v_max3_u32 v230, v56, v57, v58
v_max3_u32 v231, v59, v60, v61
v_max3_u32 v230, v230, v62, v63
v_max3_u32 v231, v231, v64, v65
v_max3_u32 v230, v230, v66, v67
v_max3_u32 v231, v231, v68, v69
v_max3_u32 v230, v230, v70, v71
v_max3_u32 v231, v231, v72, v73
v_max3_u32 v230, v230, v74, v75
v_max3_u32 v231, v231, v76, v77
v_max3_u32 v230, v230, v78, v79
v_max_u32 v230, v230, v231
v_cmp_eq_u32 vcc, -1, v230
s_cbranch_vccz L_ok19_B
s_sub_u32 s98, s98, 1
s_cmp_lg_u32 s98, 0
s_cbranch_scc1 L_spinl19_B
s_branch L_ok19_B
L_codeend:
.section .rodata,"a"
.p2align 6
.amdhsa_kernel parallel_sum__linear_attn_block__geglu_ffn__prompt_kernel
  .amdhsa_next_free_vgpr 512
  .amdhsa_next_free_sgpr 102
  .amdhsa_accum_offset 256
  .amdhsa_group_segment_fixed_size 0
  .amdhsa_kernarg_size 80
  .amdhsa_user_sgpr_count 2
  .amdhsa_user_sgpr_kernarg_segment_ptr 1
  .amdhsa_system_sgpr_workgroup_id_x 1
.end_amdhsa_kernel
```
